```python
import torch

def _softmax(x, axis=-1):
    return torch.softmax(x, dim=axis)

def _gelu(x):
    return torch.nn.functional.gelu(x, approximate='tanh')

def _silu(x):
    return torch.nn.functional.silu(x)

def _sigmoid(x):
    return torch.sigmoid(x)

def _layernorm(x, axis=-1, eps=1e-05):
    m = x.mean(dim=axis, keepdim=True)
    v = x.var(dim=axis, keepdim=True, unbiased=False)
    return (x - m) / torch.sqrt(v + eps)

def _scatter_add(tgt, idx, src, axis=0):
    return tgt.clone().index_add_(axis, idx, src)

def _segment_sum(src, seg, n):
    out = torch.zeros((n,) + src.shape[1:], dtype=src.dtype)
    return out.index_add_(0, seg, src)

def _pad(x, pw):
    flat = tuple((v for pair in reversed(pw) for v in pair))
    return torch.nn.functional.pad(x, flat)
kernel_name = 'concat_heads__ssm_conv_s5__memory_aug_recurrent_mem_tr__prompt'

def setup_inputs():

    _w = lambda a: (lambda t: t.to(torch.bfloat16) if t.is_floating_point() else t)(torch.as_tensor(a))

    def _A_setup():
        B, S, D = (1, 2048, 512)
        P = D
        Lambda_re = -0.5 * (lambda _x: torch.exp(torch.as_tensor(_x)))((lambda *s: torch.randn(*s, dtype=torch.bfloat16) * 0.8)(P))
        Lambda_im = (lambda *s: torch.randn(*s, dtype=torch.bfloat16) * 0.8)(P) * 1.0
        B_re = (lambda *s: torch.randn(*s, dtype=torch.bfloat16) * 0.8)(P, D) * D ** (-0.5)
        B_im = (lambda *s: torch.randn(*s, dtype=torch.bfloat16) * 0.8)(P, D) * D ** (-0.5)
        C_re = (lambda *s: torch.randn(*s, dtype=torch.bfloat16) * 0.8)(D, P) * P ** (-0.5)
        C_im = (lambda *s: torch.randn(*s, dtype=torch.bfloat16) * 0.8)(D, P) * P ** (-0.5)
        log_dt = (lambda *s: torch.randn(*s, dtype=torch.bfloat16) * 0.8)(P) * 0.3 - 2.0
        Dskip = (lambda *s: torch.randn(*s, dtype=torch.bfloat16) * 0.8)(D)
        return {'x': _w((lambda *s: torch.randn(*s, dtype=torch.bfloat16) * 0.05)(B, S, D)), 'Lambda_re': _w(Lambda_re), 'Lambda_im': _w(Lambda_im), 'B_re': _w(B_re), 'B_im': _w(B_im), 'C_re': _w(C_re), 'C_im': _w(C_im), 'log_dt': _w(log_dt), 'Dskip': _w(Dskip)}
    _A_in = _A_setup()

    def _B_setup():
        B, S, Dm = (1, 2048, 512)
        H, Dh = (32, 128)
        M, seg = (8, 32)
        seg = min(seg, S)
        S = S // seg * seg
        return {'x': _w((lambda *s: torch.randn(*s, dtype=torch.bfloat16) * 0.05)(B, S, Dm)), 'mem0': _w((lambda *s: torch.randn(*s, dtype=torch.bfloat16) * 0.8)(B, M, Dm)), 'Wq': _w((lambda *s: torch.randn(*s, dtype=torch.bfloat16) * 1.6)(Dm, H, Dh) * Dm ** (-0.5)), 'Wk': _w((lambda *s: torch.randn(*s, dtype=torch.bfloat16) * 1.6)(Dm, H, Dh) * Dm ** (-0.5)), 'Wv': _w((lambda *s: torch.randn(*s, dtype=torch.bfloat16) * 0.8)(Dm, H, Dh) * Dm ** (-0.5)), 'Wo': _w((lambda *s: torch.randn(*s, dtype=torch.bfloat16) * 0.8)(H, Dh, Dm) * (H * Dh) ** (-0.5)), 'seg_len': seg}
    _B_in = _B_setup()
    return {'A_x': _A_in['x'], 'A_Lambda_re': _A_in['Lambda_re'], 'A_Lambda_im': _A_in['Lambda_im'], 'A_B_re': _A_in['B_re'], 'A_B_im': _A_in['B_im'], 'A_C_re': _A_in['C_re'], 'A_C_im': _A_in['C_im'], 'A_log_dt': _A_in['log_dt'], 'A_Dskip': _A_in['Dskip'], 'B_x': _B_in['x'], 'B_mem0': _B_in['mem0'], 'B_Wq': _B_in['Wq'], 'B_Wk': _B_in['Wk'], 'B_Wv': _B_in['Wv'], 'B_Wo': _B_in['Wo'], 'B_seg_len': _B_in['seg_len']}

def reference(A_x, A_Lambda_re, A_Lambda_im, A_B_re, A_B_im, A_C_re, A_C_im, A_log_dt, A_Dskip, B_x, B_mem0, B_Wq, B_Wk, B_Wv, B_Wo, B_seg_len):

    def _A_ref(x, Lambda_re, Lambda_im, B_re, B_im, C_re, C_im, log_dt, Dskip):
        Bsz, L, H = x.shape
        Lam = Lambda_re + 1j * Lambda_im
        Bmat = B_re + 1j * B_im
        Cmat = C_re + 1j * C_im
        dt = torch.exp(log_dt)
        Lam_bar = torch.exp(dt * Lam)
        B_bar = ((Lam_bar - 1.0) / Lam)[:, None] * Bmat
        Bu = torch.einsum('bld,pd->blp', x + 0j, B_bar)
        h = torch.zeros_like(Bu[:, 0, :])
        hs = []
        for t in range(L):
            h = Lam_bar[None, :] * h + Bu[:, t, :]
            hs.append(h)
        hseq = torch.stack(hs, 1)
        y = 2.0 * torch.einsum('blp,dp->bld', hseq, Cmat).real + x * Dskip[None, None, :]
        return y

    def _B_ref(x, mem0, Wq, Wk, Wv, Wo, seg_len):
        B, S, Dm = x.shape
        H, Dh = (Wq.shape[1], Wq.shape[2])
        M = mem0.shape[1]
        scale = Dh ** (-0.5)
        n_seg = S // seg_len
        L = M + seg_len
        idx = torch.arange(L)
        mask = (idx[:, None] < M) | (idx[:, None] >= idx[None, :])
        mem = mem0
        outs = []
        for s in range(n_seg):
            xs = x[:, s * seg_len:(s + 1) * seg_len, :].clone()
            h = torch.concatenate([mem, xs], axis=1)
            q = torch.einsum('btd,dhe->bhte', h, Wq)
            k = torch.einsum('btd,dhe->bhte', h, Wk)
            v = torch.einsum('btd,dhe->bhte', h, Wv)
            scores = torch.einsum('bhqe,bhke->bhqk', q, k) * scale
            scores = torch.where(mask[None, None], scores, -1000000000.0)
            p = _softmax(scores, axis=-1)
            o = torch.einsum('bhqk,bhke->bhqe', p, v)
            o = torch.einsum('bhte,hed->btd', o, Wo)
            mem = o[:, :M, :].clone()
            outs.append(o[:, M:, :])
        return torch.concatenate(outs, axis=1)
    a = _A_ref(A_x, A_Lambda_re, A_Lambda_im, A_B_re, A_B_im, A_C_re, A_C_im, A_log_dt, A_Dskip)
    b = _B_ref(B_x, B_mem0, B_Wq, B_Wk, B_Wv, B_Wo, B_seg_len)
    return torch.concatenate([a, b], axis=-1)
```

```asm
; @launch grid=(256,1,1) block=(256,1,1) lds=163840
.amdgcn_target "amdgcn-amd-amdhsa--gfx950"
.text
.globl concat_heads__ssm_conv_s5__memory_aug_recurrent_mem_tr__prompt_kernel
.p2align 8
.type concat_heads__ssm_conv_s5__memory_aug_recurrent_mem_tr__prompt_kernel,@function
concat_heads__ssm_conv_s5__memory_aug_recurrent_mem_tr__prompt_kernel:
    s_cmp_ge_u32 s2, 256
    s_cbranch_scc1 L_end
    s_load_dwordx2 s[4:5], s[0:1], 144
    s_load_dwordx2 s[28:29], s[0:1], 136
    s_load_dwordx8 s[64:71], s[0:1], 80
    s_load_dwordx2 s[72:73], s[0:1], 112
    v_lshrrev_b32 v1, 6, v0
    v_and_b32 v0, 63, v0
    v_readfirstlane_b32 s30, v1
    s_waitcnt lgkmcnt(0)
    s_mov_b32 s6, 268435456
    s_mov_b32 s7, 0x20000
    s_getpc_b64 s[40:41]
    s_nop 0
L_pc:
    s_sub_u32 s40, s40, L_pc-concat_heads__ssm_conv_s5__memory_aug_recurrent_mem_tr__prompt_kernel
    s_subb_u32 s41, s41, 0
    s_lshr_b32 s42, s2, 3
    s_and_b32 s42, s42, 31
    s_lshl_b32 s42, s42, 2
    s_add_u32 s42, s42, s30
    s_min_u32 s42, s42, (L_code_end-concat_heads__ssm_conv_s5__memory_aug_recurrent_mem_tr__prompt_kernel)/1024 - 1
    s_lshl_b32 s42, s42, 10
    s_add_u32 s40, s40, s42
    s_addc_u32 s41, s41, 0
    v_lshlrev_b32 v1, 4, v0
    v_mov_b32 v3, s41
    v_add_co_u32 v2, vcc, s40, v1
    s_nop 1
    v_addc_co_u32 v3, vcc, 0, v3, vcc
    global_load_dwordx4 v[244:247], v[2:3], off
    s_getreg_b32 s3, hwreg(HW_REG_XCC_ID, 0, 4)
    s_xor_b32 s3, s3, 3
    s_cmp_lg_u32 s30, 0
    s_cbranch_scc1 L_tkw
    s_and_b32 s45, s3, 7
    s_cmp_eq_u32 s45, 1
    s_cselect_b32 s46, 6, 0
    s_cmp_eq_u32 s45, 7
    s_cselect_b32 s46, 6, s46
    s_xor_b32 s45, s45, s46
    s_mov_b32 s46, 0
    s_mov_b64 exec, 1
    v_mov_b32 v6, 1
    s_nop 1
L_tk:
    s_lshl_b32 s47, s45, 2
    s_add_u32 s47, s47, 128
    s_cmp_eq_u32 s45, 0
    s_cselect_b32 s47, 0, s47
    v_mov_b32 v5, s47
    global_atomic_add v7, v5, v6, s[28:29] sc0
    s_waitcnt vmcnt(0)
    v_readfirstlane_b32 s31, v7
    s_nop 1
    s_cmp_lt_u32 s31, 32
    s_nop 0
    s_cbranch_scc1 L_tkok
    s_add_u32 s45, s45, 1
    s_and_b32 s45, s45, 7
    s_add_u32 s46, s46, 1
    s_cmp_lt_u32 s46, 8
    s_cbranch_scc1 L_tk
    s_mov_b32 s45, 8
L_tkok:
    s_lshl_b32 s45, s45, 5
    s_add_u32 s45, s45, s31
    v_mov_b32 v7, s45
    v_mov_b32 v8, 161792
    ds_write_b32 v8, v7
    s_waitcnt lgkmcnt(0)
    s_mov_b64 exec, -1
L_tkw:
    s_barrier
    v_mov_b32 v8, 161792
    ds_read_b32 v7, v8
    s_waitcnt lgkmcnt(0)
    v_readfirstlane_b32 s31, v7
    s_nop 1
    s_cmp_ge_u32 s31, 256
    s_nop 0
    s_cbranch_scc1 L_end
    s_cmp_ge_u32 s31, 32
    s_cbranch_scc1 L_worker
    s_cmp_lg_u32 s3, 0
    s_cselect_b32 s32, 1, 0
    s_mov_b64 s[24:25], s[64:65]
    s_mov_b32 s26, 8192
    s_mov_b32 s27, 0x20000
    s_mov_b64 s[8:9], s[66:67]
    s_mov_b32 s10, 4194304
    s_mov_b32 s11, 0x20000
    s_mov_b64 s[12:13], s[68:69]
    s_mov_b32 s14, 4194304
    s_mov_b32 s15, 0x20000
    s_mov_b64 s[16:17], s[70:71]
    s_mov_b32 s18, 4194304
    s_mov_b32 s19, 0x20000
    s_mov_b64 s[20:21], s[72:73]
    s_mov_b32 s22, 4194304
    s_mov_b32 s23, 0x20000
    v_lshlrev_b32 v1, 4, v0
    s_lshl_b32 s45, s30, 14
    v_add_u32 v6, s45, v1
    v_add_u32 v10, 0x10000, v6
    v_add_u32 v1, 131072, v1
    s_lshl_b32 s45, s30, 11
    v_add_u32 v2, s45, v1
    v_lshrrev_b32 v32, 5, v0
    v_bfe_u32 v33, v0, 4, 1
    v_and_b32 v34, 15, v0
    v_lshrrev_b32 v35, 4, v0
    v_bfe_u32 v36, v0, 2, 2
    v_and_b32 v37, 3, v0
    v_bfe_u32 v38, v0, 1, 2
    v_lshlrev_b32 v38, 2, v38
    v_bfe_u32 v39, v0, 3, 1
    v_lshl_add_u32 v38, v39, 1, v38
    v_and_b32 v39, 1, v0
    v_add_u32 v38, v38, v39
    v_lshl_add_u32 v38, v35, 4, v38
    v_lshlrev_b32 v38, 4, v38
    s_lshr_b32 s45, s30, 1
    s_lshl_b32 s45, s45, 10
    s_and_b32 s46, s30, 1
    s_lshl_b32 s46, s46, 3
    s_add_u32 s45, s45, s46
    s_add_u32 s45, s45, 131072
    v_add_u32 v5, s45, v38
    v_lshlrev_b32 v38, 4, v34
    v_lshl_add_u32 v38, v35, 2, v38
    s_lshl_b32 s45, s30, 9
    s_add_u32 s45, s45, 155648
    v_add_u32 v3, s45, v38
    s_mov_b32 s44, 4294813696
    v_lshl_add_u32 v38, v35, 2, v36
    v_lshlrev_b32 v39, 4, v38
    v_and_b32 v46, 1, v0
    v_lshl_add_u32 v39, v46, 3, v39
    v_add_u32 v4, 155648, v39
    v_lshlrev_b32 v39, 5, v38
    v_lshl_add_u32 v39, v37, 3, v39
    v_add_u32 v11, 157696, v39
    v_lshl_add_u32 v38, v36, 2, v35
    v_lshlrev_b32 v39, 0, v38
    v_add_u32 v39, s31, v39
    v_mov_b32 v39, s31
    v_and_b32 v39, 31, v39
    v_lshlrev_b32 v38, 11, v38
    v_lshl_add_u32 v38, v37, 4, v38
    v_lshl_add_u32 v38, v39, 6, v38
    s_lshl_b32 s45, s30, 16
    s_add_u32 s45, s45, 1048576
    v_add_u32 v7, s45, v38
    s_mov_b32 s48, 32768
    v_bfe_u32 v38, v0, 2, 1
    v_lshlrev_b32 v38, 5, v38
    v_lshl_add_u32 v38, v46, 4, v38
    v_bfe_u32 v39, v0, 1, 1
    v_lshl_add_u32 v38, v39, 3, v38
    v_lshl_add_u32 v38, v33, 2, v38
    s_lshl_b32 s45, s31, 2
    s_add_u32 s45, s45, s30
    s_lshl_b32 s45, s45, 6
    v_add_u32 v8, s45, v38
    v_mov_b32 v38, 0x44444444
    v_mov_b32 v48, 0xeeeeeeee
    v_cmp_eq_u32 vcc, 0, v39
    s_nop 1
    v_cndmask_b32 v9, v48, v38, vcc
    v_mov_b32 v38, 0x3f80
    v_mov_b32 v39, 0x3f800000
    v_mov_b32 v12, 0
    v_cmp_eq_u32 vcc, 0, v34
    s_nop 1
    v_cndmask_b32 v12, v12, v38, vcc
    v_cmp_eq_u32 vcc, 1, v34
    s_nop 1
    v_cndmask_b32 v12, v12, v39, vcc
    v_mov_b32 v38, 0x3f80
    v_mov_b32 v39, 0x3f800000
    v_mov_b32 v13, 0
    v_cmp_eq_u32 vcc, 2, v34
    s_nop 1
    v_cndmask_b32 v13, v13, v38, vcc
    v_cmp_eq_u32 vcc, 3, v34
    s_nop 1
    v_cndmask_b32 v13, v13, v39, vcc
    v_mov_b32 v38, 0x3f80
    v_mov_b32 v39, 0x3f800000
    v_mov_b32 v14, 0
    v_cmp_eq_u32 vcc, 4, v34
    s_nop 1
    v_cndmask_b32 v14, v14, v38, vcc
    v_cmp_eq_u32 vcc, 5, v34
    s_nop 1
    v_cndmask_b32 v14, v14, v39, vcc
    v_mov_b32 v38, 0x3f80
    v_mov_b32 v39, 0x3f800000
    v_mov_b32 v15, 0
    v_cmp_eq_u32 vcc, 6, v34
    s_nop 1
    v_cndmask_b32 v15, v15, v38, vcc
    v_cmp_eq_u32 vcc, 7, v34
    s_nop 1
    v_cndmask_b32 v15, v15, v39, vcc
    s_lshl_b32 s45, s31, 13
    s_add_u32 s34, s45, 917504
    s_add_u32 s40, s45, 52035584
    s_lshl_b32 s45, s31, 14
    s_add_u32 s38, s45, 1966080
    s_add_u32 s39, s38, 8192
    s_lshl_b32 s45, s30, 11
    s_add_u32 s41, s45, 139264
    s_add_u32 s42, s41, 8192
    s_mov_b32 s50, 0x3e0293ee
    s_mov_b32 s51, 0x3e0293ee
    s_mov_b32 s90, 0x3f803f80
    s_mov_b32 s91, 0x3f803f80
    s_mov_b32 s96, 0x00ff00ff
    s_mov_b32 s97, 0x00ff00ff
    s_mov_b32 s98, 0x00ff00ff
    s_mov_b32 s99, 0
    v_lshlrev_b32 v38, 1, v33
    v_xor_b32 v38, v38, v34
    s_lshl_b32 s45, s30, 2
    v_xor_b32 v38, s45, v38
    v_lshlrev_b32 v38, 4, v38
    v_lshl_add_u32 v38, v35, 13, v38
    s_lshl_b32 s45, s30, 17
    s_lshl_b32 s46, s31, 8
    s_add_u32 s45, s45, s46
    v_add_u32 v40, s45, v38
    s_lshl_b32 s45, s30, 2
    v_xor_b32 v38, s45, v0
    v_lshlrev_b32 v39, 4, v38
    s_lshl_b32 s45, s31, 17
    s_lshl_b32 s46, s30, 14
    s_add_u32 s45, s45, s46
    v_add_u32 v41, s45, v39
    v_xor_b32 v42, 32, v41
    v_lshrrev_b32 v38, 1, v36
    v_and_b32 v39, 1, v36
    v_lshrrev_b32 v48, 1, v37
    v_and_b32 v49, 1, v37
    v_lshlrev_b32 v46, 5, v38
    v_lshl_add_u32 v46, v33, 4, v46
    v_lshl_add_u32 v46, v32, 2, v46
    v_add_u32 v46, v46, v39
    v_lshlrev_b32 v47, 1, v39
    v_lshl_add_u32 v47, v33, 2, v47
    v_lshl_add_u32 v47, v38, 3, v47
    s_lshl_b32 s45, s30, 2
    v_add_u32 v50, s45, v48
    v_xor_b32 v50, v50, v47
    v_lshlrev_b32 v50, 4, v50
    v_lshl_add_u32 v50, v49, 3, v50
    v_lshl_add_u32 v43, v46, 8, v50
    v_xor_b32 v44, 32, v43
    v_lshlrev_b32 v46, 5, v33
    v_lshl_add_u32 v46, v38, 4, v46
    v_lshl_add_u32 v46, v32, 2, v46
    v_add_u32 v46, v46, v39
    v_lshlrev_b32 v47, 1, v39
    v_lshl_add_u32 v47, v38, 2, v47
    v_lshl_add_u32 v47, v33, 3, v47
    v_xor_b32 v50, v48, v47
    v_lshlrev_b32 v50, 4, v50
    v_lshl_add_u32 v50, v49, 3, v50
    v_lshl_add_u32 v50, v46, 10, v50
    s_lshl_b32 s45, s30, 8
    v_add_u32 v45, s45, v50
    s_barrier
    s_lshl_b32 s45, s30, 12
    s_add_u32 m0, s45, 131072
    s_mov_b32 s47, 0
    buffer_load_dwordx4 v40, s[12:15], s47 offen lds
    s_add_u32 m0, s45, 132096
    s_mov_b32 s47, 32768
    buffer_load_dwordx4 v40, s[12:15], s47 offen lds
    s_add_u32 m0, s45, 133120
    s_mov_b32 s47, 65536
    buffer_load_dwordx4 v40, s[12:15], s47 offen lds
    s_add_u32 m0, s45, 134144
    s_mov_b32 s47, 98304
    buffer_load_dwordx4 v40, s[12:15], s47 offen lds
    s_add_u32 m0, s45, 147456
    s_mov_b32 s47, 524288
    buffer_load_dwordx4 v40, s[12:15], s47 offen lds
    s_add_u32 m0, s45, 148480
    s_mov_b32 s47, 557056
    buffer_load_dwordx4 v40, s[12:15], s47 offen lds
    s_add_u32 m0, s45, 149504
    s_mov_b32 s47, 589824
    buffer_load_dwordx4 v40, s[12:15], s47 offen lds
    s_add_u32 m0, s45, 150528
    s_mov_b32 s47, 622592
    buffer_load_dwordx4 v40, s[12:15], s47 offen lds
    s_lshl_b32 s45, s30, 12
    s_add_u32 m0, s45, 0
    s_mov_b32 s47, 0
    buffer_load_dwordx4 v40, s[16:19], s47 offen lds
    s_add_u32 m0, s45, 1024
    s_mov_b32 s47, 32768
    buffer_load_dwordx4 v40, s[16:19], s47 offen lds
    s_add_u32 m0, s45, 2048
    s_mov_b32 s47, 65536
    buffer_load_dwordx4 v40, s[16:19], s47 offen lds
    s_add_u32 m0, s45, 3072
    s_mov_b32 s47, 98304
    buffer_load_dwordx4 v40, s[16:19], s47 offen lds
    s_add_u32 m0, s45, 16384
    s_mov_b32 s47, 524288
    buffer_load_dwordx4 v40, s[16:19], s47 offen lds
    s_add_u32 m0, s45, 17408
    s_mov_b32 s47, 557056
    buffer_load_dwordx4 v40, s[16:19], s47 offen lds
    s_add_u32 m0, s45, 18432
    s_mov_b32 s47, 589824
    buffer_load_dwordx4 v40, s[16:19], s47 offen lds
    s_add_u32 m0, s45, 19456
    s_mov_b32 s47, 622592
    buffer_load_dwordx4 v40, s[16:19], s47 offen lds
    s_lshl_b32 s45, s30, 14
    s_add_u32 m0, s45, 65536
    s_mov_b32 s47, 0
    buffer_load_dwordx4 v41, s[20:23], s47 offen lds
    s_add_u32 m0, s45, 66560
    s_mov_b32 s47, 1024
    buffer_load_dwordx4 v42, s[20:23], s47 offen lds
    s_add_u32 m0, s45, 67584
    s_mov_b32 s47, 2048
    buffer_load_dwordx4 v41, s[20:23], s47 offen lds
    s_add_u32 m0, s45, 68608
    s_mov_b32 s47, 3072
    buffer_load_dwordx4 v42, s[20:23], s47 offen lds
    s_add_u32 m0, s45, 69632
    s_mov_b32 s47, 4096
    buffer_load_dwordx4 v41, s[20:23], s47 offen lds
    s_add_u32 m0, s45, 70656
    s_mov_b32 s47, 5120
    buffer_load_dwordx4 v42, s[20:23], s47 offen lds
    s_add_u32 m0, s45, 71680
    s_mov_b32 s47, 6144
    buffer_load_dwordx4 v41, s[20:23], s47 offen lds
    s_add_u32 m0, s45, 72704
    s_mov_b32 s47, 7168
    buffer_load_dwordx4 v42, s[20:23], s47 offen lds
    s_add_u32 m0, s45, 73728
    s_mov_b32 s47, 8192
    buffer_load_dwordx4 v41, s[20:23], s47 offen lds
    s_add_u32 m0, s45, 74752
    s_mov_b32 s47, 9216
    buffer_load_dwordx4 v42, s[20:23], s47 offen lds
    s_add_u32 m0, s45, 75776
    s_mov_b32 s47, 10240
    buffer_load_dwordx4 v41, s[20:23], s47 offen lds
    s_add_u32 m0, s45, 76800
    s_mov_b32 s47, 11264
    buffer_load_dwordx4 v42, s[20:23], s47 offen lds
    s_add_u32 m0, s45, 77824
    s_mov_b32 s47, 12288
    buffer_load_dwordx4 v41, s[20:23], s47 offen lds
    s_add_u32 m0, s45, 78848
    s_mov_b32 s47, 13312
    buffer_load_dwordx4 v42, s[20:23], s47 offen lds
    s_add_u32 m0, s45, 79872
    s_mov_b32 s47, 14336
    buffer_load_dwordx4 v41, s[20:23], s47 offen lds
    s_add_u32 m0, s45, 80896
    s_mov_b32 s47, 15360
    buffer_load_dwordx4 v42, s[20:23], s47 offen lds
    s_lshl_b32 s45, s30, 12
    s_add_u32 m0, s45, 32768
    s_mov_b32 s47, 1048576
    buffer_load_dwordx4 v40, s[12:15], s47 offen lds
    s_add_u32 m0, s45, 33792
    s_mov_b32 s47, 1081344
    buffer_load_dwordx4 v40, s[12:15], s47 offen lds
    s_add_u32 m0, s45, 34816
    s_mov_b32 s47, 1114112
    buffer_load_dwordx4 v40, s[12:15], s47 offen lds
    s_add_u32 m0, s45, 35840
    s_mov_b32 s47, 1146880
    buffer_load_dwordx4 v40, s[12:15], s47 offen lds
    s_add_u32 m0, s45, 49152
    s_mov_b32 s47, 1572864
    buffer_load_dwordx4 v40, s[12:15], s47 offen lds
    s_add_u32 m0, s45, 50176
    s_mov_b32 s47, 1605632
    buffer_load_dwordx4 v40, s[12:15], s47 offen lds
    s_add_u32 m0, s45, 51200
    s_mov_b32 s47, 1638400
    buffer_load_dwordx4 v40, s[12:15], s47 offen lds
    s_add_u32 m0, s45, 52224
    s_mov_b32 s47, 1671168
    buffer_load_dwordx4 v40, s[12:15], s47 offen lds
    v_lshlrev_b32 v52, 20, v0
    s_mov_b32 s47, 2621440
    buffer_load_dword v30, v52, s[4:7], s47 offen sc1
    v_mov_b32 v52, -1
    v_mov_b32 v53, -1
    v_mov_b32 v54, -1
    v_mov_b32 v55, -1
    buffer_store_dwordx4 v[52:55], v2, s[4:7], s34 offen sc0 sc1
    buffer_store_dwordx4 v[52:55], v2, s[4:7], s34 offen offset:1024 sc0 sc1
    s_mov_b32 exec_lo, 0x00ff00ff
    s_mov_b32 exec_hi, 0
    s_mov_b32 s47, 1572864
    buffer_store_dword v52, v8, s[4:7], s47 offen sc0 sc1
    s_mov_b32 s47, 1581056
    buffer_store_dword v52, v8, s[4:7], s47 offen sc0 sc1
    s_mov_b32 s47, 1589248
    buffer_store_dword v52, v8, s[4:7], s47 offen sc0 sc1
    s_mov_b64 exec, -1
    s_add_u32 s47, s40, 16252928
    buffer_store_dwordx4 v[52:55], v2, s[4:7], s47 offen sc0 sc1
    s_add_u32 s47, s40, 16515072
    buffer_store_dwordx4 v[52:55], v2, s[4:7], s47 offen sc0 sc1
    s_add_u32 s47, s40, 16777216
    buffer_store_dwordx4 v[52:55], v2, s[4:7], s47 offen sc0 sc1
    s_add_u32 s47, s40, 17039360
    buffer_store_dwordx4 v[52:55], v2, s[4:7], s47 offen sc0 sc1
    v_and_b32 v39, 1, v0
    v_lshl_add_u32 v38, v36, 1, v39
    v_lshlrev_b32 v38, 10, v38
    v_lshl_add_u32 v38, v35, 3, v38
    v_bfe_u32 v39, v0, 1, 1
    v_lshl_add_u32 v38, v39, 6, v38
    s_lshl_b32 s45, s30, 8
    buffer_load_dwordx2 v[56:57], v38, s[24:27], s45 offen
    buffer_load_dwordx2 v[58:59], v38, s[24:27], s45 offen offset:32
    buffer_load_dwordx2 v[60:61], v38, s[24:27], s45 offen offset:128
    buffer_load_dwordx2 v[62:63], v38, s[24:27], s45 offen offset:160
    v_mov_b32 v0, v11
    s_waitcnt vmcnt(46)
    s_barrier
    v_add_u32 v51, 131072, v43
    v_add_u32 v52, 131072, v44
    s_cmp_lg_u32 s30, 0
    s_cbranch_scc1 CL_tq0_1
    ds_read_b64_tr_b16 a[0:1], v51 offset:0
    ds_read_b64_tr_b16 a[2:3], v51 offset:512
    ds_read_b64_tr_b16 a[4:5], v51 offset:2048
    ds_read_b64_tr_b16 a[6:7], v51 offset:2560
    ds_read_b64_tr_b16 a[8:9], v51 offset:16384
    ds_read_b64_tr_b16 a[10:11], v51 offset:16896
    ds_read_b64_tr_b16 a[12:13], v51 offset:18432
    ds_read_b64_tr_b16 a[14:15], v51 offset:18944
    s_waitcnt lgkmcnt(4)
    ds_read_b64_tr_b16 a[64:65], v52 offset:0
    ds_read_b64_tr_b16 a[66:67], v52 offset:512
    ds_read_b64_tr_b16 a[68:69], v52 offset:2048
    ds_read_b64_tr_b16 a[70:71], v52 offset:2560
    ds_read_b64_tr_b16 a[72:73], v52 offset:16384
    ds_read_b64_tr_b16 a[74:75], v52 offset:16896
    ds_read_b64_tr_b16 a[76:77], v52 offset:18432
    ds_read_b64_tr_b16 a[78:79], v52 offset:18944
    s_branch CL_tq0_e
CL_tq0_1:
    s_cmp_lg_u32 s30, 1
    s_cbranch_scc1 CL_tq0_2
    ds_read_b64_tr_b16 a[16:17], v51 offset:0
    ds_read_b64_tr_b16 a[18:19], v51 offset:512
    ds_read_b64_tr_b16 a[20:21], v51 offset:2048
    ds_read_b64_tr_b16 a[22:23], v51 offset:2560
    ds_read_b64_tr_b16 a[24:25], v51 offset:16384
    ds_read_b64_tr_b16 a[26:27], v51 offset:16896
    ds_read_b64_tr_b16 a[28:29], v51 offset:18432
    ds_read_b64_tr_b16 a[30:31], v51 offset:18944
    s_waitcnt lgkmcnt(4)
    ds_read_b64_tr_b16 a[80:81], v52 offset:0
    ds_read_b64_tr_b16 a[82:83], v52 offset:512
    ds_read_b64_tr_b16 a[84:85], v52 offset:2048
    ds_read_b64_tr_b16 a[86:87], v52 offset:2560
    ds_read_b64_tr_b16 a[88:89], v52 offset:16384
    ds_read_b64_tr_b16 a[90:91], v52 offset:16896
    ds_read_b64_tr_b16 a[92:93], v52 offset:18432
    ds_read_b64_tr_b16 a[94:95], v52 offset:18944
    s_branch CL_tq0_e
CL_tq0_2:
    s_cmp_lg_u32 s30, 2
    s_cbranch_scc1 CL_tq0_3
    ds_read_b64_tr_b16 a[32:33], v51 offset:0
    ds_read_b64_tr_b16 a[34:35], v51 offset:512
    ds_read_b64_tr_b16 a[36:37], v51 offset:2048
    ds_read_b64_tr_b16 a[38:39], v51 offset:2560
    ds_read_b64_tr_b16 a[40:41], v51 offset:16384
    ds_read_b64_tr_b16 a[42:43], v51 offset:16896
    ds_read_b64_tr_b16 a[44:45], v51 offset:18432
    ds_read_b64_tr_b16 a[46:47], v51 offset:18944
    s_waitcnt lgkmcnt(4)
    ds_read_b64_tr_b16 a[96:97], v52 offset:0
    ds_read_b64_tr_b16 a[98:99], v52 offset:512
    ds_read_b64_tr_b16 a[100:101], v52 offset:2048
    ds_read_b64_tr_b16 a[102:103], v52 offset:2560
    ds_read_b64_tr_b16 a[104:105], v52 offset:16384
    ds_read_b64_tr_b16 a[106:107], v52 offset:16896
    ds_read_b64_tr_b16 a[108:109], v52 offset:18432
    ds_read_b64_tr_b16 a[110:111], v52 offset:18944
    s_branch CL_tq0_e
CL_tq0_3:
    ds_read_b64_tr_b16 a[48:49], v51 offset:0
    ds_read_b64_tr_b16 a[50:51], v51 offset:512
    ds_read_b64_tr_b16 a[52:53], v51 offset:2048
    ds_read_b64_tr_b16 a[54:55], v51 offset:2560
    ds_read_b64_tr_b16 a[56:57], v51 offset:16384
    ds_read_b64_tr_b16 a[58:59], v51 offset:16896
    ds_read_b64_tr_b16 a[60:61], v51 offset:18432
    ds_read_b64_tr_b16 a[62:63], v51 offset:18944
    s_waitcnt lgkmcnt(4)
    ds_read_b64_tr_b16 a[112:113], v52 offset:0
    ds_read_b64_tr_b16 a[114:115], v52 offset:512
    ds_read_b64_tr_b16 a[116:117], v52 offset:2048
    ds_read_b64_tr_b16 a[118:119], v52 offset:2560
    ds_read_b64_tr_b16 a[120:121], v52 offset:16384
    ds_read_b64_tr_b16 a[122:123], v52 offset:16896
    ds_read_b64_tr_b16 a[124:125], v52 offset:18432
    ds_read_b64_tr_b16 a[126:127], v52 offset:18944
CL_tq0_e:
    s_waitcnt lgkmcnt(0)
    s_barrier
    s_lshl_b32 s45, s30, 12
    s_add_u32 m0, s45, 131072
    s_mov_b32 s47, 1048576
    buffer_load_dwordx4 v40, s[16:19], s47 offen lds
    s_add_u32 m0, s45, 132096
    s_mov_b32 s47, 1081344
    buffer_load_dwordx4 v40, s[16:19], s47 offen lds
    s_add_u32 m0, s45, 133120
    s_mov_b32 s47, 1114112
    buffer_load_dwordx4 v40, s[16:19], s47 offen lds
    s_add_u32 m0, s45, 134144
    s_mov_b32 s47, 1146880
    buffer_load_dwordx4 v40, s[16:19], s47 offen lds
    s_add_u32 m0, s45, 147456
    s_mov_b32 s47, 1572864
    buffer_load_dwordx4 v40, s[16:19], s47 offen lds
    s_add_u32 m0, s45, 148480
    s_mov_b32 s47, 1605632
    buffer_load_dwordx4 v40, s[16:19], s47 offen lds
    s_add_u32 m0, s45, 149504
    s_mov_b32 s47, 1638400
    buffer_load_dwordx4 v40, s[16:19], s47 offen lds
    s_add_u32 m0, s45, 150528
    s_mov_b32 s47, 1671168
    buffer_load_dwordx4 v40, s[16:19], s47 offen lds
    s_waitcnt vmcnt(46)
    s_barrier
    v_add_u32 v51, 0, v43
    v_add_u32 v52, 0, v44
    s_cmp_lg_u32 s30, 0
    s_cbranch_scc1 CL_tq1_1
    ds_read_b64_tr_b16 a[128:129], v51 offset:0
    ds_read_b64_tr_b16 a[130:131], v51 offset:512
    ds_read_b64_tr_b16 a[132:133], v51 offset:2048
    ds_read_b64_tr_b16 a[134:135], v51 offset:2560
    ds_read_b64_tr_b16 a[136:137], v51 offset:16384
    ds_read_b64_tr_b16 a[138:139], v51 offset:16896
    ds_read_b64_tr_b16 a[140:141], v51 offset:18432
    ds_read_b64_tr_b16 a[142:143], v51 offset:18944
    s_waitcnt lgkmcnt(4)
    ds_read_b64_tr_b16 a[192:193], v52 offset:0
    ds_read_b64_tr_b16 a[194:195], v52 offset:512
    ds_read_b64_tr_b16 a[196:197], v52 offset:2048
    ds_read_b64_tr_b16 a[198:199], v52 offset:2560
    ds_read_b64_tr_b16 a[200:201], v52 offset:16384
    ds_read_b64_tr_b16 a[202:203], v52 offset:16896
    ds_read_b64_tr_b16 a[204:205], v52 offset:18432
    ds_read_b64_tr_b16 a[206:207], v52 offset:18944
    s_branch CL_tq1_e
CL_tq1_1:
    s_cmp_lg_u32 s30, 1
    s_cbranch_scc1 CL_tq1_2
    ds_read_b64_tr_b16 a[144:145], v51 offset:0
    ds_read_b64_tr_b16 a[146:147], v51 offset:512
    ds_read_b64_tr_b16 a[148:149], v51 offset:2048
    ds_read_b64_tr_b16 a[150:151], v51 offset:2560
    ds_read_b64_tr_b16 a[152:153], v51 offset:16384
    ds_read_b64_tr_b16 a[154:155], v51 offset:16896
    ds_read_b64_tr_b16 a[156:157], v51 offset:18432
    ds_read_b64_tr_b16 a[158:159], v51 offset:18944
    s_waitcnt lgkmcnt(4)
    ds_read_b64_tr_b16 a[208:209], v52 offset:0
    ds_read_b64_tr_b16 a[210:211], v52 offset:512
    ds_read_b64_tr_b16 a[212:213], v52 offset:2048
    ds_read_b64_tr_b16 a[214:215], v52 offset:2560
    ds_read_b64_tr_b16 a[216:217], v52 offset:16384
    ds_read_b64_tr_b16 a[218:219], v52 offset:16896
    ds_read_b64_tr_b16 a[220:221], v52 offset:18432
    ds_read_b64_tr_b16 a[222:223], v52 offset:18944
    s_branch CL_tq1_e
CL_tq1_2:
    s_cmp_lg_u32 s30, 2
    s_cbranch_scc1 CL_tq1_3
    ds_read_b64_tr_b16 a[160:161], v51 offset:0
    ds_read_b64_tr_b16 a[162:163], v51 offset:512
    ds_read_b64_tr_b16 a[164:165], v51 offset:2048
    ds_read_b64_tr_b16 a[166:167], v51 offset:2560
    ds_read_b64_tr_b16 a[168:169], v51 offset:16384
    ds_read_b64_tr_b16 a[170:171], v51 offset:16896
    ds_read_b64_tr_b16 a[172:173], v51 offset:18432
    ds_read_b64_tr_b16 a[174:175], v51 offset:18944
    s_waitcnt lgkmcnt(4)
    ds_read_b64_tr_b16 a[224:225], v52 offset:0
    ds_read_b64_tr_b16 a[226:227], v52 offset:512
    ds_read_b64_tr_b16 a[228:229], v52 offset:2048
    ds_read_b64_tr_b16 a[230:231], v52 offset:2560
    ds_read_b64_tr_b16 a[232:233], v52 offset:16384
    ds_read_b64_tr_b16 a[234:235], v52 offset:16896
    ds_read_b64_tr_b16 a[236:237], v52 offset:18432
    ds_read_b64_tr_b16 a[238:239], v52 offset:18944
    s_branch CL_tq1_e
CL_tq1_3:
    ds_read_b64_tr_b16 a[176:177], v51 offset:0
    ds_read_b64_tr_b16 a[178:179], v51 offset:512
    ds_read_b64_tr_b16 a[180:181], v51 offset:2048
    ds_read_b64_tr_b16 a[182:183], v51 offset:2560
    ds_read_b64_tr_b16 a[184:185], v51 offset:16384
    ds_read_b64_tr_b16 a[186:187], v51 offset:16896
    ds_read_b64_tr_b16 a[188:189], v51 offset:18432
    ds_read_b64_tr_b16 a[190:191], v51 offset:18944
    s_waitcnt lgkmcnt(4)
    ds_read_b64_tr_b16 a[240:241], v52 offset:0
    ds_read_b64_tr_b16 a[242:243], v52 offset:512
    ds_read_b64_tr_b16 a[244:245], v52 offset:2048
    ds_read_b64_tr_b16 a[246:247], v52 offset:2560
    ds_read_b64_tr_b16 a[248:249], v52 offset:16384
    ds_read_b64_tr_b16 a[250:251], v52 offset:16896
    ds_read_b64_tr_b16 a[252:253], v52 offset:18432
    ds_read_b64_tr_b16 a[254:255], v52 offset:18944
CL_tq1_e:
    s_waitcnt lgkmcnt(0)
    s_barrier
    s_lshl_b32 s45, s30, 12
    s_add_u32 m0, s45, 0
    s_mov_b32 s47, 0
    buffer_load_dwordx4 v40, s[8:11], s47 offen lds
    s_add_u32 m0, s45, 1024
    s_mov_b32 s47, 32768
    buffer_load_dwordx4 v40, s[8:11], s47 offen lds
    s_add_u32 m0, s45, 2048
    s_mov_b32 s47, 65536
    buffer_load_dwordx4 v40, s[8:11], s47 offen lds
    s_add_u32 m0, s45, 3072
    s_mov_b32 s47, 98304
    buffer_load_dwordx4 v40, s[8:11], s47 offen lds
    s_add_u32 m0, s45, 16384
    s_mov_b32 s47, 524288
    buffer_load_dwordx4 v40, s[8:11], s47 offen lds
    s_add_u32 m0, s45, 17408
    s_mov_b32 s47, 557056
    buffer_load_dwordx4 v40, s[8:11], s47 offen lds
    s_add_u32 m0, s45, 18432
    s_mov_b32 s47, 589824
    buffer_load_dwordx4 v40, s[8:11], s47 offen lds
    s_add_u32 m0, s45, 19456
    s_mov_b32 s47, 622592
    buffer_load_dwordx4 v40, s[8:11], s47 offen lds
    s_waitcnt vmcnt(38)
    s_barrier
    v_xor_b32 v51, 0, v45
    v_add_u32 v51, 65536, v51
    ds_read_b64_tr_b16 v[192:193], v51 offset:0
    ds_read_b64_tr_b16 v[194:195], v51 offset:2048
    ds_read_b64_tr_b16 v[196:197], v51 offset:8192
    ds_read_b64_tr_b16 v[198:199], v51 offset:10240
    s_waitcnt lgkmcnt(8)
    v_xor_b32 v51, 32, v45
    v_add_u32 v51, 65536, v51
    ds_read_b64_tr_b16 v[200:201], v51 offset:0
    ds_read_b64_tr_b16 v[202:203], v51 offset:2048
    ds_read_b64_tr_b16 v[204:205], v51 offset:8192
    ds_read_b64_tr_b16 v[206:207], v51 offset:10240
    s_waitcnt lgkmcnt(8)
    v_xor_b32 v51, 64, v45
    v_add_u32 v51, 65536, v51
    ds_read_b64_tr_b16 v[208:209], v51 offset:0
    ds_read_b64_tr_b16 v[210:211], v51 offset:2048
    ds_read_b64_tr_b16 v[212:213], v51 offset:8192
    ds_read_b64_tr_b16 v[214:215], v51 offset:10240
    s_waitcnt lgkmcnt(8)
    v_xor_b32 v51, 96, v45
    v_add_u32 v51, 65536, v51
    ds_read_b64_tr_b16 v[216:217], v51 offset:0
    ds_read_b64_tr_b16 v[218:219], v51 offset:2048
    ds_read_b64_tr_b16 v[220:221], v51 offset:8192
    ds_read_b64_tr_b16 v[222:223], v51 offset:10240
    s_waitcnt lgkmcnt(8)
    v_xor_b32 v51, 128, v45
    v_add_u32 v51, 65536, v51
    ds_read_b64_tr_b16 v[224:225], v51 offset:0
    ds_read_b64_tr_b16 v[226:227], v51 offset:2048
    ds_read_b64_tr_b16 v[228:229], v51 offset:8192
    ds_read_b64_tr_b16 v[230:231], v51 offset:10240
    s_waitcnt lgkmcnt(8)
    v_xor_b32 v51, 160, v45
    v_add_u32 v51, 65536, v51
    ds_read_b64_tr_b16 v[232:233], v51 offset:0
    ds_read_b64_tr_b16 v[234:235], v51 offset:2048
    ds_read_b64_tr_b16 v[236:237], v51 offset:8192
    ds_read_b64_tr_b16 v[238:239], v51 offset:10240
    s_waitcnt lgkmcnt(8)
    v_xor_b32 v51, 192, v45
    v_add_u32 v51, 65536, v51
    ds_read_b64_tr_b16 v[240:241], v51 offset:0
    ds_read_b64_tr_b16 v[242:243], v51 offset:2048
    ds_read_b64_tr_b16 v[244:245], v51 offset:8192
    ds_read_b64_tr_b16 v[246:247], v51 offset:10240
    s_waitcnt lgkmcnt(8)
    v_xor_b32 v51, 224, v45
    v_add_u32 v51, 65536, v51
    ds_read_b64_tr_b16 v[248:249], v51 offset:0
    ds_read_b64_tr_b16 v[250:251], v51 offset:2048
    ds_read_b64_tr_b16 v[252:253], v51 offset:8192
    ds_read_b64_tr_b16 v[254:255], v51 offset:10240
    s_waitcnt lgkmcnt(8)
    s_waitcnt lgkmcnt(0)
    s_barrier
    s_lshl_b32 s45, s30, 14
    s_add_u32 m0, s45, 65536
    s_mov_b32 s47, 65536
    buffer_load_dwordx4 v41, s[20:23], s47 offen lds
    s_add_u32 m0, s45, 66560
    s_mov_b32 s47, 66560
    buffer_load_dwordx4 v42, s[20:23], s47 offen lds
    s_add_u32 m0, s45, 67584
    s_mov_b32 s47, 67584
    buffer_load_dwordx4 v41, s[20:23], s47 offen lds
    s_add_u32 m0, s45, 68608
    s_mov_b32 s47, 68608
    buffer_load_dwordx4 v42, s[20:23], s47 offen lds
    s_add_u32 m0, s45, 69632
    s_mov_b32 s47, 69632
    buffer_load_dwordx4 v41, s[20:23], s47 offen lds
    s_add_u32 m0, s45, 70656
    s_mov_b32 s47, 70656
    buffer_load_dwordx4 v42, s[20:23], s47 offen lds
    s_add_u32 m0, s45, 71680
    s_mov_b32 s47, 71680
    buffer_load_dwordx4 v41, s[20:23], s47 offen lds
    s_add_u32 m0, s45, 72704
    s_mov_b32 s47, 72704
    buffer_load_dwordx4 v42, s[20:23], s47 offen lds
    s_add_u32 m0, s45, 73728
    s_mov_b32 s47, 73728
    buffer_load_dwordx4 v41, s[20:23], s47 offen lds
    s_add_u32 m0, s45, 74752
    s_mov_b32 s47, 74752
    buffer_load_dwordx4 v42, s[20:23], s47 offen lds
    s_add_u32 m0, s45, 75776
    s_mov_b32 s47, 75776
    buffer_load_dwordx4 v41, s[20:23], s47 offen lds
    s_add_u32 m0, s45, 76800
    s_mov_b32 s47, 76800
    buffer_load_dwordx4 v42, s[20:23], s47 offen lds
    s_add_u32 m0, s45, 77824
    s_mov_b32 s47, 77824
    buffer_load_dwordx4 v41, s[20:23], s47 offen lds
    s_add_u32 m0, s45, 78848
    s_mov_b32 s47, 78848
    buffer_load_dwordx4 v42, s[20:23], s47 offen lds
    s_add_u32 m0, s45, 79872
    s_mov_b32 s47, 79872
    buffer_load_dwordx4 v41, s[20:23], s47 offen lds
    s_add_u32 m0, s45, 80896
    s_mov_b32 s47, 80896
    buffer_load_dwordx4 v42, s[20:23], s47 offen lds
    s_waitcnt vmcnt(46)
    s_barrier
    v_add_u32 v51, 32768, v43
    v_add_u32 v52, 32768, v44
    s_cmp_lg_u32 s30, 0
    s_cbranch_scc1 CL_tq2_1
    ds_read_b64_tr_b16 a[16:17], v51 offset:0
    ds_read_b64_tr_b16 a[18:19], v51 offset:512
    ds_read_b64_tr_b16 a[20:21], v51 offset:2048
    ds_read_b64_tr_b16 a[22:23], v51 offset:2560
    ds_read_b64_tr_b16 a[24:25], v51 offset:16384
    ds_read_b64_tr_b16 a[26:27], v51 offset:16896
    ds_read_b64_tr_b16 a[28:29], v51 offset:18432
    ds_read_b64_tr_b16 a[30:31], v51 offset:18944
    s_waitcnt lgkmcnt(4)
    ds_read_b64_tr_b16 a[80:81], v52 offset:0
    ds_read_b64_tr_b16 a[82:83], v52 offset:512
    ds_read_b64_tr_b16 a[84:85], v52 offset:2048
    ds_read_b64_tr_b16 a[86:87], v52 offset:2560
    ds_read_b64_tr_b16 a[88:89], v52 offset:16384
    ds_read_b64_tr_b16 a[90:91], v52 offset:16896
    ds_read_b64_tr_b16 a[92:93], v52 offset:18432
    ds_read_b64_tr_b16 a[94:95], v52 offset:18944
    s_branch CL_tq2_e
CL_tq2_1:
    s_cmp_lg_u32 s30, 1
    s_cbranch_scc1 CL_tq2_2
    ds_read_b64_tr_b16 a[0:1], v51 offset:0
    ds_read_b64_tr_b16 a[2:3], v51 offset:512
    ds_read_b64_tr_b16 a[4:5], v51 offset:2048
    ds_read_b64_tr_b16 a[6:7], v51 offset:2560
    ds_read_b64_tr_b16 a[8:9], v51 offset:16384
    ds_read_b64_tr_b16 a[10:11], v51 offset:16896
    ds_read_b64_tr_b16 a[12:13], v51 offset:18432
    ds_read_b64_tr_b16 a[14:15], v51 offset:18944
    s_waitcnt lgkmcnt(4)
    ds_read_b64_tr_b16 a[64:65], v52 offset:0
    ds_read_b64_tr_b16 a[66:67], v52 offset:512
    ds_read_b64_tr_b16 a[68:69], v52 offset:2048
    ds_read_b64_tr_b16 a[70:71], v52 offset:2560
    ds_read_b64_tr_b16 a[72:73], v52 offset:16384
    ds_read_b64_tr_b16 a[74:75], v52 offset:16896
    ds_read_b64_tr_b16 a[76:77], v52 offset:18432
    ds_read_b64_tr_b16 a[78:79], v52 offset:18944
    s_branch CL_tq2_e
CL_tq2_2:
    s_cmp_lg_u32 s30, 2
    s_cbranch_scc1 CL_tq2_3
    ds_read_b64_tr_b16 a[48:49], v51 offset:0
    ds_read_b64_tr_b16 a[50:51], v51 offset:512
    ds_read_b64_tr_b16 a[52:53], v51 offset:2048
    ds_read_b64_tr_b16 a[54:55], v51 offset:2560
    ds_read_b64_tr_b16 a[56:57], v51 offset:16384
    ds_read_b64_tr_b16 a[58:59], v51 offset:16896
    ds_read_b64_tr_b16 a[60:61], v51 offset:18432
    ds_read_b64_tr_b16 a[62:63], v51 offset:18944
    s_waitcnt lgkmcnt(4)
    ds_read_b64_tr_b16 a[112:113], v52 offset:0
    ds_read_b64_tr_b16 a[114:115], v52 offset:512
    ds_read_b64_tr_b16 a[116:117], v52 offset:2048
    ds_read_b64_tr_b16 a[118:119], v52 offset:2560
    ds_read_b64_tr_b16 a[120:121], v52 offset:16384
    ds_read_b64_tr_b16 a[122:123], v52 offset:16896
    ds_read_b64_tr_b16 a[124:125], v52 offset:18432
    ds_read_b64_tr_b16 a[126:127], v52 offset:18944
    s_branch CL_tq2_e
CL_tq2_3:
    ds_read_b64_tr_b16 a[32:33], v51 offset:0
    ds_read_b64_tr_b16 a[34:35], v51 offset:512
    ds_read_b64_tr_b16 a[36:37], v51 offset:2048
    ds_read_b64_tr_b16 a[38:39], v51 offset:2560
    ds_read_b64_tr_b16 a[40:41], v51 offset:16384
    ds_read_b64_tr_b16 a[42:43], v51 offset:16896
    ds_read_b64_tr_b16 a[44:45], v51 offset:18432
    ds_read_b64_tr_b16 a[46:47], v51 offset:18944
    s_waitcnt lgkmcnt(4)
    ds_read_b64_tr_b16 a[96:97], v52 offset:0
    ds_read_b64_tr_b16 a[98:99], v52 offset:512
    ds_read_b64_tr_b16 a[100:101], v52 offset:2048
    ds_read_b64_tr_b16 a[102:103], v52 offset:2560
    ds_read_b64_tr_b16 a[104:105], v52 offset:16384
    ds_read_b64_tr_b16 a[106:107], v52 offset:16896
    ds_read_b64_tr_b16 a[108:109], v52 offset:18432
    ds_read_b64_tr_b16 a[110:111], v52 offset:18944
CL_tq2_e:
    s_waitcnt lgkmcnt(0)
    s_barrier
    s_lshl_b32 s45, s30, 12
    s_add_u32 m0, s45, 32768
    s_mov_b32 s47, 1048576
    buffer_load_dwordx4 v40, s[8:11], s47 offen lds
    s_add_u32 m0, s45, 33792
    s_mov_b32 s47, 1081344
    buffer_load_dwordx4 v40, s[8:11], s47 offen lds
    s_add_u32 m0, s45, 34816
    s_mov_b32 s47, 1114112
    buffer_load_dwordx4 v40, s[8:11], s47 offen lds
    s_add_u32 m0, s45, 35840
    s_mov_b32 s47, 1146880
    buffer_load_dwordx4 v40, s[8:11], s47 offen lds
    s_add_u32 m0, s45, 49152
    s_mov_b32 s47, 1572864
    buffer_load_dwordx4 v40, s[8:11], s47 offen lds
    s_add_u32 m0, s45, 50176
    s_mov_b32 s47, 1605632
    buffer_load_dwordx4 v40, s[8:11], s47 offen lds
    s_add_u32 m0, s45, 51200
    s_mov_b32 s47, 1638400
    buffer_load_dwordx4 v40, s[8:11], s47 offen lds
    s_add_u32 m0, s45, 52224
    s_mov_b32 s47, 1671168
    buffer_load_dwordx4 v40, s[8:11], s47 offen lds
    s_waitcnt vmcnt(32)
    s_barrier
    v_add_u32 v51, 131072, v43
    v_add_u32 v52, 131072, v44
    s_cmp_lg_u32 s30, 0
    s_cbranch_scc1 CL_tq3_1
    ds_read_b64_tr_b16 a[144:145], v51 offset:0
    ds_read_b64_tr_b16 a[146:147], v51 offset:512
    ds_read_b64_tr_b16 a[148:149], v51 offset:2048
    ds_read_b64_tr_b16 a[150:151], v51 offset:2560
    ds_read_b64_tr_b16 a[152:153], v51 offset:16384
    ds_read_b64_tr_b16 a[154:155], v51 offset:16896
    ds_read_b64_tr_b16 a[156:157], v51 offset:18432
    ds_read_b64_tr_b16 a[158:159], v51 offset:18944
    s_waitcnt lgkmcnt(4)
    ds_read_b64_tr_b16 a[208:209], v52 offset:0
    ds_read_b64_tr_b16 a[210:211], v52 offset:512
    ds_read_b64_tr_b16 a[212:213], v52 offset:2048
    ds_read_b64_tr_b16 a[214:215], v52 offset:2560
    ds_read_b64_tr_b16 a[216:217], v52 offset:16384
    ds_read_b64_tr_b16 a[218:219], v52 offset:16896
    ds_read_b64_tr_b16 a[220:221], v52 offset:18432
    ds_read_b64_tr_b16 a[222:223], v52 offset:18944
    s_branch CL_tq3_e
CL_tq3_1:
    s_cmp_lg_u32 s30, 1
    s_cbranch_scc1 CL_tq3_2
    ds_read_b64_tr_b16 a[128:129], v51 offset:0
    ds_read_b64_tr_b16 a[130:131], v51 offset:512
    ds_read_b64_tr_b16 a[132:133], v51 offset:2048
    ds_read_b64_tr_b16 a[134:135], v51 offset:2560
    ds_read_b64_tr_b16 a[136:137], v51 offset:16384
    ds_read_b64_tr_b16 a[138:139], v51 offset:16896
    ds_read_b64_tr_b16 a[140:141], v51 offset:18432
    ds_read_b64_tr_b16 a[142:143], v51 offset:18944
    s_waitcnt lgkmcnt(4)
    ds_read_b64_tr_b16 a[192:193], v52 offset:0
    ds_read_b64_tr_b16 a[194:195], v52 offset:512
    ds_read_b64_tr_b16 a[196:197], v52 offset:2048
    ds_read_b64_tr_b16 a[198:199], v52 offset:2560
    ds_read_b64_tr_b16 a[200:201], v52 offset:16384
    ds_read_b64_tr_b16 a[202:203], v52 offset:16896
    ds_read_b64_tr_b16 a[204:205], v52 offset:18432
    ds_read_b64_tr_b16 a[206:207], v52 offset:18944
    s_branch CL_tq3_e
CL_tq3_2:
    s_cmp_lg_u32 s30, 2
    s_cbranch_scc1 CL_tq3_3
    ds_read_b64_tr_b16 a[176:177], v51 offset:0
    ds_read_b64_tr_b16 a[178:179], v51 offset:512
    ds_read_b64_tr_b16 a[180:181], v51 offset:2048
    ds_read_b64_tr_b16 a[182:183], v51 offset:2560
    ds_read_b64_tr_b16 a[184:185], v51 offset:16384
    ds_read_b64_tr_b16 a[186:187], v51 offset:16896
    ds_read_b64_tr_b16 a[188:189], v51 offset:18432
    ds_read_b64_tr_b16 a[190:191], v51 offset:18944
    s_waitcnt lgkmcnt(4)
    ds_read_b64_tr_b16 a[240:241], v52 offset:0
    ds_read_b64_tr_b16 a[242:243], v52 offset:512
    ds_read_b64_tr_b16 a[244:245], v52 offset:2048
    ds_read_b64_tr_b16 a[246:247], v52 offset:2560
    ds_read_b64_tr_b16 a[248:249], v52 offset:16384
    ds_read_b64_tr_b16 a[250:251], v52 offset:16896
    ds_read_b64_tr_b16 a[252:253], v52 offset:18432
    ds_read_b64_tr_b16 a[254:255], v52 offset:18944
    s_branch CL_tq3_e
CL_tq3_3:
    ds_read_b64_tr_b16 a[160:161], v51 offset:0
    ds_read_b64_tr_b16 a[162:163], v51 offset:512
    ds_read_b64_tr_b16 a[164:165], v51 offset:2048
    ds_read_b64_tr_b16 a[166:167], v51 offset:2560
    ds_read_b64_tr_b16 a[168:169], v51 offset:16384
    ds_read_b64_tr_b16 a[170:171], v51 offset:16896
    ds_read_b64_tr_b16 a[172:173], v51 offset:18432
    ds_read_b64_tr_b16 a[174:175], v51 offset:18944
    s_waitcnt lgkmcnt(4)
    ds_read_b64_tr_b16 a[224:225], v52 offset:0
    ds_read_b64_tr_b16 a[226:227], v52 offset:512
    ds_read_b64_tr_b16 a[228:229], v52 offset:2048
    ds_read_b64_tr_b16 a[230:231], v52 offset:2560
    ds_read_b64_tr_b16 a[232:233], v52 offset:16384
    ds_read_b64_tr_b16 a[234:235], v52 offset:16896
    ds_read_b64_tr_b16 a[236:237], v52 offset:18432
    ds_read_b64_tr_b16 a[238:239], v52 offset:18944
CL_tq3_e:
    s_waitcnt lgkmcnt(0)
    s_barrier
    s_lshl_b32 s45, s30, 12
    s_add_u32 m0, s45, 131072
    s_mov_b32 s47, 2097152
    buffer_load_dwordx4 v40, s[12:15], s47 offen lds
    s_add_u32 m0, s45, 132096
    s_mov_b32 s47, 2129920
    buffer_load_dwordx4 v40, s[12:15], s47 offen lds
    s_add_u32 m0, s45, 133120
    s_mov_b32 s47, 2162688
    buffer_load_dwordx4 v40, s[12:15], s47 offen lds
    s_add_u32 m0, s45, 134144
    s_mov_b32 s47, 2195456
    buffer_load_dwordx4 v40, s[12:15], s47 offen lds
    s_add_u32 m0, s45, 147456
    s_mov_b32 s47, 2621440
    buffer_load_dwordx4 v40, s[12:15], s47 offen lds
    s_add_u32 m0, s45, 148480
    s_mov_b32 s47, 2654208
    buffer_load_dwordx4 v40, s[12:15], s47 offen lds
    s_add_u32 m0, s45, 149504
    s_mov_b32 s47, 2686976
    buffer_load_dwordx4 v40, s[12:15], s47 offen lds
    s_add_u32 m0, s45, 150528
    s_mov_b32 s47, 2719744
    buffer_load_dwordx4 v40, s[12:15], s47 offen lds
    v_mov_b32 v38, 64
    s_lshl_b32 s45, s32, 16
    s_add_u32 s45, s45, 1
    s_cmp_eq_u32 s30, 0
    s_cselect_b32 s45, s45, 0
    v_mov_b32 v39, s45
    s_mov_b64 exec, 1
    global_atomic_add v38, v39, s[28:29]
    s_mov_b64 exec, -1
    s_waitcnt vmcnt(17)
    s_barrier
    v_xor_b32 v51, 0, v45
    v_add_u32 v51, 65536, v51
    ds_read_b64_tr_b16 v[64:65], v51 offset:0
    ds_read_b64_tr_b16 v[66:67], v51 offset:2048
    ds_read_b64_tr_b16 v[68:69], v51 offset:8192
    ds_read_b64_tr_b16 v[70:71], v51 offset:10240
    s_waitcnt lgkmcnt(8)
    v_xor_b32 v51, 32, v45
    v_add_u32 v51, 65536, v51
    ds_read_b64_tr_b16 v[72:73], v51 offset:0
    ds_read_b64_tr_b16 v[74:75], v51 offset:2048
    ds_read_b64_tr_b16 v[76:77], v51 offset:8192
    ds_read_b64_tr_b16 v[78:79], v51 offset:10240
    s_waitcnt lgkmcnt(8)
    v_xor_b32 v51, 64, v45
    v_add_u32 v51, 65536, v51
    ds_read_b64_tr_b16 v[80:81], v51 offset:0
    ds_read_b64_tr_b16 v[82:83], v51 offset:2048
    ds_read_b64_tr_b16 v[84:85], v51 offset:8192
    ds_read_b64_tr_b16 v[86:87], v51 offset:10240
    s_waitcnt lgkmcnt(8)
    v_xor_b32 v51, 96, v45
    v_add_u32 v51, 65536, v51
    ds_read_b64_tr_b16 v[88:89], v51 offset:0
    ds_read_b64_tr_b16 v[90:91], v51 offset:2048
    ds_read_b64_tr_b16 v[92:93], v51 offset:8192
    ds_read_b64_tr_b16 v[94:95], v51 offset:10240
    s_waitcnt lgkmcnt(8)
    v_xor_b32 v51, 128, v45
    v_add_u32 v51, 65536, v51
    ds_read_b64_tr_b16 v[96:97], v51 offset:0
    ds_read_b64_tr_b16 v[98:99], v51 offset:2048
    ds_read_b64_tr_b16 v[100:101], v51 offset:8192
    ds_read_b64_tr_b16 v[102:103], v51 offset:10240
    s_waitcnt lgkmcnt(8)
    v_xor_b32 v51, 160, v45
    v_add_u32 v51, 65536, v51
    ds_read_b64_tr_b16 v[104:105], v51 offset:0
    ds_read_b64_tr_b16 v[106:107], v51 offset:2048
    ds_read_b64_tr_b16 v[108:109], v51 offset:8192
    ds_read_b64_tr_b16 v[110:111], v51 offset:10240
    s_waitcnt lgkmcnt(8)
    v_xor_b32 v51, 192, v45
    v_add_u32 v51, 65536, v51
    ds_read_b64_tr_b16 v[112:113], v51 offset:0
    ds_read_b64_tr_b16 v[114:115], v51 offset:2048
    ds_read_b64_tr_b16 v[116:117], v51 offset:8192
    ds_read_b64_tr_b16 v[118:119], v51 offset:10240
    s_waitcnt lgkmcnt(8)
    v_xor_b32 v51, 224, v45
    v_add_u32 v51, 65536, v51
    ds_read_b64_tr_b16 v[120:121], v51 offset:0
    ds_read_b64_tr_b16 v[122:123], v51 offset:2048
    ds_read_b64_tr_b16 v[124:125], v51 offset:8192
    ds_read_b64_tr_b16 v[126:127], v51 offset:10240
    s_waitcnt lgkmcnt(8)
    s_waitcnt lgkmcnt(0)
    s_barrier
    ds_write_b128 v10, v[64:67] offset:0
    ds_write_b128 v10, v[68:71] offset:1024
    ds_write_b128 v10, v[72:75] offset:2048
    ds_write_b128 v10, v[76:79] offset:3072
    ds_write_b128 v10, v[80:83] offset:4096
    ds_write_b128 v10, v[84:87] offset:5120
    ds_write_b128 v10, v[88:91] offset:6144
    ds_write_b128 v10, v[92:95] offset:7168
    ds_write_b128 v10, v[96:99] offset:8192
    ds_write_b128 v10, v[100:103] offset:9216
    ds_write_b128 v10, v[104:107] offset:10240
    ds_write_b128 v10, v[108:111] offset:11264
    ds_write_b128 v10, v[112:115] offset:12288
    ds_write_b128 v10, v[116:119] offset:13312
    ds_write_b128 v10, v[120:123] offset:14336
    ds_write_b128 v10, v[124:127] offset:15360
    s_waitcnt lgkmcnt(0)
    s_barrier
    v_add_u32 v51, 0, v43
    v_add_u32 v52, 0, v44
    s_cmp_lg_u32 s30, 0
    s_cbranch_scc1 CL_tq4_1
    ds_read_b64_tr_b16 v[64:65], v51 offset:0
    ds_read_b64_tr_b16 v[66:67], v51 offset:512
    ds_read_b64_tr_b16 v[68:69], v51 offset:2048
    ds_read_b64_tr_b16 v[70:71], v51 offset:2560
    ds_read_b64_tr_b16 v[80:81], v51 offset:16384
    ds_read_b64_tr_b16 v[82:83], v51 offset:16896
    ds_read_b64_tr_b16 v[84:85], v51 offset:18432
    ds_read_b64_tr_b16 v[86:87], v51 offset:18944
    s_waitcnt lgkmcnt(4)
    ds_read_b64_tr_b16 v[72:73], v52 offset:0
    ds_read_b64_tr_b16 v[74:75], v52 offset:512
    ds_read_b64_tr_b16 v[76:77], v52 offset:2048
    ds_read_b64_tr_b16 v[78:79], v52 offset:2560
    ds_read_b64_tr_b16 v[88:89], v52 offset:16384
    ds_read_b64_tr_b16 v[90:91], v52 offset:16896
    ds_read_b64_tr_b16 v[92:93], v52 offset:18432
    ds_read_b64_tr_b16 v[94:95], v52 offset:18944
    s_branch CL_tq4_e
CL_tq4_1:
    s_cmp_lg_u32 s30, 1
    s_cbranch_scc1 CL_tq4_2
    ds_read_b64_tr_b16 v[96:97], v51 offset:0
    ds_read_b64_tr_b16 v[98:99], v51 offset:512
    ds_read_b64_tr_b16 v[100:101], v51 offset:2048
    ds_read_b64_tr_b16 v[102:103], v51 offset:2560
    ds_read_b64_tr_b16 v[104:105], v51 offset:16384
    ds_read_b64_tr_b16 v[106:107], v51 offset:16896
    ds_read_b64_tr_b16 v[108:109], v51 offset:18432
    ds_read_b64_tr_b16 v[110:111], v51 offset:18944
    s_waitcnt lgkmcnt(4)
    ds_read_b64_tr_b16 v[112:113], v52 offset:0
    ds_read_b64_tr_b16 v[114:115], v52 offset:512
    ds_read_b64_tr_b16 v[116:117], v52 offset:2048
    ds_read_b64_tr_b16 v[118:119], v52 offset:2560
    ds_read_b64_tr_b16 v[120:121], v52 offset:16384
    ds_read_b64_tr_b16 v[122:123], v52 offset:16896
    ds_read_b64_tr_b16 v[124:125], v52 offset:18432
    ds_read_b64_tr_b16 v[126:127], v52 offset:18944
    s_branch CL_tq4_e
CL_tq4_2:
    s_cmp_lg_u32 s30, 2
    s_cbranch_scc1 CL_tq4_3
    ds_read_b64_tr_b16 v[128:129], v51 offset:0
    ds_read_b64_tr_b16 v[130:131], v51 offset:512
    ds_read_b64_tr_b16 v[132:133], v51 offset:2048
    ds_read_b64_tr_b16 v[134:135], v51 offset:2560
    ds_read_b64_tr_b16 v[136:137], v51 offset:16384
    ds_read_b64_tr_b16 v[138:139], v51 offset:16896
    ds_read_b64_tr_b16 v[140:141], v51 offset:18432
    ds_read_b64_tr_b16 v[142:143], v51 offset:18944
    s_waitcnt lgkmcnt(4)
    ds_read_b64_tr_b16 v[160:161], v52 offset:0
    ds_read_b64_tr_b16 v[162:163], v52 offset:512
    ds_read_b64_tr_b16 v[164:165], v52 offset:2048
    ds_read_b64_tr_b16 v[166:167], v52 offset:2560
    ds_read_b64_tr_b16 v[168:169], v52 offset:16384
    ds_read_b64_tr_b16 v[170:171], v52 offset:16896
    ds_read_b64_tr_b16 v[172:173], v52 offset:18432
    ds_read_b64_tr_b16 v[174:175], v52 offset:18944
    s_branch CL_tq4_e
CL_tq4_3:
    ds_read_b64_tr_b16 v[144:145], v51 offset:0
    ds_read_b64_tr_b16 v[146:147], v51 offset:512
    ds_read_b64_tr_b16 v[148:149], v51 offset:2048
    ds_read_b64_tr_b16 v[150:151], v51 offset:2560
    ds_read_b64_tr_b16 v[152:153], v51 offset:16384
    ds_read_b64_tr_b16 v[154:155], v51 offset:16896
    ds_read_b64_tr_b16 v[156:157], v51 offset:18432
    ds_read_b64_tr_b16 v[158:159], v51 offset:18944
    s_waitcnt lgkmcnt(4)
    ds_read_b64_tr_b16 v[176:177], v52 offset:0
    ds_read_b64_tr_b16 v[178:179], v52 offset:512
    ds_read_b64_tr_b16 v[180:181], v52 offset:2048
    ds_read_b64_tr_b16 v[182:183], v52 offset:2560
    ds_read_b64_tr_b16 v[184:185], v52 offset:16384
    ds_read_b64_tr_b16 v[186:187], v52 offset:16896
    ds_read_b64_tr_b16 v[188:189], v52 offset:18432
    ds_read_b64_tr_b16 v[190:191], v52 offset:18944
CL_tq4_e:
    s_waitcnt lgkmcnt(0)
    s_barrier
    s_lshl_b32 s45, s30, 12
    s_add_u32 m0, s45, 0
    s_mov_b32 s47, 2097152
    buffer_load_dwordx4 v40, s[16:19], s47 offen lds
    s_add_u32 m0, s45, 1024
    s_mov_b32 s47, 2129920
    buffer_load_dwordx4 v40, s[16:19], s47 offen lds
    s_add_u32 m0, s45, 2048
    s_mov_b32 s47, 2162688
    buffer_load_dwordx4 v40, s[16:19], s47 offen lds
    s_add_u32 m0, s45, 3072
    s_mov_b32 s47, 2195456
    buffer_load_dwordx4 v40, s[16:19], s47 offen lds
    s_add_u32 m0, s45, 16384
    s_mov_b32 s47, 2621440
    buffer_load_dwordx4 v40, s[16:19], s47 offen lds
    s_add_u32 m0, s45, 17408
    s_mov_b32 s47, 2654208
    buffer_load_dwordx4 v40, s[16:19], s47 offen lds
    s_add_u32 m0, s45, 18432
    s_mov_b32 s47, 2686976
    buffer_load_dwordx4 v40, s[16:19], s47 offen lds
    s_add_u32 m0, s45, 19456
    s_mov_b32 s47, 2719744
    buffer_load_dwordx4 v40, s[16:19], s47 offen lds
    s_waitcnt vmcnt(17)
    s_barrier
    v_add_u32 v51, 32768, v43
    v_add_u32 v52, 32768, v44
    s_cmp_lg_u32 s30, 0
    s_cbranch_scc1 CL_tq5_1
    ds_read_b64_tr_b16 v[96:97], v51 offset:0
    ds_read_b64_tr_b16 v[98:99], v51 offset:512
    ds_read_b64_tr_b16 v[100:101], v51 offset:2048
    ds_read_b64_tr_b16 v[102:103], v51 offset:2560
    ds_read_b64_tr_b16 v[104:105], v51 offset:16384
    ds_read_b64_tr_b16 v[106:107], v51 offset:16896
    ds_read_b64_tr_b16 v[108:109], v51 offset:18432
    ds_read_b64_tr_b16 v[110:111], v51 offset:18944
    s_waitcnt lgkmcnt(4)
    ds_read_b64_tr_b16 v[112:113], v52 offset:0
    ds_read_b64_tr_b16 v[114:115], v52 offset:512
    ds_read_b64_tr_b16 v[116:117], v52 offset:2048
    ds_read_b64_tr_b16 v[118:119], v52 offset:2560
    ds_read_b64_tr_b16 v[120:121], v52 offset:16384
    ds_read_b64_tr_b16 v[122:123], v52 offset:16896
    ds_read_b64_tr_b16 v[124:125], v52 offset:18432
    ds_read_b64_tr_b16 v[126:127], v52 offset:18944
    s_branch CL_tq5_e
CL_tq5_1:
    s_cmp_lg_u32 s30, 1
    s_cbranch_scc1 CL_tq5_2
    ds_read_b64_tr_b16 v[64:65], v51 offset:0
    ds_read_b64_tr_b16 v[66:67], v51 offset:512
    ds_read_b64_tr_b16 v[68:69], v51 offset:2048
    ds_read_b64_tr_b16 v[70:71], v51 offset:2560
    ds_read_b64_tr_b16 v[80:81], v51 offset:16384
    ds_read_b64_tr_b16 v[82:83], v51 offset:16896
    ds_read_b64_tr_b16 v[84:85], v51 offset:18432
    ds_read_b64_tr_b16 v[86:87], v51 offset:18944
    s_waitcnt lgkmcnt(4)
    ds_read_b64_tr_b16 v[72:73], v52 offset:0
    ds_read_b64_tr_b16 v[74:75], v52 offset:512
    ds_read_b64_tr_b16 v[76:77], v52 offset:2048
    ds_read_b64_tr_b16 v[78:79], v52 offset:2560
    ds_read_b64_tr_b16 v[88:89], v52 offset:16384
    ds_read_b64_tr_b16 v[90:91], v52 offset:16896
    ds_read_b64_tr_b16 v[92:93], v52 offset:18432
    ds_read_b64_tr_b16 v[94:95], v52 offset:18944
    s_branch CL_tq5_e
CL_tq5_2:
    s_cmp_lg_u32 s30, 2
    s_cbranch_scc1 CL_tq5_3
    ds_read_b64_tr_b16 v[144:145], v51 offset:0
    ds_read_b64_tr_b16 v[146:147], v51 offset:512
    ds_read_b64_tr_b16 v[148:149], v51 offset:2048
    ds_read_b64_tr_b16 v[150:151], v51 offset:2560
    ds_read_b64_tr_b16 v[152:153], v51 offset:16384
    ds_read_b64_tr_b16 v[154:155], v51 offset:16896
    ds_read_b64_tr_b16 v[156:157], v51 offset:18432
    ds_read_b64_tr_b16 v[158:159], v51 offset:18944
    s_waitcnt lgkmcnt(4)
    ds_read_b64_tr_b16 v[176:177], v52 offset:0
    ds_read_b64_tr_b16 v[178:179], v52 offset:512
    ds_read_b64_tr_b16 v[180:181], v52 offset:2048
    ds_read_b64_tr_b16 v[182:183], v52 offset:2560
    ds_read_b64_tr_b16 v[184:185], v52 offset:16384
    ds_read_b64_tr_b16 v[186:187], v52 offset:16896
    ds_read_b64_tr_b16 v[188:189], v52 offset:18432
    ds_read_b64_tr_b16 v[190:191], v52 offset:18944
    s_branch CL_tq5_e
CL_tq5_3:
    ds_read_b64_tr_b16 v[128:129], v51 offset:0
    ds_read_b64_tr_b16 v[130:131], v51 offset:512
    ds_read_b64_tr_b16 v[132:133], v51 offset:2048
    ds_read_b64_tr_b16 v[134:135], v51 offset:2560
    ds_read_b64_tr_b16 v[136:137], v51 offset:16384
    ds_read_b64_tr_b16 v[138:139], v51 offset:16896
    ds_read_b64_tr_b16 v[140:141], v51 offset:18432
    ds_read_b64_tr_b16 v[142:143], v51 offset:18944
    s_waitcnt lgkmcnt(4)
    ds_read_b64_tr_b16 v[160:161], v52 offset:0
    ds_read_b64_tr_b16 v[162:163], v52 offset:512
    ds_read_b64_tr_b16 v[164:165], v52 offset:2048
    ds_read_b64_tr_b16 v[166:167], v52 offset:2560
    ds_read_b64_tr_b16 v[168:169], v52 offset:16384
    ds_read_b64_tr_b16 v[170:171], v52 offset:16896
    ds_read_b64_tr_b16 v[172:173], v52 offset:18432
    ds_read_b64_tr_b16 v[174:175], v52 offset:18944
CL_tq5_e:
    s_waitcnt lgkmcnt(0)
    s_barrier
    v_mov_b32 v46, 192
    global_load_dword v47, v46, s[28:29] sc1
    s_lshl_b32 s45, s30, 12
    s_add_u32 m0, s45, 32768
    s_mov_b32 s47, 2097152
    buffer_load_dwordx4 v40, s[8:11], s47 offen lds
    s_add_u32 m0, s45, 33792
    s_mov_b32 s47, 2129920
    buffer_load_dwordx4 v40, s[8:11], s47 offen lds
    s_add_u32 m0, s45, 34816
    s_mov_b32 s47, 2162688
    buffer_load_dwordx4 v40, s[8:11], s47 offen lds
    s_add_u32 m0, s45, 35840
    s_mov_b32 s47, 2195456
    buffer_load_dwordx4 v40, s[8:11], s47 offen lds
    s_add_u32 m0, s45, 49152
    s_mov_b32 s47, 2621440
    buffer_load_dwordx4 v40, s[8:11], s47 offen lds
    s_add_u32 m0, s45, 50176
    s_mov_b32 s47, 2654208
    buffer_load_dwordx4 v40, s[8:11], s47 offen lds
    s_add_u32 m0, s45, 51200
    s_mov_b32 s47, 2686976
    buffer_load_dwordx4 v40, s[8:11], s47 offen lds
    s_add_u32 m0, s45, 52224
    s_mov_b32 s47, 2719744
    buffer_load_dwordx4 v40, s[8:11], s47 offen lds
    s_waitcnt vmcnt(18)
    s_barrier
    v_add_u32 v51, 131072, v43
    v_add_u32 v52, 131072, v44
    s_cmp_lg_u32 s30, 0
    s_cbranch_scc1 CL_tq6_1
    ds_read_b64_tr_b16 a[32:33], v51 offset:0
    ds_read_b64_tr_b16 a[34:35], v51 offset:512
    ds_read_b64_tr_b16 a[36:37], v51 offset:2048
    ds_read_b64_tr_b16 a[38:39], v51 offset:2560
    ds_read_b64_tr_b16 a[40:41], v51 offset:16384
    ds_read_b64_tr_b16 a[42:43], v51 offset:16896
    ds_read_b64_tr_b16 a[44:45], v51 offset:18432
    ds_read_b64_tr_b16 a[46:47], v51 offset:18944
    s_waitcnt lgkmcnt(4)
    ds_read_b64_tr_b16 a[96:97], v52 offset:0
    ds_read_b64_tr_b16 a[98:99], v52 offset:512
    ds_read_b64_tr_b16 a[100:101], v52 offset:2048
    ds_read_b64_tr_b16 a[102:103], v52 offset:2560
    ds_read_b64_tr_b16 a[104:105], v52 offset:16384
    ds_read_b64_tr_b16 a[106:107], v52 offset:16896
    ds_read_b64_tr_b16 a[108:109], v52 offset:18432
    ds_read_b64_tr_b16 a[110:111], v52 offset:18944
    s_branch CL_tq6_e
CL_tq6_1:
    s_cmp_lg_u32 s30, 1
    s_cbranch_scc1 CL_tq6_2
    ds_read_b64_tr_b16 a[48:49], v51 offset:0
    ds_read_b64_tr_b16 a[50:51], v51 offset:512
    ds_read_b64_tr_b16 a[52:53], v51 offset:2048
    ds_read_b64_tr_b16 a[54:55], v51 offset:2560
    ds_read_b64_tr_b16 a[56:57], v51 offset:16384
    ds_read_b64_tr_b16 a[58:59], v51 offset:16896
    ds_read_b64_tr_b16 a[60:61], v51 offset:18432
    ds_read_b64_tr_b16 a[62:63], v51 offset:18944
    s_waitcnt lgkmcnt(4)
    ds_read_b64_tr_b16 a[112:113], v52 offset:0
    ds_read_b64_tr_b16 a[114:115], v52 offset:512
    ds_read_b64_tr_b16 a[116:117], v52 offset:2048
    ds_read_b64_tr_b16 a[118:119], v52 offset:2560
    ds_read_b64_tr_b16 a[120:121], v52 offset:16384
    ds_read_b64_tr_b16 a[122:123], v52 offset:16896
    ds_read_b64_tr_b16 a[124:125], v52 offset:18432
    ds_read_b64_tr_b16 a[126:127], v52 offset:18944
    s_branch CL_tq6_e
CL_tq6_2:
    s_cmp_lg_u32 s30, 2
    s_cbranch_scc1 CL_tq6_3
    ds_read_b64_tr_b16 a[0:1], v51 offset:0
    ds_read_b64_tr_b16 a[2:3], v51 offset:512
    ds_read_b64_tr_b16 a[4:5], v51 offset:2048
    ds_read_b64_tr_b16 a[6:7], v51 offset:2560
    ds_read_b64_tr_b16 a[8:9], v51 offset:16384
    ds_read_b64_tr_b16 a[10:11], v51 offset:16896
    ds_read_b64_tr_b16 a[12:13], v51 offset:18432
    ds_read_b64_tr_b16 a[14:15], v51 offset:18944
    s_waitcnt lgkmcnt(4)
    ds_read_b64_tr_b16 a[64:65], v52 offset:0
    ds_read_b64_tr_b16 a[66:67], v52 offset:512
    ds_read_b64_tr_b16 a[68:69], v52 offset:2048
    ds_read_b64_tr_b16 a[70:71], v52 offset:2560
    ds_read_b64_tr_b16 a[72:73], v52 offset:16384
    ds_read_b64_tr_b16 a[74:75], v52 offset:16896
    ds_read_b64_tr_b16 a[76:77], v52 offset:18432
    ds_read_b64_tr_b16 a[78:79], v52 offset:18944
    s_branch CL_tq6_e
CL_tq6_3:
    ds_read_b64_tr_b16 a[16:17], v51 offset:0
    ds_read_b64_tr_b16 a[18:19], v51 offset:512
    ds_read_b64_tr_b16 a[20:21], v51 offset:2048
    ds_read_b64_tr_b16 a[22:23], v51 offset:2560
    ds_read_b64_tr_b16 a[24:25], v51 offset:16384
    ds_read_b64_tr_b16 a[26:27], v51 offset:16896
    ds_read_b64_tr_b16 a[28:29], v51 offset:18432
    ds_read_b64_tr_b16 a[30:31], v51 offset:18944
    s_waitcnt lgkmcnt(4)
    ds_read_b64_tr_b16 a[80:81], v52 offset:0
    ds_read_b64_tr_b16 a[82:83], v52 offset:512
    ds_read_b64_tr_b16 a[84:85], v52 offset:2048
    ds_read_b64_tr_b16 a[86:87], v52 offset:2560
    ds_read_b64_tr_b16 a[88:89], v52 offset:16384
    ds_read_b64_tr_b16 a[90:91], v52 offset:16896
    ds_read_b64_tr_b16 a[92:93], v52 offset:18432
    ds_read_b64_tr_b16 a[94:95], v52 offset:18944
CL_tq6_e:
    s_waitcnt lgkmcnt(0)
    s_barrier
    s_lshl_b32 s45, s30, 12
    s_add_u32 m0, s45, 131072
    s_mov_b32 s47, 3145728
    buffer_load_dwordx4 v40, s[12:15], s47 offen lds
    s_add_u32 m0, s45, 132096
    s_mov_b32 s47, 3178496
    buffer_load_dwordx4 v40, s[12:15], s47 offen lds
    s_add_u32 m0, s45, 133120
    s_mov_b32 s47, 3211264
    buffer_load_dwordx4 v40, s[12:15], s47 offen lds
    s_add_u32 m0, s45, 134144
    s_mov_b32 s47, 3244032
    buffer_load_dwordx4 v40, s[12:15], s47 offen lds
    s_add_u32 m0, s45, 147456
    s_mov_b32 s47, 3670016
    buffer_load_dwordx4 v40, s[12:15], s47 offen lds
    s_add_u32 m0, s45, 148480
    s_mov_b32 s47, 3702784
    buffer_load_dwordx4 v40, s[12:15], s47 offen lds
    s_add_u32 m0, s45, 149504
    s_mov_b32 s47, 3735552
    buffer_load_dwordx4 v40, s[12:15], s47 offen lds
    s_add_u32 m0, s45, 150528
    s_mov_b32 s47, 3768320
    buffer_load_dwordx4 v40, s[12:15], s47 offen lds
    s_waitcnt vmcnt(17)
    s_barrier
    v_add_u32 v51, 0, v43
    v_add_u32 v52, 0, v44
    s_cmp_lg_u32 s30, 0
    s_cbranch_scc1 CL_tq7_1
    ds_read_b64_tr_b16 a[160:161], v51 offset:0
    ds_read_b64_tr_b16 a[162:163], v51 offset:512
    ds_read_b64_tr_b16 a[164:165], v51 offset:2048
    ds_read_b64_tr_b16 a[166:167], v51 offset:2560
    ds_read_b64_tr_b16 a[168:169], v51 offset:16384
    ds_read_b64_tr_b16 a[170:171], v51 offset:16896
    ds_read_b64_tr_b16 a[172:173], v51 offset:18432
    ds_read_b64_tr_b16 a[174:175], v51 offset:18944
    s_waitcnt lgkmcnt(4)
    ds_read_b64_tr_b16 a[224:225], v52 offset:0
    ds_read_b64_tr_b16 a[226:227], v52 offset:512
    ds_read_b64_tr_b16 a[228:229], v52 offset:2048
    ds_read_b64_tr_b16 a[230:231], v52 offset:2560
    ds_read_b64_tr_b16 a[232:233], v52 offset:16384
    ds_read_b64_tr_b16 a[234:235], v52 offset:16896
    ds_read_b64_tr_b16 a[236:237], v52 offset:18432
    ds_read_b64_tr_b16 a[238:239], v52 offset:18944
    s_branch CL_tq7_e
CL_tq7_1:
    s_cmp_lg_u32 s30, 1
    s_cbranch_scc1 CL_tq7_2
    ds_read_b64_tr_b16 a[176:177], v51 offset:0
    ds_read_b64_tr_b16 a[178:179], v51 offset:512
    ds_read_b64_tr_b16 a[180:181], v51 offset:2048
    ds_read_b64_tr_b16 a[182:183], v51 offset:2560
    ds_read_b64_tr_b16 a[184:185], v51 offset:16384
    ds_read_b64_tr_b16 a[186:187], v51 offset:16896
    ds_read_b64_tr_b16 a[188:189], v51 offset:18432
    ds_read_b64_tr_b16 a[190:191], v51 offset:18944
    s_waitcnt lgkmcnt(4)
    ds_read_b64_tr_b16 a[240:241], v52 offset:0
    ds_read_b64_tr_b16 a[242:243], v52 offset:512
    ds_read_b64_tr_b16 a[244:245], v52 offset:2048
    ds_read_b64_tr_b16 a[246:247], v52 offset:2560
    ds_read_b64_tr_b16 a[248:249], v52 offset:16384
    ds_read_b64_tr_b16 a[250:251], v52 offset:16896
    ds_read_b64_tr_b16 a[252:253], v52 offset:18432
    ds_read_b64_tr_b16 a[254:255], v52 offset:18944
    s_branch CL_tq7_e
CL_tq7_2:
    s_cmp_lg_u32 s30, 2
    s_cbranch_scc1 CL_tq7_3
    ds_read_b64_tr_b16 a[128:129], v51 offset:0
    ds_read_b64_tr_b16 a[130:131], v51 offset:512
    ds_read_b64_tr_b16 a[132:133], v51 offset:2048
    ds_read_b64_tr_b16 a[134:135], v51 offset:2560
    ds_read_b64_tr_b16 a[136:137], v51 offset:16384
    ds_read_b64_tr_b16 a[138:139], v51 offset:16896
    ds_read_b64_tr_b16 a[140:141], v51 offset:18432
    ds_read_b64_tr_b16 a[142:143], v51 offset:18944
    s_waitcnt lgkmcnt(4)
    ds_read_b64_tr_b16 a[192:193], v52 offset:0
    ds_read_b64_tr_b16 a[194:195], v52 offset:512
    ds_read_b64_tr_b16 a[196:197], v52 offset:2048
    ds_read_b64_tr_b16 a[198:199], v52 offset:2560
    ds_read_b64_tr_b16 a[200:201], v52 offset:16384
    ds_read_b64_tr_b16 a[202:203], v52 offset:16896
    ds_read_b64_tr_b16 a[204:205], v52 offset:18432
    ds_read_b64_tr_b16 a[206:207], v52 offset:18944
    s_branch CL_tq7_e
CL_tq7_3:
    ds_read_b64_tr_b16 a[144:145], v51 offset:0
    ds_read_b64_tr_b16 a[146:147], v51 offset:512
    ds_read_b64_tr_b16 a[148:149], v51 offset:2048
    ds_read_b64_tr_b16 a[150:151], v51 offset:2560
    ds_read_b64_tr_b16 a[152:153], v51 offset:16384
    ds_read_b64_tr_b16 a[154:155], v51 offset:16896
    ds_read_b64_tr_b16 a[156:157], v51 offset:18432
    ds_read_b64_tr_b16 a[158:159], v51 offset:18944
    s_waitcnt lgkmcnt(4)
    ds_read_b64_tr_b16 a[208:209], v52 offset:0
    ds_read_b64_tr_b16 a[210:211], v52 offset:512
    ds_read_b64_tr_b16 a[212:213], v52 offset:2048
    ds_read_b64_tr_b16 a[214:215], v52 offset:2560
    ds_read_b64_tr_b16 a[216:217], v52 offset:16384
    ds_read_b64_tr_b16 a[218:219], v52 offset:16896
    ds_read_b64_tr_b16 a[220:221], v52 offset:18432
    ds_read_b64_tr_b16 a[222:223], v52 offset:18944
CL_tq7_e:
    s_waitcnt lgkmcnt(0)
    s_barrier
    s_lshl_b32 s45, s30, 12
    s_add_u32 m0, s45, 0
    s_mov_b32 s47, 3145728
    buffer_load_dwordx4 v40, s[16:19], s47 offen lds
    s_add_u32 m0, s45, 1024
    s_mov_b32 s47, 3178496
    buffer_load_dwordx4 v40, s[16:19], s47 offen lds
    s_add_u32 m0, s45, 2048
    s_mov_b32 s47, 3211264
    buffer_load_dwordx4 v40, s[16:19], s47 offen lds
    s_add_u32 m0, s45, 3072
    s_mov_b32 s47, 3244032
    buffer_load_dwordx4 v40, s[16:19], s47 offen lds
    s_add_u32 m0, s45, 16384
    s_mov_b32 s47, 3670016
    buffer_load_dwordx4 v40, s[16:19], s47 offen lds
    s_add_u32 m0, s45, 17408
    s_mov_b32 s47, 3702784
    buffer_load_dwordx4 v40, s[16:19], s47 offen lds
    s_add_u32 m0, s45, 18432
    s_mov_b32 s47, 3735552
    buffer_load_dwordx4 v40, s[16:19], s47 offen lds
    s_add_u32 m0, s45, 19456
    s_mov_b32 s47, 3768320
    buffer_load_dwordx4 v40, s[16:19], s47 offen lds
    s_waitcnt vmcnt(16)
    s_barrier
    v_add_u32 v51, 32768, v43
    v_add_u32 v52, 32768, v44
    s_cmp_lg_u32 s30, 0
    s_cbranch_scc1 CL_tq8_1
    ds_read_b64_tr_b16 v[128:129], v51 offset:0
    ds_read_b64_tr_b16 v[130:131], v51 offset:512
    ds_read_b64_tr_b16 v[132:133], v51 offset:2048
    ds_read_b64_tr_b16 v[134:135], v51 offset:2560
    ds_read_b64_tr_b16 v[136:137], v51 offset:16384
    ds_read_b64_tr_b16 v[138:139], v51 offset:16896
    ds_read_b64_tr_b16 v[140:141], v51 offset:18432
    ds_read_b64_tr_b16 v[142:143], v51 offset:18944
    s_waitcnt lgkmcnt(4)
    ds_read_b64_tr_b16 v[160:161], v52 offset:0
    ds_read_b64_tr_b16 v[162:163], v52 offset:512
    ds_read_b64_tr_b16 v[164:165], v52 offset:2048
    ds_read_b64_tr_b16 v[166:167], v52 offset:2560
    ds_read_b64_tr_b16 v[168:169], v52 offset:16384
    ds_read_b64_tr_b16 v[170:171], v52 offset:16896
    ds_read_b64_tr_b16 v[172:173], v52 offset:18432
    ds_read_b64_tr_b16 v[174:175], v52 offset:18944
    s_branch CL_tq8_e
CL_tq8_1:
    s_cmp_lg_u32 s30, 1
    s_cbranch_scc1 CL_tq8_2
    ds_read_b64_tr_b16 v[144:145], v51 offset:0
    ds_read_b64_tr_b16 v[146:147], v51 offset:512
    ds_read_b64_tr_b16 v[148:149], v51 offset:2048
    ds_read_b64_tr_b16 v[150:151], v51 offset:2560
    ds_read_b64_tr_b16 v[152:153], v51 offset:16384
    ds_read_b64_tr_b16 v[154:155], v51 offset:16896
    ds_read_b64_tr_b16 v[156:157], v51 offset:18432
    ds_read_b64_tr_b16 v[158:159], v51 offset:18944
    s_waitcnt lgkmcnt(4)
    ds_read_b64_tr_b16 v[176:177], v52 offset:0
    ds_read_b64_tr_b16 v[178:179], v52 offset:512
    ds_read_b64_tr_b16 v[180:181], v52 offset:2048
    ds_read_b64_tr_b16 v[182:183], v52 offset:2560
    ds_read_b64_tr_b16 v[184:185], v52 offset:16384
    ds_read_b64_tr_b16 v[186:187], v52 offset:16896
    ds_read_b64_tr_b16 v[188:189], v52 offset:18432
    ds_read_b64_tr_b16 v[190:191], v52 offset:18944
    s_branch CL_tq8_e
CL_tq8_2:
    s_cmp_lg_u32 s30, 2
    s_cbranch_scc1 CL_tq8_3
    ds_read_b64_tr_b16 v[64:65], v51 offset:0
    ds_read_b64_tr_b16 v[66:67], v51 offset:512
    ds_read_b64_tr_b16 v[68:69], v51 offset:2048
    ds_read_b64_tr_b16 v[70:71], v51 offset:2560
    ds_read_b64_tr_b16 v[80:81], v51 offset:16384
    ds_read_b64_tr_b16 v[82:83], v51 offset:16896
    ds_read_b64_tr_b16 v[84:85], v51 offset:18432
    ds_read_b64_tr_b16 v[86:87], v51 offset:18944
    s_waitcnt lgkmcnt(4)
    ds_read_b64_tr_b16 v[72:73], v52 offset:0
    ds_read_b64_tr_b16 v[74:75], v52 offset:512
    ds_read_b64_tr_b16 v[76:77], v52 offset:2048
    ds_read_b64_tr_b16 v[78:79], v52 offset:2560
    ds_read_b64_tr_b16 v[88:89], v52 offset:16384
    ds_read_b64_tr_b16 v[90:91], v52 offset:16896
    ds_read_b64_tr_b16 v[92:93], v52 offset:18432
    ds_read_b64_tr_b16 v[94:95], v52 offset:18944
    s_branch CL_tq8_e
CL_tq8_3:
    ds_read_b64_tr_b16 v[96:97], v51 offset:0
    ds_read_b64_tr_b16 v[98:99], v51 offset:512
    ds_read_b64_tr_b16 v[100:101], v51 offset:2048
    ds_read_b64_tr_b16 v[102:103], v51 offset:2560
    ds_read_b64_tr_b16 v[104:105], v51 offset:16384
    ds_read_b64_tr_b16 v[106:107], v51 offset:16896
    ds_read_b64_tr_b16 v[108:109], v51 offset:18432
    ds_read_b64_tr_b16 v[110:111], v51 offset:18944
    s_waitcnt lgkmcnt(4)
    ds_read_b64_tr_b16 v[112:113], v52 offset:0
    ds_read_b64_tr_b16 v[114:115], v52 offset:512
    ds_read_b64_tr_b16 v[116:117], v52 offset:2048
    ds_read_b64_tr_b16 v[118:119], v52 offset:2560
    ds_read_b64_tr_b16 v[120:121], v52 offset:16384
    ds_read_b64_tr_b16 v[122:123], v52 offset:16896
    ds_read_b64_tr_b16 v[124:125], v52 offset:18432
    ds_read_b64_tr_b16 v[126:127], v52 offset:18944
CL_tq8_e:
    s_waitcnt lgkmcnt(0)
    s_barrier
    v_mov_b32 v46, 64
    s_lshl_b32 s45, s31, 6
    s_add_u32 s84, s45, 1835008
    global_load_dword v48, v46, s[28:29] sc1
    buffer_load_dwordx4 v[36:39], off, s[4:7], s84 sc1
    s_lshl_b32 s45, s30, 12
    s_add_u32 m0, s45, 32768
    s_mov_b32 s47, 3145728
    buffer_load_dwordx4 v40, s[8:11], s47 offen lds
    s_add_u32 m0, s45, 33792
    s_mov_b32 s47, 3178496
    buffer_load_dwordx4 v40, s[8:11], s47 offen lds
    s_add_u32 m0, s45, 34816
    s_mov_b32 s47, 3211264
    buffer_load_dwordx4 v40, s[8:11], s47 offen lds
    s_add_u32 m0, s45, 35840
    s_mov_b32 s47, 3244032
    buffer_load_dwordx4 v40, s[8:11], s47 offen lds
    s_add_u32 m0, s45, 49152
    s_mov_b32 s47, 3670016
    buffer_load_dwordx4 v40, s[8:11], s47 offen lds
    s_add_u32 m0, s45, 50176
    s_mov_b32 s47, 3702784
    buffer_load_dwordx4 v40, s[8:11], s47 offen lds
    s_add_u32 m0, s45, 51200
    s_mov_b32 s47, 3735552
    buffer_load_dwordx4 v40, s[8:11], s47 offen lds
    s_add_u32 m0, s45, 52224
    s_mov_b32 s47, 3768320
    buffer_load_dwordx4 v40, s[8:11], s47 offen lds
    s_waitcnt vmcnt(18)
    s_barrier
    v_add_u32 v51, 131072, v43
    v_add_u32 v52, 131072, v44
    s_cmp_lg_u32 s30, 0
    s_cbranch_scc1 CL_tq9_1
    ds_read_b64_tr_b16 a[48:49], v51 offset:0
    ds_read_b64_tr_b16 a[50:51], v51 offset:512
    ds_read_b64_tr_b16 a[52:53], v51 offset:2048
    ds_read_b64_tr_b16 a[54:55], v51 offset:2560
    ds_read_b64_tr_b16 a[56:57], v51 offset:16384
    ds_read_b64_tr_b16 a[58:59], v51 offset:16896
    ds_read_b64_tr_b16 a[60:61], v51 offset:18432
    ds_read_b64_tr_b16 a[62:63], v51 offset:18944
    s_waitcnt lgkmcnt(4)
    ds_read_b64_tr_b16 a[112:113], v52 offset:0
    ds_read_b64_tr_b16 a[114:115], v52 offset:512
    ds_read_b64_tr_b16 a[116:117], v52 offset:2048
    ds_read_b64_tr_b16 a[118:119], v52 offset:2560
    ds_read_b64_tr_b16 a[120:121], v52 offset:16384
    ds_read_b64_tr_b16 a[122:123], v52 offset:16896
    ds_read_b64_tr_b16 a[124:125], v52 offset:18432
    ds_read_b64_tr_b16 a[126:127], v52 offset:18944
    s_branch CL_tq9_e
CL_tq9_1:
    s_cmp_lg_u32 s30, 1
    s_cbranch_scc1 CL_tq9_2
    ds_read_b64_tr_b16 a[32:33], v51 offset:0
    ds_read_b64_tr_b16 a[34:35], v51 offset:512
    ds_read_b64_tr_b16 a[36:37], v51 offset:2048
    ds_read_b64_tr_b16 a[38:39], v51 offset:2560
    ds_read_b64_tr_b16 a[40:41], v51 offset:16384
    ds_read_b64_tr_b16 a[42:43], v51 offset:16896
    ds_read_b64_tr_b16 a[44:45], v51 offset:18432
    ds_read_b64_tr_b16 a[46:47], v51 offset:18944
    s_waitcnt lgkmcnt(4)
    ds_read_b64_tr_b16 a[96:97], v52 offset:0
    ds_read_b64_tr_b16 a[98:99], v52 offset:512
    ds_read_b64_tr_b16 a[100:101], v52 offset:2048
    ds_read_b64_tr_b16 a[102:103], v52 offset:2560
    ds_read_b64_tr_b16 a[104:105], v52 offset:16384
    ds_read_b64_tr_b16 a[106:107], v52 offset:16896
    ds_read_b64_tr_b16 a[108:109], v52 offset:18432
    ds_read_b64_tr_b16 a[110:111], v52 offset:18944
    s_branch CL_tq9_e
CL_tq9_2:
    s_cmp_lg_u32 s30, 2
    s_cbranch_scc1 CL_tq9_3
    ds_read_b64_tr_b16 a[16:17], v51 offset:0
    ds_read_b64_tr_b16 a[18:19], v51 offset:512
    ds_read_b64_tr_b16 a[20:21], v51 offset:2048
    ds_read_b64_tr_b16 a[22:23], v51 offset:2560
    ds_read_b64_tr_b16 a[24:25], v51 offset:16384
    ds_read_b64_tr_b16 a[26:27], v51 offset:16896
    ds_read_b64_tr_b16 a[28:29], v51 offset:18432
    ds_read_b64_tr_b16 a[30:31], v51 offset:18944
    s_waitcnt lgkmcnt(4)
    ds_read_b64_tr_b16 a[80:81], v52 offset:0
    ds_read_b64_tr_b16 a[82:83], v52 offset:512
    ds_read_b64_tr_b16 a[84:85], v52 offset:2048
    ds_read_b64_tr_b16 a[86:87], v52 offset:2560
    ds_read_b64_tr_b16 a[88:89], v52 offset:16384
    ds_read_b64_tr_b16 a[90:91], v52 offset:16896
    ds_read_b64_tr_b16 a[92:93], v52 offset:18432
    ds_read_b64_tr_b16 a[94:95], v52 offset:18944
    s_branch CL_tq9_e
CL_tq9_3:
    ds_read_b64_tr_b16 a[0:1], v51 offset:0
    ds_read_b64_tr_b16 a[2:3], v51 offset:512
    ds_read_b64_tr_b16 a[4:5], v51 offset:2048
    ds_read_b64_tr_b16 a[6:7], v51 offset:2560
    ds_read_b64_tr_b16 a[8:9], v51 offset:16384
    ds_read_b64_tr_b16 a[10:11], v51 offset:16896
    ds_read_b64_tr_b16 a[12:13], v51 offset:18432
    ds_read_b64_tr_b16 a[14:15], v51 offset:18944
    s_waitcnt lgkmcnt(4)
    ds_read_b64_tr_b16 a[64:65], v52 offset:0
    ds_read_b64_tr_b16 a[66:67], v52 offset:512
    ds_read_b64_tr_b16 a[68:69], v52 offset:2048
    ds_read_b64_tr_b16 a[70:71], v52 offset:2560
    ds_read_b64_tr_b16 a[72:73], v52 offset:16384
    ds_read_b64_tr_b16 a[74:75], v52 offset:16896
    ds_read_b64_tr_b16 a[76:77], v52 offset:18432
    ds_read_b64_tr_b16 a[78:79], v52 offset:18944
CL_tq9_e:
    s_waitcnt lgkmcnt(0)
    s_barrier
    s_waitcnt vmcnt(8)
    v_min_u32 v36, v36, v37
    v_min3_u32 v36, v36, v38, v39
    v_readfirstlane_b32 s45, v48
    v_readfirstlane_b32 s46, v47
    v_readfirstlane_b32 s49, v36
    s_nop 1
    s_lshl_b32 s49, s49, 2
    s_cmp_eq_u32 s46, 0
    s_cselect_b32 s49, 0, s49
    s_cselect_b32 s47, 0, s45
    s_and_b32 s47, s47, 0xffff
    s_cmp_eq_u32 s47, 32
    s_cbranch_scc1 CL_arr_ok
    v_mov_b32 v38, 64
    v_mov_b32 v40, 192
    s_mov_b32 s43, 0
    s_nop 0
CL_arr:
    global_load_dword v39, v38, s[28:29] sc1
    global_load_dword v41, v40, s[28:29] sc1
    s_add_u32 s43, s43, 1
    s_cmp_gt_u32 s43, 2000000
    s_cbranch_scc1 L_end
    s_waitcnt vmcnt(0)
    v_readfirstlane_b32 s45, v39
    v_readfirstlane_b32 s46, v41
    s_nop 0
    s_and_b32 s47, s45, 0xffff
    s_cmp_lt_u32 s47, 32
    s_nop 0
    s_cbranch_scc1 CL_arr
    s_cmp_eq_u32 s46, 0
    s_cbranch_scc1 CL_arr
CL_arr_ok:
    s_lshr_b32 s32, s45, 16
    s_nop 0
    s_lshr_b32 s45, s31, 2
    s_lshl_b32 s45, s45, 7
    s_and_b32 s46, s31, 3
    s_lshl_b32 s46, s46, 2
    s_add_u32 s45, s45, s46
    s_add_u32 s45, s45, 1839104
    s_cmp_eq_u32 s30, 0
    s_cselect_b32 s85, s45, 268435456
    s_mov_b32 s33, -1
    s_add_u32 s45, s33, 3
    s_min_u32 s45, s45, 64
    s_cmp_ge_u32 s49, s45
    s_cbranch_scc0 CL_kvp
CL_kvbp:
    s_mov_b32 m0, s41
    s_nop 0
    buffer_load_dwordx4 v2, s[4:7], s38 offen sc1 lds
    buffer_load_dwordx4 v2, s[4:7], s38 offen offset:1024 sc1 lds
    buffer_load_dwordx4 v[16:19], v2, s[4:7], s39 offen sc1
    buffer_load_dwordx4 v[20:23], v2, s[4:7], s39 offen offset:1024 sc1
    s_mov_b32 s33, 0
    s_mov_b32 s83, 0
    s_mov_b32 s82, s84
    s_mov_b32 s35, 1572864
    s_mov_b32 s36, 1581056
    s_mov_b32 s37, 1589248
    s_barrier
    v_add_u32 v51, 0, v43
    v_add_u32 v52, 0, v44
    s_cmp_lg_u32 s30, 0
    s_cbranch_scc1 CL_tq10_1
    ds_read_b64_tr_b16 a[176:177], v51 offset:0
    ds_read_b64_tr_b16 a[178:179], v51 offset:512
    ds_read_b64_tr_b16 a[180:181], v51 offset:2048
    ds_read_b64_tr_b16 a[182:183], v51 offset:2560
    ds_read_b64_tr_b16 a[184:185], v51 offset:16384
    ds_read_b64_tr_b16 a[186:187], v51 offset:16896
    ds_read_b64_tr_b16 a[188:189], v51 offset:18432
    ds_read_b64_tr_b16 a[190:191], v51 offset:18944
    s_waitcnt lgkmcnt(4)
    ds_read_b64_tr_b16 a[240:241], v52 offset:0
    ds_read_b64_tr_b16 a[242:243], v52 offset:512
    ds_read_b64_tr_b16 a[244:245], v52 offset:2048
    ds_read_b64_tr_b16 a[246:247], v52 offset:2560
    ds_read_b64_tr_b16 a[248:249], v52 offset:16384
    ds_read_b64_tr_b16 a[250:251], v52 offset:16896
    ds_read_b64_tr_b16 a[252:253], v52 offset:18432
    ds_read_b64_tr_b16 a[254:255], v52 offset:18944
    s_branch CL_tq10_e
CL_tq10_1:
    s_cmp_lg_u32 s30, 1
    s_cbranch_scc1 CL_tq10_2
    ds_read_b64_tr_b16 a[160:161], v51 offset:0
    ds_read_b64_tr_b16 a[162:163], v51 offset:512
    ds_read_b64_tr_b16 a[164:165], v51 offset:2048
    ds_read_b64_tr_b16 a[166:167], v51 offset:2560
    ds_read_b64_tr_b16 a[168:169], v51 offset:16384
    ds_read_b64_tr_b16 a[170:171], v51 offset:16896
    ds_read_b64_tr_b16 a[172:173], v51 offset:18432
    ds_read_b64_tr_b16 a[174:175], v51 offset:18944
    s_waitcnt lgkmcnt(4)
    ds_read_b64_tr_b16 a[224:225], v52 offset:0
    ds_read_b64_tr_b16 a[226:227], v52 offset:512
    ds_read_b64_tr_b16 a[228:229], v52 offset:2048
    ds_read_b64_tr_b16 a[230:231], v52 offset:2560
    ds_read_b64_tr_b16 a[232:233], v52 offset:16384
    ds_read_b64_tr_b16 a[234:235], v52 offset:16896
    ds_read_b64_tr_b16 a[236:237], v52 offset:18432
    ds_read_b64_tr_b16 a[238:239], v52 offset:18944
    s_branch CL_tq10_e
CL_tq10_2:
    s_cmp_lg_u32 s30, 2
    s_cbranch_scc1 CL_tq10_3
    ds_read_b64_tr_b16 a[144:145], v51 offset:0
    ds_read_b64_tr_b16 a[146:147], v51 offset:512
    ds_read_b64_tr_b16 a[148:149], v51 offset:2048
    ds_read_b64_tr_b16 a[150:151], v51 offset:2560
    ds_read_b64_tr_b16 a[152:153], v51 offset:16384
    ds_read_b64_tr_b16 a[154:155], v51 offset:16896
    ds_read_b64_tr_b16 a[156:157], v51 offset:18432
    ds_read_b64_tr_b16 a[158:159], v51 offset:18944
    s_waitcnt lgkmcnt(4)
    ds_read_b64_tr_b16 a[208:209], v52 offset:0
    ds_read_b64_tr_b16 a[210:211], v52 offset:512
    ds_read_b64_tr_b16 a[212:213], v52 offset:2048
    ds_read_b64_tr_b16 a[214:215], v52 offset:2560
    ds_read_b64_tr_b16 a[216:217], v52 offset:16384
    ds_read_b64_tr_b16 a[218:219], v52 offset:16896
    ds_read_b64_tr_b16 a[220:221], v52 offset:18432
    ds_read_b64_tr_b16 a[222:223], v52 offset:18944
    s_branch CL_tq10_e
CL_tq10_3:
    ds_read_b64_tr_b16 a[128:129], v51 offset:0
    ds_read_b64_tr_b16 a[130:131], v51 offset:512
    ds_read_b64_tr_b16 a[132:133], v51 offset:2048
    ds_read_b64_tr_b16 a[134:135], v51 offset:2560
    ds_read_b64_tr_b16 a[136:137], v51 offset:16384
    ds_read_b64_tr_b16 a[138:139], v51 offset:16896
    ds_read_b64_tr_b16 a[140:141], v51 offset:18432
    ds_read_b64_tr_b16 a[142:143], v51 offset:18944
    s_waitcnt lgkmcnt(4)
    ds_read_b64_tr_b16 a[192:193], v52 offset:0
    ds_read_b64_tr_b16 a[194:195], v52 offset:512
    ds_read_b64_tr_b16 a[196:197], v52 offset:2048
    ds_read_b64_tr_b16 a[198:199], v52 offset:2560
    ds_read_b64_tr_b16 a[200:201], v52 offset:16384
    ds_read_b64_tr_b16 a[202:203], v52 offset:16896
    ds_read_b64_tr_b16 a[204:205], v52 offset:18432
    ds_read_b64_tr_b16 a[206:207], v52 offset:18944
CL_tq10_e:
    s_waitcnt lgkmcnt(0)
    s_barrier
    s_waitcnt vmcnt(4)
    s_barrier
    v_add_u32 v51, 32768, v43
    v_add_u32 v52, 32768, v44
    s_cmp_lg_u32 s30, 0
    s_cbranch_scc1 CL_tq11_1
    ds_read_b64_tr_b16 v[144:145], v51 offset:0
    ds_read_b64_tr_b16 v[146:147], v51 offset:512
    ds_read_b64_tr_b16 v[148:149], v51 offset:2048
    ds_read_b64_tr_b16 v[150:151], v51 offset:2560
    ds_read_b64_tr_b16 v[152:153], v51 offset:16384
    ds_read_b64_tr_b16 v[154:155], v51 offset:16896
    ds_read_b64_tr_b16 v[156:157], v51 offset:18432
    ds_read_b64_tr_b16 v[158:159], v51 offset:18944
    s_waitcnt lgkmcnt(4)
    ds_read_b64_tr_b16 v[176:177], v52 offset:0
    ds_read_b64_tr_b16 v[178:179], v52 offset:512
    ds_read_b64_tr_b16 v[180:181], v52 offset:2048
    ds_read_b64_tr_b16 v[182:183], v52 offset:2560
    ds_read_b64_tr_b16 v[184:185], v52 offset:16384
    ds_read_b64_tr_b16 v[186:187], v52 offset:16896
    ds_read_b64_tr_b16 v[188:189], v52 offset:18432
    ds_read_b64_tr_b16 v[190:191], v52 offset:18944
    s_branch CL_tq11_e
CL_tq11_1:
    s_cmp_lg_u32 s30, 1
    s_cbranch_scc1 CL_tq11_2
    ds_read_b64_tr_b16 v[128:129], v51 offset:0
    ds_read_b64_tr_b16 v[130:131], v51 offset:512
    ds_read_b64_tr_b16 v[132:133], v51 offset:2048
    ds_read_b64_tr_b16 v[134:135], v51 offset:2560
    ds_read_b64_tr_b16 v[136:137], v51 offset:16384
    ds_read_b64_tr_b16 v[138:139], v51 offset:16896
    ds_read_b64_tr_b16 v[140:141], v51 offset:18432
    ds_read_b64_tr_b16 v[142:143], v51 offset:18944
    s_waitcnt lgkmcnt(4)
    ds_read_b64_tr_b16 v[160:161], v52 offset:0
    ds_read_b64_tr_b16 v[162:163], v52 offset:512
    ds_read_b64_tr_b16 v[164:165], v52 offset:2048
    ds_read_b64_tr_b16 v[166:167], v52 offset:2560
    ds_read_b64_tr_b16 v[168:169], v52 offset:16384
    ds_read_b64_tr_b16 v[170:171], v52 offset:16896
    ds_read_b64_tr_b16 v[172:173], v52 offset:18432
    ds_read_b64_tr_b16 v[174:175], v52 offset:18944
    s_branch CL_tq11_e
CL_tq11_2:
    s_cmp_lg_u32 s30, 2
    s_cbranch_scc1 CL_tq11_3
    ds_read_b64_tr_b16 v[96:97], v51 offset:0
    ds_read_b64_tr_b16 v[98:99], v51 offset:512
    ds_read_b64_tr_b16 v[100:101], v51 offset:2048
    ds_read_b64_tr_b16 v[102:103], v51 offset:2560
    ds_read_b64_tr_b16 v[104:105], v51 offset:16384
    ds_read_b64_tr_b16 v[106:107], v51 offset:16896
    ds_read_b64_tr_b16 v[108:109], v51 offset:18432
    ds_read_b64_tr_b16 v[110:111], v51 offset:18944
    s_waitcnt lgkmcnt(4)
    ds_read_b64_tr_b16 v[112:113], v52 offset:0
    ds_read_b64_tr_b16 v[114:115], v52 offset:512
    ds_read_b64_tr_b16 v[116:117], v52 offset:2048
    ds_read_b64_tr_b16 v[118:119], v52 offset:2560
    ds_read_b64_tr_b16 v[120:121], v52 offset:16384
    ds_read_b64_tr_b16 v[122:123], v52 offset:16896
    ds_read_b64_tr_b16 v[124:125], v52 offset:18432
    ds_read_b64_tr_b16 v[126:127], v52 offset:18944
    s_branch CL_tq11_e
CL_tq11_3:
    ds_read_b64_tr_b16 v[64:65], v51 offset:0
    ds_read_b64_tr_b16 v[66:67], v51 offset:512
    ds_read_b64_tr_b16 v[68:69], v51 offset:2048
    ds_read_b64_tr_b16 v[70:71], v51 offset:2560
    ds_read_b64_tr_b16 v[80:81], v51 offset:16384
    ds_read_b64_tr_b16 v[82:83], v51 offset:16896
    ds_read_b64_tr_b16 v[84:85], v51 offset:18432
    ds_read_b64_tr_b16 v[86:87], v51 offset:18944
    s_waitcnt lgkmcnt(4)
    ds_read_b64_tr_b16 v[72:73], v52 offset:0
    ds_read_b64_tr_b16 v[74:75], v52 offset:512
    ds_read_b64_tr_b16 v[76:77], v52 offset:2048
    ds_read_b64_tr_b16 v[78:79], v52 offset:2560
    ds_read_b64_tr_b16 v[88:89], v52 offset:16384
    ds_read_b64_tr_b16 v[90:91], v52 offset:16896
    ds_read_b64_tr_b16 v[92:93], v52 offset:18432
    ds_read_b64_tr_b16 v[94:95], v52 offset:18944
CL_tq11_e:
    s_waitcnt lgkmcnt(0)
    s_barrier
    ds_write_b128 v6, v[64:67] offset:0
    ds_write_b128 v6, v[68:71] offset:1024
    ds_write_b128 v6, v[72:75] offset:2048
    ds_write_b128 v6, v[76:79] offset:3072
    ds_write_b128 v6, v[80:83] offset:4096
    ds_write_b128 v6, v[84:87] offset:5120
    ds_write_b128 v6, v[88:91] offset:6144
    ds_write_b128 v6, v[92:95] offset:7168
    ds_write_b128 v6, v[96:99] offset:8192
    ds_write_b128 v6, v[100:103] offset:9216
    ds_write_b128 v6, v[104:107] offset:10240
    ds_write_b128 v6, v[108:111] offset:11264
    ds_write_b128 v6, v[112:115] offset:12288
    ds_write_b128 v6, v[116:119] offset:13312
    ds_write_b128 v6, v[120:123] offset:14336
    ds_write_b128 v6, v[124:127] offset:15360
    s_waitcnt lgkmcnt(0)
    ds_read_b128 v[88:91], v6 offset:0
    ds_read_b128 v[92:95], v6 offset:1024
    ds_read_b128 v[96:99], v6 offset:2048
    ds_read_b128 v[100:103], v6 offset:3072
    ds_read_b128 v[104:107], v6 offset:4096
    ds_read_b128 v[108:111], v6 offset:5120
    ds_read_b128 v[112:115], v6 offset:6144
    ds_read_b128 v[116:119], v6 offset:7168
    ds_read_b128 v[120:123], v6 offset:8192
    ds_read_b128 v[124:127], v6 offset:9216
    v_mov_b64 v[64:65], 0
    v_mov_b64 v[66:67], 0
    v_mov_b64 v[68:69], 0
    v_mov_b64 v[70:71], 0
    v_mov_b64 v[72:73], 0
    v_mov_b64 v[74:75], 0
    v_mov_b64 v[76:77], 0
    v_mov_b64 v[78:79], 0
    v_mov_b64 v[80:81], 0
    v_mov_b64 v[82:83], 0
    v_mov_b64 v[84:85], 0
    v_mov_b64 v[86:87], 0
    s_add_u32 s38, s38, 0x80000
    s_add_u32 s39, s39, 0x80000
    s_add_u32 s40, s40, 0x40000
    s_mov_b32 m0, s42
    v_mov_b64 v[32:33], v[56:57]
    v_mov_b64 v[34:35], v[58:59]
    v_mov_b64 v[36:37], v[60:61]
    v_mov_b64 v[38:39], v[62:63]
    s_waitcnt vmcnt(0) lgkmcnt(0)
    ds_write_b128 v2, v[32:35] offset:0
    ds_write_b128 v2, v[36:39] offset:1024
    s_cmp_lg_u32 s32, 0
    s_cbranch_scc1 CL_s01_p2_j
    s_branch CL_s00_p2_j
CL_s00:
    s_nop 15
    s_nop 9
    buffer_load_dwordx4 v[56:59], v2, s[4:7], s47 offen sc1
    buffer_load_dwordx4 v[60:63], v2, s[4:7], s47 offen offset:1024 sc1
    s_mov_b64 s[92:93], -1
    s_waitcnt vmcnt(2)
    ds_write_b128 v2, v[32:35] offset:0
    ds_write_b128 v2, v[36:39] offset:1024
    v_max3_u32 v44, v32, v33, v34
    v_max3_u32 v45, v35, v36, v37
    v_max3_u32 v44, v44, v38, v39
    v_max_u32 v44, v44, v45
    v_cmp_eq_u32 vcc, -1, v44
    s_cbranch_vccnz CL_s00_p2_r
CL_s00_p2_j:
    v_smfmac_f32_16x16x64_bf16 v[64:67], v[32:35], v[88:95], v9
    v_xor_b32 v52, 2048, v2
    v_smfmac_f32_16x16x64_bf16 v[68:71], v[32:35], v[96:103], v9
    v_xor_b32 v53, 4096, v2
    v_smfmac_f32_16x16x64_bf16 v[64:67], v[36:39], v[104:111], v9
    v_xor_b32 v11, 6144, v2
    ds_read_b128 v[88:91], v6 offset:10240
    v_smfmac_f32_16x16x64_bf16 v[68:71], v[36:39], v[112:119], v9
    ds_read_b128 v[92:95], v6 offset:11264
    v_smfmac_f32_16x16x64_bf16 v[72:75], v[32:35], a[0:7], v9
    ds_read_b128 v[96:99], v6 offset:12288
    v_smfmac_f32_16x16x64_bf16 v[76:79], v[32:35], a[64:71], v9
    ds_read_b128 v[100:103], v6 offset:13312
    s_waitcnt lgkmcnt(4)
    s_barrier
    ds_read_b128 v[40:43], v52 offset:0
    ds_read_b128 v[44:47], v52 offset:1024
    v_smfmac_f32_16x16x64_bf16 v[72:75], v[36:39], a[8:15], v9
    ds_read_b128 v[48:51], v53 offset:0
    v_smfmac_f32_16x16x64_bf16 v[76:79], v[36:39], a[72:79], v9
    ds_read_b128 v[52:55], v53 offset:1024
    v_smfmac_f32_16x16x64_bf16 v[80:83], v[32:35], a[128:135], v9
    s_waitcnt vmcnt(0)
    ds_read_b128 v[56:59], v11 offset:0
    v_smfmac_f32_16x16x64_bf16 v[84:87], v[32:35], a[192:199], v9
    ds_read_b128 v[60:63], v11 offset:1024
    s_waitcnt lgkmcnt(4)
    v_smfmac_f32_16x16x64_bf16 v[64:67], v[40:43], v[120:127], v9
    ds_read_b128 v[104:107], v6 offset:14336
    v_smfmac_f32_16x16x64_bf16 v[64:67], v[44:47], v[88:95], v9
    ds_read_b128 v[108:111], v6 offset:15360
    s_waitcnt lgkmcnt(4)
    v_smfmac_f32_16x16x64_bf16 v[64:67], v[48:51], v[128:135], v9
    buffer_store_dwordx4 v[24:27], v2, s[4:7], s40 offen sc0 sc1
    v_smfmac_f32_16x16x64_bf16 v[64:67], v[52:55], v[136:143], v9
    s_waitcnt lgkmcnt(2)
    ds_read_b128 v[112:115], v1 offset:12288
    v_smfmac_f32_16x16x64_bf16 v[64:67], v[56:59], v[144:151], v9
    ds_read_b128 v[116:119], v1 offset:13312
    v_mov_b32 v11, s83
    v_smfmac_f32_16x16x64_bf16 v[64:67], v[60:63], v[152:159], v9
    buffer_load_dwordx4 v[24:27], v2, s[4:7], s39 offen sc1
    s_waitcnt lgkmcnt(2)
    v_smfmac_f32_16x16x64_bf16 v[68:71], v[40:43], v[96:103], v9
    buffer_store_dword v11, off, s[4:7], s85 sc0 sc1
    v_smfmac_f32_16x16x64_bf16 v[68:71], v[44:47], v[104:111], v9
    ds_read_b128 v[96:99], v1 offset:8192
    v_smfmac_f32_16x16x64_bf16 v[68:71], v[48:51], v[160:167], v9
    ds_read_b128 v[100:103], v1 offset:9216
    v_add_f32 v64, v64, v66
    v_smfmac_f32_16x16x64_bf16 v[68:71], v[52:55], v[168:175], v9
    ds_read_b128 v[104:107], v1 offset:10240
    v_add_f32 v65, v65, v67
    v_smfmac_f32_16x16x64_bf16 v[68:71], v[56:59], v[176:183], v9
    ds_read_b128 v[108:111], v1 offset:11264
    v_cvt_pk_bf16_f32 v66, v64, v65
    v_smfmac_f32_16x16x64_bf16 v[68:71], v[60:63], v[184:191], v9
    buffer_load_dwordx4 v[28:31], v2, s[4:7], s39 offen offset:1024 sc1
    v_lshl_add_u32 v11, v3, 1, s44
    v_smfmac_f32_16x16x64_bf16 v[72:75], v[40:43], a[16:23], v9
    buffer_load_dwordx4 v2, s[4:7], s38 offen sc1 lds
    v_smfmac_f32_16x16x64_bf16 v[72:75], v[44:47], a[24:31], v9
    v_smfmac_f32_16x16x64_bf16 v[72:75], v[48:51], a[32:39], v9
    v_add_f32 v68, v68, v70
    v_smfmac_f32_16x16x64_bf16 v[72:75], v[52:55], a[40:47], v9
    v_add_f32 v69, v69, v71
    v_smfmac_f32_16x16x64_bf16 v[72:75], v[56:59], a[48:55], v9
    v_cvt_pk_bf16_f32 v67, v68, v69
    ds_write2_b32 v3, v66, v67 offset1:64
    v_smfmac_f32_16x16x64_bf16 v[72:75], v[60:63], a[56:63], v9
    buffer_load_dwordx4 v2, s[4:7], s38 offen offset:1024 sc1 lds
    v_smfmac_f32_16x16x64_bf16 v[76:79], v[40:43], a[80:87], v9
    v_smfmac_f32_16x16x64_bf16 v[76:79], v[44:47], a[88:95], v9
    v_smfmac_f32_16x16x64_bf16 v[76:79], v[48:51], a[96:103], v9
    v_add_f32 v72, v72, v74
    v_smfmac_f32_16x16x64_bf16 v[76:79], v[52:55], a[104:111], v9
    v_add_f32 v73, v73, v75
    s_waitcnt lgkmcnt(0)
    s_barrier
    ds_read_b64_tr_b16 v[64:65], v4 offset:0
    v_smfmac_f32_16x16x64_bf16 v[76:79], v[56:59], a[112:119], v9
    v_cvt_pk_bf16_f32 v73, v72, v73
    ds_read_b64_tr_b16 v[66:67], v4 offset:256
    v_smfmac_f32_16x16x64_bf16 v[76:79], v[60:63], a[120:127], v9
    ds_read_b64_tr_b16 v[68:69], v4 offset:512
    ds_read_b64_tr_b16 v[70:71], v4 offset:768
    v_smfmac_f32_16x16x64_bf16 v[80:83], v[36:39], a[136:143], v9
    ds_read_b64_tr_b16 v[88:89], v4 offset:1024
    ds_read_b64_tr_b16 v[90:91], v4 offset:1280
    v_smfmac_f32_16x16x64_bf16 v[84:87], v[36:39], a[200:207], v9
    ds_read_b64_tr_b16 v[92:93], v4 offset:1536
    v_smfmac_f32_16x16x64_bf16 v[80:83], v[40:43], a[144:151], v9
    ds_read_b64_tr_b16 v[94:95], v4 offset:1792
    s_waitcnt lgkmcnt(4)
    v_add_f32 v76, v76, v78
    v_add_f32 v77, v77, v79
    v_mfma_f32_16x16x32_bf16 v[120:123], v[96:99], v[64:67], 0
    v_cvt_pk_bf16_f32 v75, v76, v77
    ds_write2_b32 v11, v73, v75 offset1:128
    v_mfma_f32_16x16x32_bf16 v[120:123], v[100:103], v[68:71], v[120:123]
    v_mfma_f32_16x16x32_bf16 v[124:127], v[112:115], v[64:67], 0
    ds_read_b128 v[96:99], v1 offset:14336
    ds_read_b128 v[100:103], v1 offset:15360
    v_mfma_f32_16x16x32_bf16 v[124:127], v[116:119], v[68:71], v[124:127]
    s_waitcnt lgkmcnt(3)
    v_mfma_f32_16x16x32_bf16 v[120:123], v[104:107], v[88:91], v[120:123]
    v_mfma_f32_16x16x32_bf16 v[120:123], v[108:111], v[92:95], v[120:123]
    s_waitcnt lgkmcnt(2)
    s_barrier
    ds_read_b64_tr_b16 v[104:105], v0 offset:0
    v_smfmac_f32_16x16x64_bf16 v[84:87], v[40:43], a[208:215], v9
    ds_read_b64_tr_b16 v[106:107], v0 offset:512
    ds_read_b64_tr_b16 v[108:109], v0 offset:1024
    s_waitcnt lgkmcnt(3)
    v_mfma_f32_16x16x32_bf16 v[124:127], v[96:99], v[88:91], v[124:127]
    ds_read_b64_tr_b16 v[110:111], v0 offset:1536
    ds_read_b64_tr_b16 v[112:113], v0 offset:2048
    v_mfma_f32_16x16x32_bf16 v[124:127], v[100:103], v[92:95], v[124:127]
    ds_read_b64_tr_b16 v[114:115], v0 offset:2560
    ds_read_b64_tr_b16 v[116:117], v0 offset:3072
    v_smfmac_f32_16x16x64_bf16 v[80:83], v[44:47], a[152:159], v9
    ds_read_b64_tr_b16 v[118:119], v0 offset:3584
    v_smfmac_f32_16x16x64_bf16 v[84:87], v[44:47], a[216:223], v9
    v_smfmac_f32_16x16x64_bf16 v[80:83], v[48:51], a[160:167], v9
    s_waitcnt lgkmcnt(4)
    v_mfma_f32_16x16x32_bf16 v[32:35], v[104:107], v[64:67], 0
    v_max3_f32 v78, v120, v121, v122
    v_max3_f32 v78, v78, v123, v124
    v_mfma_f32_16x16x32_bf16 v[32:35], v[108:111], v[68:71], v[32:35]
    v_max3_f32 v78, v78, v125, v126
    s_waitcnt lgkmcnt(0)
    v_mfma_f32_16x16x32_bf16 v[32:35], v[112:115], v[88:91], v[32:35]
    v_max_f32 v78, v78, v127
    v_mov_b32 v65, v73
    v_mfma_f32_16x16x32_bf16 v[32:35], v[116:119], v[92:95], v[32:35]
    v_mov_b32 v67, v75
    v_mov_b64 v[68:69], 0
    v_smfmac_f32_16x16x64_bf16 v[84:87], v[48:51], a[224:231], v9
    ds_read_b128 v[96:99], v10 offset:2048
    v_mov_b32 v41, 0
    v_smfmac_f32_16x16x64_bf16 v[80:83], v[52:55], a[168:175], v9
    ds_read_b128 v[100:103], v10 offset:3072
    v_mov_b64 v[42:43], 0
    v_smfmac_f32_16x16x64_bf16 v[84:87], v[52:55], a[232:239], v9
    ds_read_b128 v[88:91], v10 offset:0
    v_max3_f32 v70, v78, v32, v33
    v_smfmac_f32_16x16x64_bf16 v[80:83], v[56:59], a[176:183], v9
    ds_read_b128 v[92:95], v10 offset:1024
    v_mov_b32 v71, v70
    v_smfmac_f32_16x16x64_bf16 v[84:87], v[56:59], a[240:247], v9
    ds_read_b128 v[104:107], v10 offset:4096
    v_mov_b64 v[36:37], s[90:91]
    v_smfmac_f32_16x16x64_bf16 v[80:83], v[60:63], a[184:191], v9
    ds_read_b128 v[108:111], v10 offset:5120
    v_permlane32_swap_b32 v70, v71
    v_smfmac_f32_16x16x64_bf16 v[84:87], v[60:63], a[248:255], v9
    ds_read_b128 v[112:115], v10 offset:6144
    v_max_f32 v70, v70, v71
    v_mov_b32 v71, v70
    ds_read_b128 v[116:119], v10 offset:7168
    v_mov_b64 v[38:39], s[90:91]
    v_permlane16_swap_b32 v70, v71
    v_max_f32 v70, v70, v71
    v_mul_f32 v70, s50, v70
    v_pk_fma_f32 v[120:121], v[120:121], s[50:51], v[70:71] op_sel_hi:[1,1,0] neg_lo:[0,0,1] neg_hi:[0,0,1]
    v_pk_fma_f32 v[122:123], v[122:123], s[50:51], v[70:71] op_sel_hi:[1,1,0] neg_lo:[0,0,1] neg_hi:[0,0,1]
    v_pk_fma_f32 v[124:125], v[124:125], s[50:51], v[70:71] op_sel_hi:[1,1,0] neg_lo:[0,0,1] neg_hi:[0,0,1]
    v_pk_fma_f32 v[126:127], v[126:127], s[50:51], v[70:71] op_sel_hi:[1,1,0] neg_lo:[0,0,1] neg_hi:[0,0,1]
    v_pk_fma_f32 v[32:33], v[32:33], s[50:51], v[70:71] op_sel_hi:[1,1,0] neg_lo:[0,0,1] neg_hi:[0,0,1]
    v_exp_f32 v120, v120
    v_exp_f32 v121, v121
    v_exp_f32 v122, v122
    ds_read_b128 v[72:75], v10 offset:8192
    v_exp_f32 v123, v123
    v_cvt_pk_bf16_f32 v44, v120, v121
    v_exp_f32 v124, v124
    ds_read_b128 v[76:79], v10 offset:9216
    v_exp_f32 v125, v125
    v_cvt_pk_bf16_f32 v45, v122, v123
    v_exp_f32 v126, v126
    v_exp_f32 v127, v127
    v_cvt_pk_bf16_f32 v46, v124, v125
    v_exp_f32 v32, v32
    v_cvt_pk_bf16_f32 v47, v126, v127
    v_exp_f32 v33, v33
    v_add_f32 v80, v80, v82
    v_mfma_f32_16x16x32_bf16 v[48:51], v[36:39], v[44:47], 0
    v_cvt_pk_bf16_f32 v40, v32, v33
    v_add_f32 v81, v81, v83
    v_mfma_f32_16x16x32_bf16 v[52:55], v[16:19], v[44:47], 0
    v_add_f32 v84, v84, v86
    v_add_f32 v85, v85, v87
    v_mfma_f32_16x16x32_bf16 v[48:51], v[36:39], v[40:43], v[48:51]
    v_cvt_pk_bf16_f32 v64, v80, v81
    v_cvt_pk_bf16_f32 v66, v84, v85
    v_mfma_f32_16x16x32_bf16 v[56:59], v[20:23], v[44:47], 0
    v_mov_b64 v[32:33], 0
    v_mov_b64 v[34:35], 0
    v_mfma_f32_16x16x32_bf16 v[52:55], v[64:67], v[40:43], v[52:55]
    v_mov_b64 v[36:37], 0
    s_nop 0
    v_rcp_f32 v60, v48
    v_mfma_f32_16x16x32_bf16 v[56:59], v[66:69], v[40:43], v[56:59]
    s_mov_b64 exec, s[96:97]
    s_nop 2
    v_mul_f32 v52, v52, v60
    v_mul_f32 v53, v53, v60
    v_mul_f32 v54, v54, v60
    v_mul_f32 v55, v55, v60
    s_not_b64 exec, exec
    v_pk_mul_f32 v[52:53], v[56:57], v[60:61] op_sel_hi:[1,0]
    v_pk_mul_f32 v[54:55], v[58:59], v[60:61] op_sel_hi:[1,0]
    s_mov_b64 exec, -1
    v_cvt_pk_bf16_f32 v56, v52, v53
    v_cvt_pk_bf16_f32 v57, v54, v55
    ds_write_b64 v5, v[56:57] offset:30720
    v_min_u32 v16, -2, v64
    v_mov_b32 v17, v65
    v_mov_b64 v[18:19], v[66:67]
    buffer_load_dwordx4 v[20:23], off, s[4:7], s82 sc1
    v_mov_b64 v[38:39], 0
    v_mov_b64 v[40:41], 0
    v_mov_b64 v[42:43], 0
    v_mov_b64 v[44:45], 0
    v_mov_b64 v[46:47], 0
    s_waitcnt lgkmcnt(0)
    s_barrier
    ds_read_b128 v[68:71], v1 offset:31744
    ds_read_b128 v[64:67], v1 offset:30720
    v_mov_b64 v[48:49], 0
    v_mov_b64 v[50:51], 0
    v_mov_b64 v[52:53], 0
    v_mov_b64 v[54:55], 0
    v_mov_b64 v[56:57], 0
    v_mov_b64 v[58:59], 0
    v_mov_b64 v[60:61], 0
    v_mov_b64 v[62:63], 0
    s_waitcnt lgkmcnt(0)
    v_smfmac_f32_16x16x64_bf16 v[32:35], v[68:71], v[88:95], v9
    ds_read_b128 v[80:83], v10 offset:10240
    v_smfmac_f32_16x16x64_bf16 v[32:35], v[64:67], v[192:199], v9
    ds_read_b128 v[84:87], v10 offset:11264
    ds_read_b128 v[120:123], v10 offset:12288
    v_smfmac_f32_16x16x64_bf16 v[36:39], v[68:71], v[96:103], v9
    ds_read_b128 v[124:127], v10 offset:13312
    ds_read_b128 v[88:91], v10 offset:14336
    v_smfmac_f32_16x16x64_bf16 v[36:39], v[64:67], v[200:207], v9
    ds_read_b128 v[92:95], v10 offset:15360
    s_nop 0
    v_add_f32 v32, v32, v34
    v_smfmac_f32_16x16x64_bf16 v[40:43], v[68:71], v[104:111], v9
    v_add_f32 v33, v33, v35
    v_cvt_pk_bf16_f32 v32, v32, v33
    v_smfmac_f32_16x16x64_bf16 v[40:43], v[64:67], v[208:215], v9
    v_and_b32 v32, -2, v32
    v_smfmac_f32_16x16x64_bf16 v[44:47], v[68:71], v[112:119], v9
    v_add_f32 v36, v36, v38
    v_add_f32 v37, v37, v39
    v_smfmac_f32_16x16x64_bf16 v[44:47], v[64:67], v[216:223], v9
    v_cvt_pk_bf16_f32 v33, v36, v37
    v_smfmac_f32_16x16x64_bf16 v[48:51], v[68:71], v[72:79], v9
    v_add_f32 v40, v40, v42
    v_add_f32 v41, v41, v43
    v_smfmac_f32_16x16x64_bf16 v[48:51], v[64:67], v[224:231], v9
    v_cvt_pk_bf16_f32 v34, v40, v41
    s_waitcnt lgkmcnt(0)
    v_smfmac_f32_16x16x64_bf16 v[52:55], v[68:71], v[80:87], v9
    v_add_f32 v44, v44, v46
    v_add_f32 v45, v45, v47
    v_smfmac_f32_16x16x64_bf16 v[52:55], v[64:67], v[232:239], v9
    v_cvt_pk_bf16_f32 v35, v44, v45
    buffer_store_dwordx4 v[32:35], v7, s[4:7], 0 offen
    v_smfmac_f32_16x16x64_bf16 v[56:59], v[68:71], v[120:127], v9
    v_add_f32 v48, v48, v50
    v_add_f32 v49, v49, v51
    v_smfmac_f32_16x16x64_bf16 v[56:59], v[64:67], v[240:247], v9
    v_cvt_pk_bf16_f32 v48, v48, v49
    v_smfmac_f32_16x16x64_bf16 v[60:63], v[64:67], v[248:255], v9
    v_and_b32 v48, -2, v48
    v_add_f32 v52, v52, v54
    v_smfmac_f32_16x16x64_bf16 v[60:63], v[68:71], v[88:95], v9
    v_add_f32 v53, v53, v55
    v_cvt_pk_bf16_f32 v49, v52, v53
    v_add_f32 v56, v56, v58
    v_add_f32 v57, v57, v59
    v_cvt_pk_bf16_f32 v50, v56, v57
    s_nop 2
    v_add_f32 v60, v60, v62
    v_add_f32 v61, v61, v63
    v_cvt_pk_bf16_f32 v51, v60, v61
    buffer_store_dwordx4 v[48:51], v7, s[4:7], s48 offen
    s_add_u32 s45, s33, 3
    s_min_u32 s45, s45, 64
    s_cmp_ge_u32 s49, s45
    s_cbranch_scc0 CL_kv00
CL_kvb00:
    ds_read_b128 v[88:91], v6 offset:0
    v_mov_b64 v[64:65], 0
    ds_read_b128 v[92:95], v6 offset:1024
    v_mov_b64 v[66:67], 0
    ds_read_b128 v[96:99], v6 offset:2048
    v_mov_b64 v[68:69], 0
    ds_read_b128 v[100:103], v6 offset:3072
    v_mov_b64 v[70:71], 0
    ds_read_b128 v[104:107], v6 offset:4096
    v_mov_b64 v[72:73], 0
    ds_read_b128 v[108:111], v6 offset:5120
    v_mov_b64 v[74:75], 0
    v_mov_b64 v[76:77], 0
    ds_read_b128 v[112:115], v6 offset:6144
    v_mov_b64 v[78:79], 0
    ds_read_b128 v[116:119], v6 offset:7168
    v_mov_b64 v[80:81], 0
    ds_read_b128 v[120:123], v6 offset:8192
    v_mov_b64 v[82:83], 0
    ds_read_b128 v[124:127], v6 offset:9216
    v_mov_b64 v[84:85], 0
    v_mov_b64 v[86:87], 0
    s_add_u32 s38, s38, 0x80000
    s_add_u32 s39, s39, 0x80000
    s_add_u32 s40, s40, 0x40000
    s_mov_b32 m0, s41
    s_mov_b32 s43, 0
    buffer_load_dwordx4 v[36:39], v2, s[4:7], s34 offen sc1
    buffer_load_dwordx4 v[40:43], v2, s[4:7], s34 offen offset:1024 sc1
    s_nop 15
    s_nop 3
    buffer_load_dwordx4 v[56:59], v2, s[4:7], s34 offen sc1
    buffer_load_dwordx4 v[60:63], v2, s[4:7], s34 offen offset:1024 sc1
    s_mov_b64 s[92:93], -1
    s_waitcnt vmcnt(2)
    v_mfma_f32_16x16x32_bf16 v[44:47], v[36:39], v[12:15], 0
    v_mfma_f32_16x16x32_bf16 v[44:47], v[40:43], v[12:15], v[44:47]
    v_or_b32 v11, v36, v40
    v_and_b32 v11, 1, v11
    v_cmp_ne_u32 vcc, 0, v11
    s_cbranch_vccnz CL_s00_p1_r
CL_s00_p1_j:
    v_mov_b32 v11, -1
    s_nop 2
    v_permlane32_swap_b32 v44, v45
    v_permlane32_swap_b32 v46, v47
    v_add_f32 v44, v44, v45
    v_add_f32 v46, v46, v47
    s_nop 1
    v_permlane16_swap_b32 v44, v46
    v_add_f32 v44, v44, v46
    v_mov_b32 v45, v44
    s_nop 1
    v_permlane32_swap_b32 v44, v45
    s_mov_b64 exec, s[98:99]
    v_cvt_pk_bf16_f32 v44, v44, v45
    v_min_u32 v44, -2, v44
    buffer_store_dword v44, v8, s[4:7], s35 offen
    buffer_store_dword v11, v8, s[4:7], s37 offen
    s_mov_b64 exec, -1
    s_sub_u32 s47, s35, 131072
    s_mov_b32 s45, s35
    s_mov_b32 s35, s36
    s_mov_b32 s36, s37
    s_mov_b32 s37, s45
    s_mov_b32 s83, s33
    s_add_u32 s33, s33, 1
    v_min_u32 v20, v20, v21
    v_min3_u32 v20, v20, v22, v23
    s_nop 0
    v_readfirstlane_b32 s45, v20
    s_nop 1
    s_lshl_b32 s45, s45, 2
    s_max_u32 s49, s49, s45
    s_add_u32 s45, s33, 8
    s_min_u32 s45, s45, 64
    s_cmp_ge_u32 s49, s45
    s_cselect_b32 s82, 268435456, s84
    s_nop 15
    s_nop 15
    s_nop 3
    s_mov_b32 s43, 0
    buffer_load_dwordx4 v[32:35], v2, s[4:7], s47 offen sc1
    buffer_load_dwordx4 v[36:39], v2, s[4:7], s47 offen offset:1024 sc1
    s_waitcnt lgkmcnt(0)
    s_cmp_eq_u32 s33, 63
    s_cbranch_scc1 CL_chain_last
CL_s10:
    s_nop 15
    s_nop 11
    buffer_load_dwordx4 v[56:59], v2, s[4:7], s47 offen sc1
    buffer_load_dwordx4 v[60:63], v2, s[4:7], s47 offen offset:1024 sc1
    s_mov_b64 s[92:93], -1
    s_waitcnt vmcnt(2)
    ds_write_b128 v2, v[32:35] offset:0
    ds_write_b128 v2, v[36:39] offset:1024
    v_max3_u32 v44, v32, v33, v34
    v_max3_u32 v45, v35, v36, v37
    v_max3_u32 v44, v44, v38, v39
    v_max_u32 v44, v44, v45
    v_cmp_eq_u32 vcc, -1, v44
    s_cbranch_vccnz CL_s10_p2_r
CL_s10_p2_j:
    v_smfmac_f32_16x16x64_bf16 v[64:67], v[32:35], v[88:95], v9
    v_xor_b32 v52, 2048, v2
    v_smfmac_f32_16x16x64_bf16 v[68:71], v[32:35], v[96:103], v9
    v_xor_b32 v53, 4096, v2
    v_smfmac_f32_16x16x64_bf16 v[64:67], v[36:39], v[104:111], v9
    v_xor_b32 v11, 6144, v2
    ds_read_b128 v[88:91], v6 offset:10240
    v_smfmac_f32_16x16x64_bf16 v[68:71], v[36:39], v[112:119], v9
    ds_read_b128 v[92:95], v6 offset:11264
    v_smfmac_f32_16x16x64_bf16 v[72:75], v[32:35], a[0:7], v9
    ds_read_b128 v[96:99], v6 offset:12288
    v_smfmac_f32_16x16x64_bf16 v[76:79], v[32:35], a[64:71], v9
    ds_read_b128 v[100:103], v6 offset:13312
    s_waitcnt lgkmcnt(4)
    s_barrier
    ds_read_b128 v[40:43], v52 offset:0
    ds_read_b128 v[44:47], v52 offset:1024
    v_smfmac_f32_16x16x64_bf16 v[72:75], v[36:39], a[8:15], v9
    ds_read_b128 v[48:51], v53 offset:0
    v_smfmac_f32_16x16x64_bf16 v[76:79], v[36:39], a[72:79], v9
    ds_read_b128 v[52:55], v53 offset:1024
    v_smfmac_f32_16x16x64_bf16 v[80:83], v[32:35], a[128:135], v9
    s_waitcnt vmcnt(0)
    ds_read_b128 v[56:59], v11 offset:0
    v_smfmac_f32_16x16x64_bf16 v[84:87], v[32:35], a[192:199], v9
    ds_read_b128 v[60:63], v11 offset:1024
    s_waitcnt lgkmcnt(4)
    v_smfmac_f32_16x16x64_bf16 v[64:67], v[40:43], v[120:127], v9
    ds_read_b128 v[104:107], v6 offset:14336
    v_smfmac_f32_16x16x64_bf16 v[64:67], v[44:47], v[88:95], v9
    ds_read_b128 v[108:111], v6 offset:15360
    s_waitcnt lgkmcnt(4)
    v_smfmac_f32_16x16x64_bf16 v[64:67], v[48:51], v[128:135], v9
    buffer_store_dwordx4 v[16:19], v2, s[4:7], s40 offen sc0 sc1
    v_smfmac_f32_16x16x64_bf16 v[64:67], v[52:55], v[136:143], v9
    s_waitcnt lgkmcnt(2)
    ds_read_b128 v[112:115], v1 offset:20480
    v_smfmac_f32_16x16x64_bf16 v[64:67], v[56:59], v[144:151], v9
    ds_read_b128 v[116:119], v1 offset:21504
    v_mov_b32 v11, s83
    v_smfmac_f32_16x16x64_bf16 v[64:67], v[60:63], v[152:159], v9
    buffer_load_dwordx4 v[16:19], v2, s[4:7], s39 offen sc1
    s_waitcnt lgkmcnt(2)
    v_smfmac_f32_16x16x64_bf16 v[68:71], v[40:43], v[96:103], v9
    buffer_store_dword v11, off, s[4:7], s85 sc0 sc1
    v_smfmac_f32_16x16x64_bf16 v[68:71], v[44:47], v[104:111], v9
    ds_read_b128 v[96:99], v1 offset:16384
    v_smfmac_f32_16x16x64_bf16 v[68:71], v[48:51], v[160:167], v9
    ds_read_b128 v[100:103], v1 offset:17408
    v_add_f32 v64, v64, v66
    v_smfmac_f32_16x16x64_bf16 v[68:71], v[52:55], v[168:175], v9
    ds_read_b128 v[104:107], v1 offset:18432
    v_add_f32 v65, v65, v67
    v_smfmac_f32_16x16x64_bf16 v[68:71], v[56:59], v[176:183], v9
    ds_read_b128 v[108:111], v1 offset:19456
    v_cvt_pk_bf16_f32 v66, v64, v65
    v_smfmac_f32_16x16x64_bf16 v[68:71], v[60:63], v[184:191], v9
    buffer_load_dwordx4 v[20:23], v2, s[4:7], s39 offen offset:1024 sc1
    v_lshl_add_u32 v11, v3, 1, s44
    v_smfmac_f32_16x16x64_bf16 v[72:75], v[40:43], a[16:23], v9
    buffer_load_dwordx4 v2, s[4:7], s38 offen sc1 lds
    v_smfmac_f32_16x16x64_bf16 v[72:75], v[44:47], a[24:31], v9
    v_smfmac_f32_16x16x64_bf16 v[72:75], v[48:51], a[32:39], v9
    v_add_f32 v68, v68, v70
    v_smfmac_f32_16x16x64_bf16 v[72:75], v[52:55], a[40:47], v9
    v_add_f32 v69, v69, v71
    v_smfmac_f32_16x16x64_bf16 v[72:75], v[56:59], a[48:55], v9
    v_cvt_pk_bf16_f32 v67, v68, v69
    ds_write2_b32 v3, v66, v67 offset1:64
    v_smfmac_f32_16x16x64_bf16 v[72:75], v[60:63], a[56:63], v9
    buffer_load_dwordx4 v2, s[4:7], s38 offen offset:1024 sc1 lds
    v_smfmac_f32_16x16x64_bf16 v[76:79], v[40:43], a[80:87], v9
    v_smfmac_f32_16x16x64_bf16 v[76:79], v[44:47], a[88:95], v9
    v_smfmac_f32_16x16x64_bf16 v[76:79], v[48:51], a[96:103], v9
    v_add_f32 v72, v72, v74
    v_smfmac_f32_16x16x64_bf16 v[76:79], v[52:55], a[104:111], v9
    v_add_f32 v73, v73, v75
    s_waitcnt lgkmcnt(0)
    s_barrier
    ds_read_b64_tr_b16 v[64:65], v4 offset:0
    v_smfmac_f32_16x16x64_bf16 v[76:79], v[56:59], a[112:119], v9
    v_cvt_pk_bf16_f32 v73, v72, v73
    ds_read_b64_tr_b16 v[66:67], v4 offset:256
    v_smfmac_f32_16x16x64_bf16 v[76:79], v[60:63], a[120:127], v9
    ds_read_b64_tr_b16 v[68:69], v4 offset:512
    ds_read_b64_tr_b16 v[70:71], v4 offset:768
    v_smfmac_f32_16x16x64_bf16 v[80:83], v[36:39], a[136:143], v9
    ds_read_b64_tr_b16 v[88:89], v4 offset:1024
    ds_read_b64_tr_b16 v[90:91], v4 offset:1280
    v_smfmac_f32_16x16x64_bf16 v[84:87], v[36:39], a[200:207], v9
    ds_read_b64_tr_b16 v[92:93], v4 offset:1536
    v_smfmac_f32_16x16x64_bf16 v[80:83], v[40:43], a[144:151], v9
    ds_read_b64_tr_b16 v[94:95], v4 offset:1792
    s_waitcnt lgkmcnt(4)
    v_add_f32 v76, v76, v78
    v_add_f32 v77, v77, v79
    v_mfma_f32_16x16x32_bf16 v[120:123], v[96:99], v[64:67], 0
    v_cvt_pk_bf16_f32 v75, v76, v77
    ds_write2_b32 v11, v73, v75 offset1:128
    v_mfma_f32_16x16x32_bf16 v[120:123], v[100:103], v[68:71], v[120:123]
    v_mfma_f32_16x16x32_bf16 v[124:127], v[112:115], v[64:67], 0
    ds_read_b128 v[96:99], v1 offset:22528
    ds_read_b128 v[100:103], v1 offset:23552
    v_mfma_f32_16x16x32_bf16 v[124:127], v[116:119], v[68:71], v[124:127]
    s_waitcnt lgkmcnt(3)
    v_mfma_f32_16x16x32_bf16 v[120:123], v[104:107], v[88:91], v[120:123]
    v_mfma_f32_16x16x32_bf16 v[120:123], v[108:111], v[92:95], v[120:123]
    s_waitcnt lgkmcnt(2)
    s_barrier
    ds_read_b64_tr_b16 v[104:105], v0 offset:0
    v_smfmac_f32_16x16x64_bf16 v[84:87], v[40:43], a[208:215], v9
    ds_read_b64_tr_b16 v[106:107], v0 offset:512
    ds_read_b64_tr_b16 v[108:109], v0 offset:1024
    s_waitcnt lgkmcnt(3)
    v_mfma_f32_16x16x32_bf16 v[124:127], v[96:99], v[88:91], v[124:127]
    ds_read_b64_tr_b16 v[110:111], v0 offset:1536
    ds_read_b64_tr_b16 v[112:113], v0 offset:2048
    v_mfma_f32_16x16x32_bf16 v[124:127], v[100:103], v[92:95], v[124:127]
    ds_read_b64_tr_b16 v[114:115], v0 offset:2560
    ds_read_b64_tr_b16 v[116:117], v0 offset:3072
    v_smfmac_f32_16x16x64_bf16 v[80:83], v[44:47], a[152:159], v9
    ds_read_b64_tr_b16 v[118:119], v0 offset:3584
    v_smfmac_f32_16x16x64_bf16 v[84:87], v[44:47], a[216:223], v9
    v_smfmac_f32_16x16x64_bf16 v[80:83], v[48:51], a[160:167], v9
    s_waitcnt lgkmcnt(4)
    v_mfma_f32_16x16x32_bf16 v[32:35], v[104:107], v[64:67], 0
    v_max3_f32 v78, v120, v121, v122
    v_max3_f32 v78, v78, v123, v124
    v_mfma_f32_16x16x32_bf16 v[32:35], v[108:111], v[68:71], v[32:35]
    v_max3_f32 v78, v78, v125, v126
    s_waitcnt lgkmcnt(0)
    v_mfma_f32_16x16x32_bf16 v[32:35], v[112:115], v[88:91], v[32:35]
    v_max_f32 v78, v78, v127
    v_mov_b32 v65, v73
    v_mfma_f32_16x16x32_bf16 v[32:35], v[116:119], v[92:95], v[32:35]
    v_mov_b32 v67, v75
    v_mov_b64 v[68:69], 0
    v_smfmac_f32_16x16x64_bf16 v[84:87], v[48:51], a[224:231], v9
    ds_read_b128 v[96:99], v10 offset:2048
    v_mov_b32 v41, 0
    v_smfmac_f32_16x16x64_bf16 v[80:83], v[52:55], a[168:175], v9
    ds_read_b128 v[100:103], v10 offset:3072
    v_mov_b64 v[42:43], 0
    v_smfmac_f32_16x16x64_bf16 v[84:87], v[52:55], a[232:239], v9
    ds_read_b128 v[88:91], v10 offset:0
    v_max3_f32 v70, v78, v32, v33
    v_smfmac_f32_16x16x64_bf16 v[80:83], v[56:59], a[176:183], v9
    ds_read_b128 v[92:95], v10 offset:1024
    v_mov_b32 v71, v70
    v_smfmac_f32_16x16x64_bf16 v[84:87], v[56:59], a[240:247], v9
    ds_read_b128 v[104:107], v10 offset:4096
    v_mov_b64 v[36:37], s[90:91]
    v_smfmac_f32_16x16x64_bf16 v[80:83], v[60:63], a[184:191], v9
    ds_read_b128 v[108:111], v10 offset:5120
    v_permlane32_swap_b32 v70, v71
    v_smfmac_f32_16x16x64_bf16 v[84:87], v[60:63], a[248:255], v9
    ds_read_b128 v[112:115], v10 offset:6144
    v_max_f32 v70, v70, v71
    v_mov_b32 v71, v70
    ds_read_b128 v[116:119], v10 offset:7168
    v_mov_b64 v[38:39], s[90:91]
    v_permlane16_swap_b32 v70, v71
    v_max_f32 v70, v70, v71
    v_mul_f32 v70, s50, v70
    v_pk_fma_f32 v[120:121], v[120:121], s[50:51], v[70:71] op_sel_hi:[1,1,0] neg_lo:[0,0,1] neg_hi:[0,0,1]
    v_pk_fma_f32 v[122:123], v[122:123], s[50:51], v[70:71] op_sel_hi:[1,1,0] neg_lo:[0,0,1] neg_hi:[0,0,1]
    v_pk_fma_f32 v[124:125], v[124:125], s[50:51], v[70:71] op_sel_hi:[1,1,0] neg_lo:[0,0,1] neg_hi:[0,0,1]
    v_pk_fma_f32 v[126:127], v[126:127], s[50:51], v[70:71] op_sel_hi:[1,1,0] neg_lo:[0,0,1] neg_hi:[0,0,1]
    v_pk_fma_f32 v[32:33], v[32:33], s[50:51], v[70:71] op_sel_hi:[1,1,0] neg_lo:[0,0,1] neg_hi:[0,0,1]
    v_exp_f32 v120, v120
    v_exp_f32 v121, v121
    v_exp_f32 v122, v122
    ds_read_b128 v[72:75], v10 offset:8192
    v_exp_f32 v123, v123
    v_cvt_pk_bf16_f32 v44, v120, v121
    v_exp_f32 v124, v124
    ds_read_b128 v[76:79], v10 offset:9216
    v_exp_f32 v125, v125
    v_cvt_pk_bf16_f32 v45, v122, v123
    v_exp_f32 v126, v126
    v_exp_f32 v127, v127
    v_cvt_pk_bf16_f32 v46, v124, v125
    v_exp_f32 v32, v32
    v_cvt_pk_bf16_f32 v47, v126, v127
    v_exp_f32 v33, v33
    v_add_f32 v80, v80, v82
    v_mfma_f32_16x16x32_bf16 v[48:51], v[36:39], v[44:47], 0
    v_cvt_pk_bf16_f32 v40, v32, v33
    v_add_f32 v81, v81, v83
    v_mfma_f32_16x16x32_bf16 v[52:55], v[24:27], v[44:47], 0
    v_add_f32 v84, v84, v86
    v_add_f32 v85, v85, v87
    v_mfma_f32_16x16x32_bf16 v[48:51], v[36:39], v[40:43], v[48:51]
    v_cvt_pk_bf16_f32 v64, v80, v81
    v_cvt_pk_bf16_f32 v66, v84, v85
    v_mfma_f32_16x16x32_bf16 v[56:59], v[28:31], v[44:47], 0
    v_mov_b64 v[32:33], 0
    v_mov_b64 v[34:35], 0
    v_mfma_f32_16x16x32_bf16 v[52:55], v[64:67], v[40:43], v[52:55]
    v_mov_b64 v[36:37], 0
    s_nop 0
    v_rcp_f32 v60, v48
    v_mfma_f32_16x16x32_bf16 v[56:59], v[66:69], v[40:43], v[56:59]
    s_mov_b64 exec, s[96:97]
    s_nop 2
    v_mul_f32 v52, v52, v60
    v_mul_f32 v53, v53, v60
    v_mul_f32 v54, v54, v60
    v_mul_f32 v55, v55, v60
    s_not_b64 exec, exec
    v_pk_mul_f32 v[52:53], v[56:57], v[60:61] op_sel_hi:[1,0]
    v_pk_mul_f32 v[54:55], v[58:59], v[60:61] op_sel_hi:[1,0]
    s_mov_b64 exec, -1
    v_cvt_pk_bf16_f32 v56, v52, v53
    v_cvt_pk_bf16_f32 v57, v54, v55
    ds_write_b64 v5, v[56:57] offset:30720
    v_min_u32 v24, -2, v64
    v_mov_b32 v25, v65
    v_mov_b64 v[26:27], v[66:67]
    buffer_load_dwordx4 v[28:31], off, s[4:7], s82 sc1
    v_mov_b64 v[38:39], 0
    v_mov_b64 v[40:41], 0
    v_mov_b64 v[42:43], 0
    v_mov_b64 v[44:45], 0
    v_mov_b64 v[46:47], 0
    s_waitcnt lgkmcnt(0)
    s_barrier
    ds_read_b128 v[68:71], v1 offset:31744
    ds_read_b128 v[64:67], v1 offset:30720
    v_mov_b64 v[48:49], 0
    v_mov_b64 v[50:51], 0
    v_mov_b64 v[52:53], 0
    v_mov_b64 v[54:55], 0
    v_mov_b64 v[56:57], 0
    v_mov_b64 v[58:59], 0
    v_mov_b64 v[60:61], 0
    v_mov_b64 v[62:63], 0
    s_waitcnt lgkmcnt(0)
    v_smfmac_f32_16x16x64_bf16 v[32:35], v[68:71], v[88:95], v9
    ds_read_b128 v[80:83], v10 offset:10240
    v_smfmac_f32_16x16x64_bf16 v[32:35], v[64:67], v[192:199], v9
    ds_read_b128 v[84:87], v10 offset:11264
    ds_read_b128 v[120:123], v10 offset:12288
    v_smfmac_f32_16x16x64_bf16 v[36:39], v[68:71], v[96:103], v9
    ds_read_b128 v[124:127], v10 offset:13312
    ds_read_b128 v[88:91], v10 offset:14336
    v_smfmac_f32_16x16x64_bf16 v[36:39], v[64:67], v[200:207], v9
    ds_read_b128 v[92:95], v10 offset:15360
    s_nop 0
    v_add_f32 v32, v32, v34
    v_smfmac_f32_16x16x64_bf16 v[40:43], v[68:71], v[104:111], v9
    v_add_f32 v33, v33, v35
    v_cvt_pk_bf16_f32 v32, v32, v33
    v_smfmac_f32_16x16x64_bf16 v[40:43], v[64:67], v[208:215], v9
    v_or_b32 v32, 1, v32
    v_smfmac_f32_16x16x64_bf16 v[44:47], v[68:71], v[112:119], v9
    v_add_f32 v36, v36, v38
    v_add_f32 v37, v37, v39
    v_smfmac_f32_16x16x64_bf16 v[44:47], v[64:67], v[216:223], v9
    v_cvt_pk_bf16_f32 v33, v36, v37
    v_smfmac_f32_16x16x64_bf16 v[48:51], v[68:71], v[72:79], v9
    v_add_f32 v40, v40, v42
    v_add_f32 v41, v41, v43
    v_smfmac_f32_16x16x64_bf16 v[48:51], v[64:67], v[224:231], v9
    v_cvt_pk_bf16_f32 v34, v40, v41
    s_waitcnt lgkmcnt(0)
    v_smfmac_f32_16x16x64_bf16 v[52:55], v[68:71], v[80:87], v9
    v_add_f32 v44, v44, v46
    v_add_f32 v45, v45, v47
    v_smfmac_f32_16x16x64_bf16 v[52:55], v[64:67], v[232:239], v9
    v_cvt_pk_bf16_f32 v35, v44, v45
    buffer_store_dwordx4 v[32:35], v7, s[4:7], 0 offen
    v_smfmac_f32_16x16x64_bf16 v[56:59], v[68:71], v[120:127], v9
    v_add_f32 v48, v48, v50
    v_add_f32 v49, v49, v51
    v_smfmac_f32_16x16x64_bf16 v[56:59], v[64:67], v[240:247], v9
    v_cvt_pk_bf16_f32 v48, v48, v49
    v_smfmac_f32_16x16x64_bf16 v[60:63], v[64:67], v[248:255], v9
    v_or_b32 v48, 1, v48
    v_add_f32 v52, v52, v54
    v_smfmac_f32_16x16x64_bf16 v[60:63], v[68:71], v[88:95], v9
    v_add_f32 v53, v53, v55
    v_cvt_pk_bf16_f32 v49, v52, v53
    v_add_f32 v56, v56, v58
    v_add_f32 v57, v57, v59
    v_cvt_pk_bf16_f32 v50, v56, v57
    s_nop 2
    v_add_f32 v60, v60, v62
    v_add_f32 v61, v61, v63
    v_cvt_pk_bf16_f32 v51, v60, v61
    buffer_store_dwordx4 v[48:51], v7, s[4:7], s48 offen
    s_add_u32 s45, s33, 3
    s_min_u32 s45, s45, 64
    s_cmp_ge_u32 s49, s45
    s_cbranch_scc0 CL_kv10
CL_kvb10:
    ds_read_b128 v[88:91], v6 offset:0
    v_mov_b64 v[64:65], 0
    ds_read_b128 v[92:95], v6 offset:1024
    v_mov_b64 v[66:67], 0
    ds_read_b128 v[96:99], v6 offset:2048
    v_mov_b64 v[68:69], 0
    ds_read_b128 v[100:103], v6 offset:3072
    v_mov_b64 v[70:71], 0
    ds_read_b128 v[104:107], v6 offset:4096
    v_mov_b64 v[72:73], 0
    ds_read_b128 v[108:111], v6 offset:5120
    v_mov_b64 v[74:75], 0
    v_mov_b64 v[76:77], 0
    ds_read_b128 v[112:115], v6 offset:6144
    v_mov_b64 v[78:79], 0
    ds_read_b128 v[116:119], v6 offset:7168
    v_mov_b64 v[80:81], 0
    ds_read_b128 v[120:123], v6 offset:8192
    v_mov_b64 v[82:83], 0
    ds_read_b128 v[124:127], v6 offset:9216
    v_mov_b64 v[84:85], 0
    v_mov_b64 v[86:87], 0
    s_add_u32 s38, s38, 0x80000
    s_add_u32 s39, s39, 0x80000
    s_add_u32 s40, s40, 0x40000
    s_mov_b32 m0, s42
    s_mov_b32 s43, 0
    buffer_load_dwordx4 v[36:39], v2, s[4:7], s34 offen sc1
    buffer_load_dwordx4 v[40:43], v2, s[4:7], s34 offen offset:1024 sc1
    s_nop 15
    s_nop 3
    buffer_load_dwordx4 v[56:59], v2, s[4:7], s34 offen sc1
    buffer_load_dwordx4 v[60:63], v2, s[4:7], s34 offen offset:1024 sc1
    s_mov_b64 s[92:93], -1
    s_waitcnt vmcnt(2)
    v_mfma_f32_16x16x32_bf16 v[44:47], v[36:39], v[12:15], 0
    v_mfma_f32_16x16x32_bf16 v[44:47], v[40:43], v[12:15], v[44:47]
    v_and_b32 v11, v36, v40
    v_and_b32 v11, 1, v11
    v_cmp_eq_u32 vcc, 0, v11
    s_cbranch_vccnz CL_s10_p1_r
CL_s10_p1_j:
    v_mov_b32 v11, -1
    s_nop 2
    v_permlane32_swap_b32 v44, v45
    v_permlane32_swap_b32 v46, v47
    v_add_f32 v44, v44, v45
    v_add_f32 v46, v46, v47
    s_nop 1
    v_permlane16_swap_b32 v44, v46
    v_add_f32 v44, v44, v46
    v_mov_b32 v45, v44
    s_nop 1
    v_permlane32_swap_b32 v44, v45
    s_mov_b64 exec, s[98:99]
    v_cvt_pk_bf16_f32 v44, v44, v45
    v_min_u32 v44, -2, v44
    buffer_store_dword v44, v8, s[4:7], s35 offen
    buffer_store_dword v11, v8, s[4:7], s37 offen
    s_mov_b64 exec, -1
    s_sub_u32 s47, s35, 131072
    s_mov_b32 s45, s35
    s_mov_b32 s35, s36
    s_mov_b32 s36, s37
    s_mov_b32 s37, s45
    s_mov_b32 s83, s33
    s_add_u32 s33, s33, 1
    v_min_u32 v28, v28, v29
    v_min3_u32 v28, v28, v30, v31
    s_nop 0
    v_readfirstlane_b32 s45, v28
    s_nop 1
    s_lshl_b32 s45, s45, 2
    s_max_u32 s49, s49, s45
    s_add_u32 s45, s33, 8
    s_min_u32 s45, s45, 64
    s_cmp_ge_u32 s49, s45
    s_cselect_b32 s82, 268435456, s84
    s_nop 15
    s_nop 15
    s_nop 3
    s_mov_b32 s43, 0
    buffer_load_dwordx4 v[32:35], v2, s[4:7], s47 offen sc1
    buffer_load_dwordx4 v[36:39], v2, s[4:7], s47 offen offset:1024 sc1
    s_waitcnt lgkmcnt(0)
    s_branch CL_s00
CL_s01:
    s_nop 15
    s_nop 9
    buffer_load_dwordx4 v[56:59], v2, s[4:7], s47 offen sc1
    buffer_load_dwordx4 v[60:63], v2, s[4:7], s47 offen offset:1024 sc1
    s_mov_b64 s[92:93], -1
    s_waitcnt vmcnt(2)
    ds_write_b128 v2, v[32:35] offset:0
    ds_write_b128 v2, v[36:39] offset:1024
    v_max3_u32 v44, v32, v33, v34
    v_max3_u32 v45, v35, v36, v37
    v_max3_u32 v44, v44, v38, v39
    v_max_u32 v44, v44, v45
    v_cmp_eq_u32 vcc, -1, v44
    s_cbranch_vccnz CL_s01_p2_r
CL_s01_p2_j:
    v_smfmac_f32_16x16x64_bf16 v[64:67], v[32:35], v[88:95], v9
    v_xor_b32 v52, 2048, v2
    v_smfmac_f32_16x16x64_bf16 v[68:71], v[32:35], v[96:103], v9
    v_xor_b32 v53, 4096, v2
    v_smfmac_f32_16x16x64_bf16 v[64:67], v[36:39], v[104:111], v9
    v_xor_b32 v11, 6144, v2
    ds_read_b128 v[88:91], v6 offset:10240
    v_smfmac_f32_16x16x64_bf16 v[68:71], v[36:39], v[112:119], v9
    ds_read_b128 v[92:95], v6 offset:11264
    v_smfmac_f32_16x16x64_bf16 v[72:75], v[32:35], a[0:7], v9
    ds_read_b128 v[96:99], v6 offset:12288
    v_smfmac_f32_16x16x64_bf16 v[76:79], v[32:35], a[64:71], v9
    ds_read_b128 v[100:103], v6 offset:13312
    s_waitcnt lgkmcnt(4)
    s_barrier
    ds_read_b128 v[40:43], v52 offset:0
    ds_read_b128 v[44:47], v52 offset:1024
    v_smfmac_f32_16x16x64_bf16 v[72:75], v[36:39], a[8:15], v9
    ds_read_b128 v[48:51], v53 offset:0
    v_smfmac_f32_16x16x64_bf16 v[76:79], v[36:39], a[72:79], v9
    ds_read_b128 v[52:55], v53 offset:1024
    v_smfmac_f32_16x16x64_bf16 v[80:83], v[32:35], a[128:135], v9
    s_waitcnt vmcnt(0)
    ds_read_b128 v[56:59], v11 offset:0
    v_smfmac_f32_16x16x64_bf16 v[84:87], v[32:35], a[192:199], v9
    ds_read_b128 v[60:63], v11 offset:1024
    s_waitcnt lgkmcnt(4)
    v_smfmac_f32_16x16x64_bf16 v[64:67], v[40:43], v[120:127], v9
    ds_read_b128 v[104:107], v6 offset:14336
    v_smfmac_f32_16x16x64_bf16 v[64:67], v[44:47], v[88:95], v9
    ds_read_b128 v[108:111], v6 offset:15360
    s_waitcnt lgkmcnt(4)
    v_smfmac_f32_16x16x64_bf16 v[64:67], v[48:51], v[128:135], v9
    buffer_store_dwordx4 v[24:27], v2, s[4:7], s40 offen sc0 sc1
    v_smfmac_f32_16x16x64_bf16 v[64:67], v[52:55], v[136:143], v9
    s_waitcnt lgkmcnt(2)
    ds_read_b128 v[112:115], v1 offset:12288
    v_smfmac_f32_16x16x64_bf16 v[64:67], v[56:59], v[144:151], v9
    ds_read_b128 v[116:119], v1 offset:13312
    v_mov_b32 v11, s83
    v_smfmac_f32_16x16x64_bf16 v[64:67], v[60:63], v[152:159], v9
    buffer_load_dwordx4 v[24:27], v2, s[4:7], s39 offen sc1
    s_waitcnt lgkmcnt(2)
    v_smfmac_f32_16x16x64_bf16 v[68:71], v[40:43], v[96:103], v9
    buffer_store_dword v11, off, s[4:7], s85 sc0 sc1
    v_smfmac_f32_16x16x64_bf16 v[68:71], v[44:47], v[104:111], v9
    ds_read_b128 v[96:99], v1 offset:8192
    v_smfmac_f32_16x16x64_bf16 v[68:71], v[48:51], v[160:167], v9
    ds_read_b128 v[100:103], v1 offset:9216
    v_add_f32 v64, v64, v66
    v_smfmac_f32_16x16x64_bf16 v[68:71], v[52:55], v[168:175], v9
    ds_read_b128 v[104:107], v1 offset:10240
    v_add_f32 v65, v65, v67
    v_smfmac_f32_16x16x64_bf16 v[68:71], v[56:59], v[176:183], v9
    ds_read_b128 v[108:111], v1 offset:11264
    v_cvt_pk_bf16_f32 v66, v64, v65
    v_smfmac_f32_16x16x64_bf16 v[68:71], v[60:63], v[184:191], v9
    buffer_load_dwordx4 v[28:31], v2, s[4:7], s39 offen offset:1024 sc1
    v_lshl_add_u32 v11, v3, 1, s44
    v_smfmac_f32_16x16x64_bf16 v[72:75], v[40:43], a[16:23], v9
    buffer_load_dwordx4 v2, s[4:7], s38 offen sc1 lds
    v_smfmac_f32_16x16x64_bf16 v[72:75], v[44:47], a[24:31], v9
    v_smfmac_f32_16x16x64_bf16 v[72:75], v[48:51], a[32:39], v9
    v_add_f32 v68, v68, v70
    v_smfmac_f32_16x16x64_bf16 v[72:75], v[52:55], a[40:47], v9
    v_add_f32 v69, v69, v71
    v_smfmac_f32_16x16x64_bf16 v[72:75], v[56:59], a[48:55], v9
    v_cvt_pk_bf16_f32 v67, v68, v69
    ds_write2_b32 v3, v66, v67 offset1:64
    v_smfmac_f32_16x16x64_bf16 v[72:75], v[60:63], a[56:63], v9
    buffer_load_dwordx4 v2, s[4:7], s38 offen offset:1024 sc1 lds
    v_smfmac_f32_16x16x64_bf16 v[76:79], v[40:43], a[80:87], v9
    v_smfmac_f32_16x16x64_bf16 v[76:79], v[44:47], a[88:95], v9
    v_smfmac_f32_16x16x64_bf16 v[76:79], v[48:51], a[96:103], v9
    v_add_f32 v72, v72, v74
    v_smfmac_f32_16x16x64_bf16 v[76:79], v[52:55], a[104:111], v9
    v_add_f32 v73, v73, v75
    s_waitcnt lgkmcnt(0)
    s_barrier
    ds_read_b64_tr_b16 v[64:65], v4 offset:0
    v_smfmac_f32_16x16x64_bf16 v[76:79], v[56:59], a[112:119], v9
    v_cvt_pk_bf16_f32 v73, v72, v73
    ds_read_b64_tr_b16 v[66:67], v4 offset:256
    v_smfmac_f32_16x16x64_bf16 v[76:79], v[60:63], a[120:127], v9
    ds_read_b64_tr_b16 v[68:69], v4 offset:512
    ds_read_b64_tr_b16 v[70:71], v4 offset:768
    v_smfmac_f32_16x16x64_bf16 v[80:83], v[36:39], a[136:143], v9
    ds_read_b64_tr_b16 v[88:89], v4 offset:1024
    ds_read_b64_tr_b16 v[90:91], v4 offset:1280
    v_smfmac_f32_16x16x64_bf16 v[84:87], v[36:39], a[200:207], v9
    ds_read_b64_tr_b16 v[92:93], v4 offset:1536
    v_smfmac_f32_16x16x64_bf16 v[80:83], v[40:43], a[144:151], v9
    ds_read_b64_tr_b16 v[94:95], v4 offset:1792
    s_waitcnt lgkmcnt(4)
    v_add_f32 v76, v76, v78
    v_add_f32 v77, v77, v79
    v_mfma_f32_16x16x32_bf16 v[120:123], v[96:99], v[64:67], 0
    v_cvt_pk_bf16_f32 v75, v76, v77
    ds_write2_b32 v11, v73, v75 offset1:128
    v_mfma_f32_16x16x32_bf16 v[120:123], v[100:103], v[68:71], v[120:123]
    v_mfma_f32_16x16x32_bf16 v[124:127], v[112:115], v[64:67], 0
    ds_read_b128 v[96:99], v1 offset:14336
    ds_read_b128 v[100:103], v1 offset:15360
    v_mfma_f32_16x16x32_bf16 v[124:127], v[116:119], v[68:71], v[124:127]
    s_waitcnt lgkmcnt(3)
    v_mfma_f32_16x16x32_bf16 v[120:123], v[104:107], v[88:91], v[120:123]
    v_mfma_f32_16x16x32_bf16 v[120:123], v[108:111], v[92:95], v[120:123]
    s_waitcnt lgkmcnt(2)
    s_barrier
    ds_read_b64_tr_b16 v[104:105], v0 offset:0
    v_smfmac_f32_16x16x64_bf16 v[84:87], v[40:43], a[208:215], v9
    ds_read_b64_tr_b16 v[106:107], v0 offset:512
    ds_read_b64_tr_b16 v[108:109], v0 offset:1024
    s_waitcnt lgkmcnt(3)
    v_mfma_f32_16x16x32_bf16 v[124:127], v[96:99], v[88:91], v[124:127]
    ds_read_b64_tr_b16 v[110:111], v0 offset:1536
    ds_read_b64_tr_b16 v[112:113], v0 offset:2048
    v_mfma_f32_16x16x32_bf16 v[124:127], v[100:103], v[92:95], v[124:127]
    ds_read_b64_tr_b16 v[114:115], v0 offset:2560
    ds_read_b64_tr_b16 v[116:117], v0 offset:3072
    v_smfmac_f32_16x16x64_bf16 v[80:83], v[44:47], a[152:159], v9
    ds_read_b64_tr_b16 v[118:119], v0 offset:3584
    v_smfmac_f32_16x16x64_bf16 v[84:87], v[44:47], a[216:223], v9
    v_smfmac_f32_16x16x64_bf16 v[80:83], v[48:51], a[160:167], v9
    s_waitcnt lgkmcnt(4)
    v_mfma_f32_16x16x32_bf16 v[32:35], v[104:107], v[64:67], 0
    v_max3_f32 v78, v120, v121, v122
    v_max3_f32 v78, v78, v123, v124
    v_mfma_f32_16x16x32_bf16 v[32:35], v[108:111], v[68:71], v[32:35]
    v_max3_f32 v78, v78, v125, v126
    s_waitcnt lgkmcnt(0)
    v_mfma_f32_16x16x32_bf16 v[32:35], v[112:115], v[88:91], v[32:35]
    v_max_f32 v78, v78, v127
    v_mov_b32 v65, v73
    v_mfma_f32_16x16x32_bf16 v[32:35], v[116:119], v[92:95], v[32:35]
    v_mov_b32 v67, v75
    v_mov_b64 v[68:69], 0
    v_smfmac_f32_16x16x64_bf16 v[84:87], v[48:51], a[224:231], v9
    ds_read_b128 v[96:99], v10 offset:2048
    v_mov_b32 v41, 0
    v_smfmac_f32_16x16x64_bf16 v[80:83], v[52:55], a[168:175], v9
    ds_read_b128 v[100:103], v10 offset:3072
    v_mov_b64 v[42:43], 0
    v_smfmac_f32_16x16x64_bf16 v[84:87], v[52:55], a[232:239], v9
    ds_read_b128 v[88:91], v10 offset:0
    v_max3_f32 v70, v78, v32, v33
    v_smfmac_f32_16x16x64_bf16 v[80:83], v[56:59], a[176:183], v9
    ds_read_b128 v[92:95], v10 offset:1024
    v_mov_b32 v71, v70
    v_smfmac_f32_16x16x64_bf16 v[84:87], v[56:59], a[240:247], v9
    ds_read_b128 v[104:107], v10 offset:4096
    v_mov_b64 v[36:37], s[90:91]
    v_smfmac_f32_16x16x64_bf16 v[80:83], v[60:63], a[184:191], v9
    ds_read_b128 v[108:111], v10 offset:5120
    v_permlane32_swap_b32 v70, v71
    v_smfmac_f32_16x16x64_bf16 v[84:87], v[60:63], a[248:255], v9
    ds_read_b128 v[112:115], v10 offset:6144
    v_max_f32 v70, v70, v71
    v_mov_b32 v71, v70
    ds_read_b128 v[116:119], v10 offset:7168
    v_mov_b64 v[38:39], s[90:91]
    v_permlane16_swap_b32 v70, v71
    v_max_f32 v70, v70, v71
    v_mul_f32 v70, s50, v70
    v_pk_fma_f32 v[120:121], v[120:121], s[50:51], v[70:71] op_sel_hi:[1,1,0] neg_lo:[0,0,1] neg_hi:[0,0,1]
    v_pk_fma_f32 v[122:123], v[122:123], s[50:51], v[70:71] op_sel_hi:[1,1,0] neg_lo:[0,0,1] neg_hi:[0,0,1]
    v_pk_fma_f32 v[124:125], v[124:125], s[50:51], v[70:71] op_sel_hi:[1,1,0] neg_lo:[0,0,1] neg_hi:[0,0,1]
    v_pk_fma_f32 v[126:127], v[126:127], s[50:51], v[70:71] op_sel_hi:[1,1,0] neg_lo:[0,0,1] neg_hi:[0,0,1]
    v_pk_fma_f32 v[32:33], v[32:33], s[50:51], v[70:71] op_sel_hi:[1,1,0] neg_lo:[0,0,1] neg_hi:[0,0,1]
    v_exp_f32 v120, v120
    v_exp_f32 v121, v121
    v_exp_f32 v122, v122
    ds_read_b128 v[72:75], v10 offset:8192
    v_exp_f32 v123, v123
    v_cvt_pk_bf16_f32 v44, v120, v121
    v_exp_f32 v124, v124
    ds_read_b128 v[76:79], v10 offset:9216
    v_exp_f32 v125, v125
    v_cvt_pk_bf16_f32 v45, v122, v123
    v_exp_f32 v126, v126
    v_exp_f32 v127, v127
    v_cvt_pk_bf16_f32 v46, v124, v125
    v_exp_f32 v32, v32
    v_cvt_pk_bf16_f32 v47, v126, v127
    v_exp_f32 v33, v33
    v_add_f32 v80, v80, v82
    v_mfma_f32_16x16x32_bf16 v[48:51], v[36:39], v[44:47], 0
    v_cvt_pk_bf16_f32 v40, v32, v33
    v_add_f32 v81, v81, v83
    v_mfma_f32_16x16x32_bf16 v[52:55], v[16:19], v[44:47], 0
    v_add_f32 v84, v84, v86
    v_add_f32 v85, v85, v87
    v_mfma_f32_16x16x32_bf16 v[48:51], v[36:39], v[40:43], v[48:51]
    v_cvt_pk_bf16_f32 v64, v80, v81
    v_cvt_pk_bf16_f32 v66, v84, v85
    v_mfma_f32_16x16x32_bf16 v[56:59], v[20:23], v[44:47], 0
    v_mov_b64 v[32:33], 0
    v_mov_b64 v[34:35], 0
    v_mfma_f32_16x16x32_bf16 v[52:55], v[64:67], v[40:43], v[52:55]
    v_mov_b64 v[36:37], 0
    s_nop 0
    v_rcp_f32 v60, v48
    v_mfma_f32_16x16x32_bf16 v[56:59], v[66:69], v[40:43], v[56:59]
    s_mov_b64 exec, s[96:97]
    s_nop 2
    v_mul_f32 v52, v52, v60
    v_mul_f32 v53, v53, v60
    v_mul_f32 v54, v54, v60
    v_mul_f32 v55, v55, v60
    s_not_b64 exec, exec
    v_pk_mul_f32 v[52:53], v[56:57], v[60:61] op_sel_hi:[1,0]
    v_pk_mul_f32 v[54:55], v[58:59], v[60:61] op_sel_hi:[1,0]
    s_mov_b64 exec, -1
    v_cvt_pk_bf16_f32 v56, v52, v53
    v_cvt_pk_bf16_f32 v57, v54, v55
    ds_write_b64 v5, v[56:57] offset:30720
    v_min_u32 v16, -2, v64
    v_mov_b32 v17, v65
    v_mov_b64 v[18:19], v[66:67]
    buffer_load_dwordx4 v[20:23], off, s[4:7], s82 sc1
    v_mov_b64 v[38:39], 0
    v_mov_b64 v[40:41], 0
    v_mov_b64 v[42:43], 0
    v_mov_b64 v[44:45], 0
    v_mov_b64 v[46:47], 0
    s_waitcnt lgkmcnt(0)
    s_barrier
    ds_read_b128 v[68:71], v1 offset:31744
    ds_read_b128 v[64:67], v1 offset:30720
    v_mov_b64 v[48:49], 0
    v_mov_b64 v[50:51], 0
    v_mov_b64 v[52:53], 0
    v_mov_b64 v[54:55], 0
    v_mov_b64 v[56:57], 0
    v_mov_b64 v[58:59], 0
    v_mov_b64 v[60:61], 0
    v_mov_b64 v[62:63], 0
    s_waitcnt lgkmcnt(0)
    v_smfmac_f32_16x16x64_bf16 v[32:35], v[68:71], v[88:95], v9
    ds_read_b128 v[80:83], v10 offset:10240
    v_smfmac_f32_16x16x64_bf16 v[32:35], v[64:67], v[192:199], v9
    ds_read_b128 v[84:87], v10 offset:11264
    ds_read_b128 v[120:123], v10 offset:12288
    v_smfmac_f32_16x16x64_bf16 v[36:39], v[68:71], v[96:103], v9
    ds_read_b128 v[124:127], v10 offset:13312
    ds_read_b128 v[88:91], v10 offset:14336
    v_smfmac_f32_16x16x64_bf16 v[36:39], v[64:67], v[200:207], v9
    ds_read_b128 v[92:95], v10 offset:15360
    s_nop 0
    v_add_f32 v32, v32, v34
    v_smfmac_f32_16x16x64_bf16 v[40:43], v[68:71], v[104:111], v9
    v_add_f32 v33, v33, v35
    v_cvt_pk_bf16_f32 v32, v32, v33
    v_smfmac_f32_16x16x64_bf16 v[40:43], v[64:67], v[208:215], v9
    v_and_b32 v32, -2, v32
    v_smfmac_f32_16x16x64_bf16 v[44:47], v[68:71], v[112:119], v9
    v_add_f32 v36, v36, v38
    v_add_f32 v37, v37, v39
    v_smfmac_f32_16x16x64_bf16 v[44:47], v[64:67], v[216:223], v9
    v_cvt_pk_bf16_f32 v33, v36, v37
    v_smfmac_f32_16x16x64_bf16 v[48:51], v[68:71], v[72:79], v9
    v_add_f32 v40, v40, v42
    v_add_f32 v41, v41, v43
    v_smfmac_f32_16x16x64_bf16 v[48:51], v[64:67], v[224:231], v9
    v_cvt_pk_bf16_f32 v34, v40, v41
    s_waitcnt lgkmcnt(0)
    v_smfmac_f32_16x16x64_bf16 v[52:55], v[68:71], v[80:87], v9
    v_add_f32 v44, v44, v46
    v_add_f32 v45, v45, v47
    v_smfmac_f32_16x16x64_bf16 v[52:55], v[64:67], v[232:239], v9
    v_cvt_pk_bf16_f32 v35, v44, v45
    buffer_store_dwordx4 v[32:35], v7, s[4:7], 0 offen sc0 sc1
    v_smfmac_f32_16x16x64_bf16 v[56:59], v[68:71], v[120:127], v9
    v_add_f32 v48, v48, v50
    v_add_f32 v49, v49, v51
    v_smfmac_f32_16x16x64_bf16 v[56:59], v[64:67], v[240:247], v9
    v_cvt_pk_bf16_f32 v48, v48, v49
    v_smfmac_f32_16x16x64_bf16 v[60:63], v[64:67], v[248:255], v9
    v_and_b32 v48, -2, v48
    v_add_f32 v52, v52, v54
    v_smfmac_f32_16x16x64_bf16 v[60:63], v[68:71], v[88:95], v9
    v_add_f32 v53, v53, v55
    v_cvt_pk_bf16_f32 v49, v52, v53
    v_add_f32 v56, v56, v58
    v_add_f32 v57, v57, v59
    v_cvt_pk_bf16_f32 v50, v56, v57
    s_nop 2
    v_add_f32 v60, v60, v62
    v_add_f32 v61, v61, v63
    v_cvt_pk_bf16_f32 v51, v60, v61
    buffer_store_dwordx4 v[48:51], v7, s[4:7], s48 offen sc0 sc1
    s_add_u32 s45, s33, 3
    s_min_u32 s45, s45, 64
    s_cmp_ge_u32 s49, s45
    s_cbranch_scc0 CL_kv01
CL_kvb01:
    ds_read_b128 v[88:91], v6 offset:0
    v_mov_b64 v[64:65], 0
    ds_read_b128 v[92:95], v6 offset:1024
    v_mov_b64 v[66:67], 0
    ds_read_b128 v[96:99], v6 offset:2048
    v_mov_b64 v[68:69], 0
    ds_read_b128 v[100:103], v6 offset:3072
    v_mov_b64 v[70:71], 0
    ds_read_b128 v[104:107], v6 offset:4096
    v_mov_b64 v[72:73], 0
    ds_read_b128 v[108:111], v6 offset:5120
    v_mov_b64 v[74:75], 0
    v_mov_b64 v[76:77], 0
    ds_read_b128 v[112:115], v6 offset:6144
    v_mov_b64 v[78:79], 0
    ds_read_b128 v[116:119], v6 offset:7168
    v_mov_b64 v[80:81], 0
    ds_read_b128 v[120:123], v6 offset:8192
    v_mov_b64 v[82:83], 0
    ds_read_b128 v[124:127], v6 offset:9216
    v_mov_b64 v[84:85], 0
    v_mov_b64 v[86:87], 0
    s_add_u32 s38, s38, 0x80000
    s_add_u32 s39, s39, 0x80000
    s_add_u32 s40, s40, 0x40000
    s_mov_b32 m0, s41
    s_mov_b32 s43, 0
    buffer_load_dwordx4 v[36:39], v2, s[4:7], s34 offen sc1
    buffer_load_dwordx4 v[40:43], v2, s[4:7], s34 offen offset:1024 sc1
    s_nop 15
    s_nop 3
    buffer_load_dwordx4 v[56:59], v2, s[4:7], s34 offen sc1
    buffer_load_dwordx4 v[60:63], v2, s[4:7], s34 offen offset:1024 sc1
    s_mov_b64 s[92:93], -1
    s_waitcnt vmcnt(2)
    v_mfma_f32_16x16x32_bf16 v[44:47], v[36:39], v[12:15], 0
    v_mfma_f32_16x16x32_bf16 v[44:47], v[40:43], v[12:15], v[44:47]
    v_or_b32 v11, v36, v40
    v_and_b32 v11, 1, v11
    v_cmp_ne_u32 vcc, 0, v11
    s_cbranch_vccnz CL_s01_p1_r
CL_s01_p1_j:
    v_mov_b32 v11, -1
    s_nop 2
    v_permlane32_swap_b32 v44, v45
    v_permlane32_swap_b32 v46, v47
    v_add_f32 v44, v44, v45
    v_add_f32 v46, v46, v47
    s_nop 1
    v_permlane16_swap_b32 v44, v46
    v_add_f32 v44, v44, v46
    v_mov_b32 v45, v44
    s_nop 1
    v_permlane32_swap_b32 v44, v45
    s_mov_b64 exec, s[98:99]
    v_cvt_pk_bf16_f32 v44, v44, v45
    v_min_u32 v44, -2, v44
    buffer_store_dword v44, v8, s[4:7], s35 offen sc0 sc1
    buffer_store_dword v11, v8, s[4:7], s37 offen sc0 sc1
    s_mov_b64 exec, -1
    s_sub_u32 s47, s35, 131072
    s_mov_b32 s45, s35
    s_mov_b32 s35, s36
    s_mov_b32 s36, s37
    s_mov_b32 s37, s45
    s_mov_b32 s83, s33
    s_add_u32 s33, s33, 1
    v_min_u32 v20, v20, v21
    v_min3_u32 v20, v20, v22, v23
    s_nop 0
    v_readfirstlane_b32 s45, v20
    s_nop 1
    s_lshl_b32 s45, s45, 2
    s_max_u32 s49, s49, s45
    s_add_u32 s45, s33, 8
    s_min_u32 s45, s45, 64
    s_cmp_ge_u32 s49, s45
    s_cselect_b32 s82, 268435456, s84
    s_nop 15
    s_nop 15
    s_nop 3
    s_mov_b32 s43, 0
    buffer_load_dwordx4 v[32:35], v2, s[4:7], s47 offen sc1
    buffer_load_dwordx4 v[36:39], v2, s[4:7], s47 offen offset:1024 sc1
    s_waitcnt lgkmcnt(0)
    s_cmp_eq_u32 s33, 63
    s_cbranch_scc1 CL_chain_last
CL_s11:
    s_nop 15
    s_nop 11
    buffer_load_dwordx4 v[56:59], v2, s[4:7], s47 offen sc1
    buffer_load_dwordx4 v[60:63], v2, s[4:7], s47 offen offset:1024 sc1
    s_mov_b64 s[92:93], -1
    s_waitcnt vmcnt(2)
    ds_write_b128 v2, v[32:35] offset:0
    ds_write_b128 v2, v[36:39] offset:1024
    v_max3_u32 v44, v32, v33, v34
    v_max3_u32 v45, v35, v36, v37
    v_max3_u32 v44, v44, v38, v39
    v_max_u32 v44, v44, v45
    v_cmp_eq_u32 vcc, -1, v44
    s_cbranch_vccnz CL_s11_p2_r
CL_s11_p2_j:
    v_smfmac_f32_16x16x64_bf16 v[64:67], v[32:35], v[88:95], v9
    v_xor_b32 v52, 2048, v2
    v_smfmac_f32_16x16x64_bf16 v[68:71], v[32:35], v[96:103], v9
    v_xor_b32 v53, 4096, v2
    v_smfmac_f32_16x16x64_bf16 v[64:67], v[36:39], v[104:111], v9
    v_xor_b32 v11, 6144, v2
    ds_read_b128 v[88:91], v6 offset:10240
    v_smfmac_f32_16x16x64_bf16 v[68:71], v[36:39], v[112:119], v9
    ds_read_b128 v[92:95], v6 offset:11264
    v_smfmac_f32_16x16x64_bf16 v[72:75], v[32:35], a[0:7], v9
    ds_read_b128 v[96:99], v6 offset:12288
    v_smfmac_f32_16x16x64_bf16 v[76:79], v[32:35], a[64:71], v9
    ds_read_b128 v[100:103], v6 offset:13312
    s_waitcnt lgkmcnt(4)
    s_barrier
    ds_read_b128 v[40:43], v52 offset:0
    ds_read_b128 v[44:47], v52 offset:1024
    v_smfmac_f32_16x16x64_bf16 v[72:75], v[36:39], a[8:15], v9
    ds_read_b128 v[48:51], v53 offset:0
    v_smfmac_f32_16x16x64_bf16 v[76:79], v[36:39], a[72:79], v9
    ds_read_b128 v[52:55], v53 offset:1024
    v_smfmac_f32_16x16x64_bf16 v[80:83], v[32:35], a[128:135], v9
    s_waitcnt vmcnt(0)
    ds_read_b128 v[56:59], v11 offset:0
    v_smfmac_f32_16x16x64_bf16 v[84:87], v[32:35], a[192:199], v9
    ds_read_b128 v[60:63], v11 offset:1024
    s_waitcnt lgkmcnt(4)
    v_smfmac_f32_16x16x64_bf16 v[64:67], v[40:43], v[120:127], v9
    ds_read_b128 v[104:107], v6 offset:14336
    v_smfmac_f32_16x16x64_bf16 v[64:67], v[44:47], v[88:95], v9
    ds_read_b128 v[108:111], v6 offset:15360
    s_waitcnt lgkmcnt(4)
    v_smfmac_f32_16x16x64_bf16 v[64:67], v[48:51], v[128:135], v9
    buffer_store_dwordx4 v[16:19], v2, s[4:7], s40 offen sc0 sc1
    v_smfmac_f32_16x16x64_bf16 v[64:67], v[52:55], v[136:143], v9
    s_waitcnt lgkmcnt(2)
    ds_read_b128 v[112:115], v1 offset:20480
    v_smfmac_f32_16x16x64_bf16 v[64:67], v[56:59], v[144:151], v9
    ds_read_b128 v[116:119], v1 offset:21504
    v_mov_b32 v11, s83
    v_smfmac_f32_16x16x64_bf16 v[64:67], v[60:63], v[152:159], v9
    buffer_load_dwordx4 v[16:19], v2, s[4:7], s39 offen sc1
    s_waitcnt lgkmcnt(2)
    v_smfmac_f32_16x16x64_bf16 v[68:71], v[40:43], v[96:103], v9
    buffer_store_dword v11, off, s[4:7], s85 sc0 sc1
    v_smfmac_f32_16x16x64_bf16 v[68:71], v[44:47], v[104:111], v9
    ds_read_b128 v[96:99], v1 offset:16384
    v_smfmac_f32_16x16x64_bf16 v[68:71], v[48:51], v[160:167], v9
    ds_read_b128 v[100:103], v1 offset:17408
    v_add_f32 v64, v64, v66
    v_smfmac_f32_16x16x64_bf16 v[68:71], v[52:55], v[168:175], v9
    ds_read_b128 v[104:107], v1 offset:18432
    v_add_f32 v65, v65, v67
    v_smfmac_f32_16x16x64_bf16 v[68:71], v[56:59], v[176:183], v9
    ds_read_b128 v[108:111], v1 offset:19456
    v_cvt_pk_bf16_f32 v66, v64, v65
    v_smfmac_f32_16x16x64_bf16 v[68:71], v[60:63], v[184:191], v9
    buffer_load_dwordx4 v[20:23], v2, s[4:7], s39 offen offset:1024 sc1
    v_lshl_add_u32 v11, v3, 1, s44
    v_smfmac_f32_16x16x64_bf16 v[72:75], v[40:43], a[16:23], v9
    buffer_load_dwordx4 v2, s[4:7], s38 offen sc1 lds
    v_smfmac_f32_16x16x64_bf16 v[72:75], v[44:47], a[24:31], v9
    v_smfmac_f32_16x16x64_bf16 v[72:75], v[48:51], a[32:39], v9
    v_add_f32 v68, v68, v70
    v_smfmac_f32_16x16x64_bf16 v[72:75], v[52:55], a[40:47], v9
    v_add_f32 v69, v69, v71
    v_smfmac_f32_16x16x64_bf16 v[72:75], v[56:59], a[48:55], v9
    v_cvt_pk_bf16_f32 v67, v68, v69
    ds_write2_b32 v3, v66, v67 offset1:64
    v_smfmac_f32_16x16x64_bf16 v[72:75], v[60:63], a[56:63], v9
    buffer_load_dwordx4 v2, s[4:7], s38 offen offset:1024 sc1 lds
    v_smfmac_f32_16x16x64_bf16 v[76:79], v[40:43], a[80:87], v9
    v_smfmac_f32_16x16x64_bf16 v[76:79], v[44:47], a[88:95], v9
    v_smfmac_f32_16x16x64_bf16 v[76:79], v[48:51], a[96:103], v9
    v_add_f32 v72, v72, v74
    v_smfmac_f32_16x16x64_bf16 v[76:79], v[52:55], a[104:111], v9
    v_add_f32 v73, v73, v75
    s_waitcnt lgkmcnt(0)
    s_barrier
    ds_read_b64_tr_b16 v[64:65], v4 offset:0
    v_smfmac_f32_16x16x64_bf16 v[76:79], v[56:59], a[112:119], v9
    v_cvt_pk_bf16_f32 v73, v72, v73
    ds_read_b64_tr_b16 v[66:67], v4 offset:256
    v_smfmac_f32_16x16x64_bf16 v[76:79], v[60:63], a[120:127], v9
    ds_read_b64_tr_b16 v[68:69], v4 offset:512
    ds_read_b64_tr_b16 v[70:71], v4 offset:768
    v_smfmac_f32_16x16x64_bf16 v[80:83], v[36:39], a[136:143], v9
    ds_read_b64_tr_b16 v[88:89], v4 offset:1024
    ds_read_b64_tr_b16 v[90:91], v4 offset:1280
    v_smfmac_f32_16x16x64_bf16 v[84:87], v[36:39], a[200:207], v9
    ds_read_b64_tr_b16 v[92:93], v4 offset:1536
    v_smfmac_f32_16x16x64_bf16 v[80:83], v[40:43], a[144:151], v9
    ds_read_b64_tr_b16 v[94:95], v4 offset:1792
    s_waitcnt lgkmcnt(4)
    v_add_f32 v76, v76, v78
    v_add_f32 v77, v77, v79
    v_mfma_f32_16x16x32_bf16 v[120:123], v[96:99], v[64:67], 0
    v_cvt_pk_bf16_f32 v75, v76, v77
    ds_write2_b32 v11, v73, v75 offset1:128
    v_mfma_f32_16x16x32_bf16 v[120:123], v[100:103], v[68:71], v[120:123]
    v_mfma_f32_16x16x32_bf16 v[124:127], v[112:115], v[64:67], 0
    ds_read_b128 v[96:99], v1 offset:22528
    ds_read_b128 v[100:103], v1 offset:23552
    v_mfma_f32_16x16x32_bf16 v[124:127], v[116:119], v[68:71], v[124:127]
    s_waitcnt lgkmcnt(3)
    v_mfma_f32_16x16x32_bf16 v[120:123], v[104:107], v[88:91], v[120:123]
    v_mfma_f32_16x16x32_bf16 v[120:123], v[108:111], v[92:95], v[120:123]
    s_waitcnt lgkmcnt(2)
    s_barrier
    ds_read_b64_tr_b16 v[104:105], v0 offset:0
    v_smfmac_f32_16x16x64_bf16 v[84:87], v[40:43], a[208:215], v9
    ds_read_b64_tr_b16 v[106:107], v0 offset:512
    ds_read_b64_tr_b16 v[108:109], v0 offset:1024
    s_waitcnt lgkmcnt(3)
    v_mfma_f32_16x16x32_bf16 v[124:127], v[96:99], v[88:91], v[124:127]
    ds_read_b64_tr_b16 v[110:111], v0 offset:1536
    ds_read_b64_tr_b16 v[112:113], v0 offset:2048
    v_mfma_f32_16x16x32_bf16 v[124:127], v[100:103], v[92:95], v[124:127]
    ds_read_b64_tr_b16 v[114:115], v0 offset:2560
    ds_read_b64_tr_b16 v[116:117], v0 offset:3072
    v_smfmac_f32_16x16x64_bf16 v[80:83], v[44:47], a[152:159], v9
    ds_read_b64_tr_b16 v[118:119], v0 offset:3584
    v_smfmac_f32_16x16x64_bf16 v[84:87], v[44:47], a[216:223], v9
    v_smfmac_f32_16x16x64_bf16 v[80:83], v[48:51], a[160:167], v9
    s_waitcnt lgkmcnt(4)
    v_mfma_f32_16x16x32_bf16 v[32:35], v[104:107], v[64:67], 0
    v_max3_f32 v78, v120, v121, v122
    v_max3_f32 v78, v78, v123, v124
    v_mfma_f32_16x16x32_bf16 v[32:35], v[108:111], v[68:71], v[32:35]
    v_max3_f32 v78, v78, v125, v126
    s_waitcnt lgkmcnt(0)
    v_mfma_f32_16x16x32_bf16 v[32:35], v[112:115], v[88:91], v[32:35]
    v_max_f32 v78, v78, v127
    v_mov_b32 v65, v73
    v_mfma_f32_16x16x32_bf16 v[32:35], v[116:119], v[92:95], v[32:35]
    v_mov_b32 v67, v75
    v_mov_b64 v[68:69], 0
    v_smfmac_f32_16x16x64_bf16 v[84:87], v[48:51], a[224:231], v9
    ds_read_b128 v[96:99], v10 offset:2048
    v_mov_b32 v41, 0
    v_smfmac_f32_16x16x64_bf16 v[80:83], v[52:55], a[168:175], v9
    ds_read_b128 v[100:103], v10 offset:3072
    v_mov_b64 v[42:43], 0
    v_smfmac_f32_16x16x64_bf16 v[84:87], v[52:55], a[232:239], v9
    ds_read_b128 v[88:91], v10 offset:0
    v_max3_f32 v70, v78, v32, v33
    v_smfmac_f32_16x16x64_bf16 v[80:83], v[56:59], a[176:183], v9
    ds_read_b128 v[92:95], v10 offset:1024
    v_mov_b32 v71, v70
    v_smfmac_f32_16x16x64_bf16 v[84:87], v[56:59], a[240:247], v9
    ds_read_b128 v[104:107], v10 offset:4096
    v_mov_b64 v[36:37], s[90:91]
    v_smfmac_f32_16x16x64_bf16 v[80:83], v[60:63], a[184:191], v9
    ds_read_b128 v[108:111], v10 offset:5120
    v_permlane32_swap_b32 v70, v71
    v_smfmac_f32_16x16x64_bf16 v[84:87], v[60:63], a[248:255], v9
    ds_read_b128 v[112:115], v10 offset:6144
    v_max_f32 v70, v70, v71
    v_mov_b32 v71, v70
    ds_read_b128 v[116:119], v10 offset:7168
    v_mov_b64 v[38:39], s[90:91]
    v_permlane16_swap_b32 v70, v71
    v_max_f32 v70, v70, v71
    v_mul_f32 v70, s50, v70
    v_pk_fma_f32 v[120:121], v[120:121], s[50:51], v[70:71] op_sel_hi:[1,1,0] neg_lo:[0,0,1] neg_hi:[0,0,1]
    v_pk_fma_f32 v[122:123], v[122:123], s[50:51], v[70:71] op_sel_hi:[1,1,0] neg_lo:[0,0,1] neg_hi:[0,0,1]
    v_pk_fma_f32 v[124:125], v[124:125], s[50:51], v[70:71] op_sel_hi:[1,1,0] neg_lo:[0,0,1] neg_hi:[0,0,1]
    v_pk_fma_f32 v[126:127], v[126:127], s[50:51], v[70:71] op_sel_hi:[1,1,0] neg_lo:[0,0,1] neg_hi:[0,0,1]
    v_pk_fma_f32 v[32:33], v[32:33], s[50:51], v[70:71] op_sel_hi:[1,1,0] neg_lo:[0,0,1] neg_hi:[0,0,1]
    v_exp_f32 v120, v120
    v_exp_f32 v121, v121
    v_exp_f32 v122, v122
    ds_read_b128 v[72:75], v10 offset:8192
    v_exp_f32 v123, v123
    v_cvt_pk_bf16_f32 v44, v120, v121
    v_exp_f32 v124, v124
    ds_read_b128 v[76:79], v10 offset:9216
    v_exp_f32 v125, v125
    v_cvt_pk_bf16_f32 v45, v122, v123
    v_exp_f32 v126, v126
    v_exp_f32 v127, v127
    v_cvt_pk_bf16_f32 v46, v124, v125
    v_exp_f32 v32, v32
    v_cvt_pk_bf16_f32 v47, v126, v127
    v_exp_f32 v33, v33
    v_add_f32 v80, v80, v82
    v_mfma_f32_16x16x32_bf16 v[48:51], v[36:39], v[44:47], 0
    v_cvt_pk_bf16_f32 v40, v32, v33
    v_add_f32 v81, v81, v83
    v_mfma_f32_16x16x32_bf16 v[52:55], v[24:27], v[44:47], 0
    v_add_f32 v84, v84, v86
    v_add_f32 v85, v85, v87
    v_mfma_f32_16x16x32_bf16 v[48:51], v[36:39], v[40:43], v[48:51]
    v_cvt_pk_bf16_f32 v64, v80, v81
    v_cvt_pk_bf16_f32 v66, v84, v85
    v_mfma_f32_16x16x32_bf16 v[56:59], v[28:31], v[44:47], 0
    v_mov_b64 v[32:33], 0
    v_mov_b64 v[34:35], 0
    v_mfma_f32_16x16x32_bf16 v[52:55], v[64:67], v[40:43], v[52:55]
    v_mov_b64 v[36:37], 0
    s_nop 0
    v_rcp_f32 v60, v48
    v_mfma_f32_16x16x32_bf16 v[56:59], v[66:69], v[40:43], v[56:59]
    s_mov_b64 exec, s[96:97]
    s_nop 2
    v_mul_f32 v52, v52, v60
    v_mul_f32 v53, v53, v60
    v_mul_f32 v54, v54, v60
    v_mul_f32 v55, v55, v60
    s_not_b64 exec, exec
    v_pk_mul_f32 v[52:53], v[56:57], v[60:61] op_sel_hi:[1,0]
    v_pk_mul_f32 v[54:55], v[58:59], v[60:61] op_sel_hi:[1,0]
    s_mov_b64 exec, -1
    v_cvt_pk_bf16_f32 v56, v52, v53
    v_cvt_pk_bf16_f32 v57, v54, v55
    ds_write_b64 v5, v[56:57] offset:30720
    v_min_u32 v24, -2, v64
    v_mov_b32 v25, v65
    v_mov_b64 v[26:27], v[66:67]
    buffer_load_dwordx4 v[28:31], off, s[4:7], s82 sc1
    v_mov_b64 v[38:39], 0
    v_mov_b64 v[40:41], 0
    v_mov_b64 v[42:43], 0
    v_mov_b64 v[44:45], 0
    v_mov_b64 v[46:47], 0
    s_waitcnt lgkmcnt(0)
    s_barrier
    ds_read_b128 v[68:71], v1 offset:31744
    ds_read_b128 v[64:67], v1 offset:30720
    v_mov_b64 v[48:49], 0
    v_mov_b64 v[50:51], 0
    v_mov_b64 v[52:53], 0
    v_mov_b64 v[54:55], 0
    v_mov_b64 v[56:57], 0
    v_mov_b64 v[58:59], 0
    v_mov_b64 v[60:61], 0
    v_mov_b64 v[62:63], 0
    s_waitcnt lgkmcnt(0)
    v_smfmac_f32_16x16x64_bf16 v[32:35], v[68:71], v[88:95], v9
    ds_read_b128 v[80:83], v10 offset:10240
    v_smfmac_f32_16x16x64_bf16 v[32:35], v[64:67], v[192:199], v9
    ds_read_b128 v[84:87], v10 offset:11264
    ds_read_b128 v[120:123], v10 offset:12288
    v_smfmac_f32_16x16x64_bf16 v[36:39], v[68:71], v[96:103], v9
    ds_read_b128 v[124:127], v10 offset:13312
    ds_read_b128 v[88:91], v10 offset:14336
    v_smfmac_f32_16x16x64_bf16 v[36:39], v[64:67], v[200:207], v9
    ds_read_b128 v[92:95], v10 offset:15360
    s_nop 0
    v_add_f32 v32, v32, v34
    v_smfmac_f32_16x16x64_bf16 v[40:43], v[68:71], v[104:111], v9
    v_add_f32 v33, v33, v35
    v_cvt_pk_bf16_f32 v32, v32, v33
    v_smfmac_f32_16x16x64_bf16 v[40:43], v[64:67], v[208:215], v9
    v_or_b32 v32, 1, v32
    v_smfmac_f32_16x16x64_bf16 v[44:47], v[68:71], v[112:119], v9
    v_add_f32 v36, v36, v38
    v_add_f32 v37, v37, v39
    v_smfmac_f32_16x16x64_bf16 v[44:47], v[64:67], v[216:223], v9
    v_cvt_pk_bf16_f32 v33, v36, v37
    v_smfmac_f32_16x16x64_bf16 v[48:51], v[68:71], v[72:79], v9
    v_add_f32 v40, v40, v42
    v_add_f32 v41, v41, v43
    v_smfmac_f32_16x16x64_bf16 v[48:51], v[64:67], v[224:231], v9
    v_cvt_pk_bf16_f32 v34, v40, v41
    s_waitcnt lgkmcnt(0)
    v_smfmac_f32_16x16x64_bf16 v[52:55], v[68:71], v[80:87], v9
    v_add_f32 v44, v44, v46
    v_add_f32 v45, v45, v47
    v_smfmac_f32_16x16x64_bf16 v[52:55], v[64:67], v[232:239], v9
    v_cvt_pk_bf16_f32 v35, v44, v45
    buffer_store_dwordx4 v[32:35], v7, s[4:7], 0 offen sc0 sc1
    v_smfmac_f32_16x16x64_bf16 v[56:59], v[68:71], v[120:127], v9
    v_add_f32 v48, v48, v50
    v_add_f32 v49, v49, v51
    v_smfmac_f32_16x16x64_bf16 v[56:59], v[64:67], v[240:247], v9
    v_cvt_pk_bf16_f32 v48, v48, v49
    v_smfmac_f32_16x16x64_bf16 v[60:63], v[64:67], v[248:255], v9
    v_or_b32 v48, 1, v48
    v_add_f32 v52, v52, v54
    v_smfmac_f32_16x16x64_bf16 v[60:63], v[68:71], v[88:95], v9
    v_add_f32 v53, v53, v55
    v_cvt_pk_bf16_f32 v49, v52, v53
    v_add_f32 v56, v56, v58
    v_add_f32 v57, v57, v59
    v_cvt_pk_bf16_f32 v50, v56, v57
    s_nop 2
    v_add_f32 v60, v60, v62
    v_add_f32 v61, v61, v63
    v_cvt_pk_bf16_f32 v51, v60, v61
    buffer_store_dwordx4 v[48:51], v7, s[4:7], s48 offen sc0 sc1
    s_add_u32 s45, s33, 3
    s_min_u32 s45, s45, 64
    s_cmp_ge_u32 s49, s45
    s_cbranch_scc0 CL_kv11
CL_kvb11:
    ds_read_b128 v[88:91], v6 offset:0
    v_mov_b64 v[64:65], 0
    ds_read_b128 v[92:95], v6 offset:1024
    v_mov_b64 v[66:67], 0
    ds_read_b128 v[96:99], v6 offset:2048
    v_mov_b64 v[68:69], 0
    ds_read_b128 v[100:103], v6 offset:3072
    v_mov_b64 v[70:71], 0
    ds_read_b128 v[104:107], v6 offset:4096
    v_mov_b64 v[72:73], 0
    ds_read_b128 v[108:111], v6 offset:5120
    v_mov_b64 v[74:75], 0
    v_mov_b64 v[76:77], 0
    ds_read_b128 v[112:115], v6 offset:6144
    v_mov_b64 v[78:79], 0
    ds_read_b128 v[116:119], v6 offset:7168
    v_mov_b64 v[80:81], 0
    ds_read_b128 v[120:123], v6 offset:8192
    v_mov_b64 v[82:83], 0
    ds_read_b128 v[124:127], v6 offset:9216
    v_mov_b64 v[84:85], 0
    v_mov_b64 v[86:87], 0
    s_add_u32 s38, s38, 0x80000
    s_add_u32 s39, s39, 0x80000
    s_add_u32 s40, s40, 0x40000
    s_mov_b32 m0, s42
    s_mov_b32 s43, 0
    buffer_load_dwordx4 v[36:39], v2, s[4:7], s34 offen sc1
    buffer_load_dwordx4 v[40:43], v2, s[4:7], s34 offen offset:1024 sc1
    s_nop 15
    s_nop 3
    buffer_load_dwordx4 v[56:59], v2, s[4:7], s34 offen sc1
    buffer_load_dwordx4 v[60:63], v2, s[4:7], s34 offen offset:1024 sc1
    s_mov_b64 s[92:93], -1
    s_waitcnt vmcnt(2)
    v_mfma_f32_16x16x32_bf16 v[44:47], v[36:39], v[12:15], 0
    v_mfma_f32_16x16x32_bf16 v[44:47], v[40:43], v[12:15], v[44:47]
    v_and_b32 v11, v36, v40
    v_and_b32 v11, 1, v11
    v_cmp_eq_u32 vcc, 0, v11
    s_cbranch_vccnz CL_s11_p1_r
CL_s11_p1_j:
    v_mov_b32 v11, -1
    s_nop 2
    v_permlane32_swap_b32 v44, v45
    v_permlane32_swap_b32 v46, v47
    v_add_f32 v44, v44, v45
    v_add_f32 v46, v46, v47
    s_nop 1
    v_permlane16_swap_b32 v44, v46
    v_add_f32 v44, v44, v46
    v_mov_b32 v45, v44
    s_nop 1
    v_permlane32_swap_b32 v44, v45
    s_mov_b64 exec, s[98:99]
    v_cvt_pk_bf16_f32 v44, v44, v45
    v_min_u32 v44, -2, v44
    buffer_store_dword v44, v8, s[4:7], s35 offen sc0 sc1
    buffer_store_dword v11, v8, s[4:7], s37 offen sc0 sc1
    s_mov_b64 exec, -1
    s_sub_u32 s47, s35, 131072
    s_mov_b32 s45, s35
    s_mov_b32 s35, s36
    s_mov_b32 s36, s37
    s_mov_b32 s37, s45
    s_mov_b32 s83, s33
    s_add_u32 s33, s33, 1
    v_min_u32 v28, v28, v29
    v_min3_u32 v28, v28, v30, v31
    s_nop 0
    v_readfirstlane_b32 s45, v28
    s_nop 1
    s_lshl_b32 s45, s45, 2
    s_max_u32 s49, s49, s45
    s_add_u32 s45, s33, 8
    s_min_u32 s45, s45, 64
    s_cmp_ge_u32 s49, s45
    s_cselect_b32 s82, 268435456, s84
    s_nop 15
    s_nop 15
    s_nop 3
    s_mov_b32 s43, 0
    buffer_load_dwordx4 v[32:35], v2, s[4:7], s47 offen sc1
    buffer_load_dwordx4 v[36:39], v2, s[4:7], s47 offen offset:1024 sc1
    s_waitcnt lgkmcnt(0)
    s_branch CL_s01
CL_s00_p2_r:
    s_mov_b64 exec, vcc
    s_mov_b64 s[94:95], vcc
    buffer_load_dwordx4 v[32:35], v2, s[4:7], s47 offen sc1
    buffer_load_dwordx4 v[36:39], v2, s[4:7], s47 offen offset:1024 sc1
    s_add_u32 s43, s43, 1
    s_cmp_gt_u32 s43, 2000000
    s_cbranch_scc1 L_end
    s_mov_b64 exec, s[92:93]
    s_waitcnt vmcnt(2)
    v_max3_u32 v44, v56, v57, v58
    v_max3_u32 v45, v59, v60, v61
    v_max3_u32 v44, v44, v62, v63
    v_max_u32 v44, v44, v45
    v_cmp_eq_u32 vcc, -1, v44
    s_nop 0
    s_cbranch_vccz CL_s00_p2_ok2
    s_mov_b64 exec, vcc
    s_mov_b64 s[92:93], vcc
    buffer_load_dwordx4 v[56:59], v2, s[4:7], s47 offen sc1
    buffer_load_dwordx4 v[60:63], v2, s[4:7], s47 offen offset:1024 sc1
    s_mov_b64 exec, s[94:95]
    s_waitcnt vmcnt(2)
    v_max3_u32 v44, v32, v33, v34
    v_max3_u32 v45, v35, v36, v37
    v_max3_u32 v44, v44, v38, v39
    v_max_u32 v44, v44, v45
    v_cmp_eq_u32 vcc, -1, v44
    s_nop 0
    s_cbranch_vccnz CL_s00_p2_r
    s_mov_b64 exec, -1
    ds_write_b128 v2, v[32:35] offset:0
    ds_write_b128 v2, v[36:39] offset:1024
    s_branch CL_s00_p2_j
CL_s00_p2_ok2:
    s_mov_b64 exec, -1
    ds_write_b128 v2, v[56:59] offset:0
    ds_write_b128 v2, v[60:63] offset:1024
    v_mov_b64 v[32:33], v[56:57]
    v_mov_b64 v[34:35], v[58:59]
    v_mov_b64 v[36:37], v[60:61]
    v_mov_b64 v[38:39], v[62:63]
    s_nop 0
    s_branch CL_s00_p2_j
CL_s00_p1_r:
    s_mov_b64 exec, vcc
    s_mov_b64 s[94:95], vcc
    buffer_load_dwordx4 v[36:39], v2, s[4:7], s34 offen sc1
    buffer_load_dwordx4 v[40:43], v2, s[4:7], s34 offen offset:1024 sc1
    s_add_u32 s43, s43, 1
    s_cmp_gt_u32 s43, 2000000
    s_cbranch_scc1 L_end
    s_mov_b64 exec, s[92:93]
    s_waitcnt vmcnt(2)
    v_or_b32 v11, v56, v60
    v_and_b32 v11, 1, v11
    v_cmp_ne_u32 vcc, 0, v11
    s_nop 0
    s_cbranch_vccz CL_s00_p1_ok2
    s_mov_b64 exec, vcc
    s_mov_b64 s[92:93], vcc
    buffer_load_dwordx4 v[56:59], v2, s[4:7], s34 offen sc1
    buffer_load_dwordx4 v[60:63], v2, s[4:7], s34 offen offset:1024 sc1
    s_mov_b64 exec, s[94:95]
    s_waitcnt vmcnt(2)
    v_or_b32 v11, v36, v40
    v_and_b32 v11, 1, v11
    v_cmp_ne_u32 vcc, 0, v11
    s_nop 0
    s_cbranch_vccnz CL_s00_p1_r
    s_mov_b64 exec, -1
    v_mfma_f32_16x16x32_bf16 v[44:47], v[36:39], v[12:15], 0
    v_mfma_f32_16x16x32_bf16 v[44:47], v[40:43], v[12:15], v[44:47]
    s_nop 6
    s_branch CL_s00_p1_j
CL_s00_p1_ok2:
    s_mov_b64 exec, -1
    v_mfma_f32_16x16x32_bf16 v[44:47], v[56:59], v[12:15], 0
    v_mfma_f32_16x16x32_bf16 v[44:47], v[60:63], v[12:15], v[44:47]
    s_nop 6
    s_branch CL_s00_p1_j
CL_s10_p2_r:
    s_mov_b64 exec, vcc
    s_mov_b64 s[94:95], vcc
    buffer_load_dwordx4 v[32:35], v2, s[4:7], s47 offen sc1
    buffer_load_dwordx4 v[36:39], v2, s[4:7], s47 offen offset:1024 sc1
    s_add_u32 s43, s43, 1
    s_cmp_gt_u32 s43, 2000000
    s_cbranch_scc1 L_end
    s_mov_b64 exec, s[92:93]
    s_waitcnt vmcnt(2)
    v_max3_u32 v44, v56, v57, v58
    v_max3_u32 v45, v59, v60, v61
    v_max3_u32 v44, v44, v62, v63
    v_max_u32 v44, v44, v45
    v_cmp_eq_u32 vcc, -1, v44
    s_nop 0
    s_cbranch_vccz CL_s10_p2_ok2
    s_mov_b64 exec, vcc
    s_mov_b64 s[92:93], vcc
    buffer_load_dwordx4 v[56:59], v2, s[4:7], s47 offen sc1
    buffer_load_dwordx4 v[60:63], v2, s[4:7], s47 offen offset:1024 sc1
    s_mov_b64 exec, s[94:95]
    s_waitcnt vmcnt(2)
    v_max3_u32 v44, v32, v33, v34
    v_max3_u32 v45, v35, v36, v37
    v_max3_u32 v44, v44, v38, v39
    v_max_u32 v44, v44, v45
    v_cmp_eq_u32 vcc, -1, v44
    s_nop 0
    s_cbranch_vccnz CL_s10_p2_r
    s_mov_b64 exec, -1
    ds_write_b128 v2, v[32:35] offset:0
    ds_write_b128 v2, v[36:39] offset:1024
    s_branch CL_s10_p2_j
CL_s10_p2_ok2:
    s_mov_b64 exec, -1
    ds_write_b128 v2, v[56:59] offset:0
    ds_write_b128 v2, v[60:63] offset:1024
    v_mov_b64 v[32:33], v[56:57]
    v_mov_b64 v[34:35], v[58:59]
    v_mov_b64 v[36:37], v[60:61]
    v_mov_b64 v[38:39], v[62:63]
    s_nop 0
    s_branch CL_s10_p2_j
CL_s10_p1_r:
    s_mov_b64 exec, vcc
    s_mov_b64 s[94:95], vcc
    buffer_load_dwordx4 v[36:39], v2, s[4:7], s34 offen sc1
    buffer_load_dwordx4 v[40:43], v2, s[4:7], s34 offen offset:1024 sc1
    s_add_u32 s43, s43, 1
    s_cmp_gt_u32 s43, 2000000
    s_cbranch_scc1 L_end
    s_mov_b64 exec, s[92:93]
    s_waitcnt vmcnt(2)
    v_and_b32 v11, v56, v60
    v_and_b32 v11, 1, v11
    v_cmp_eq_u32 vcc, 0, v11
    s_nop 0
    s_cbranch_vccz CL_s10_p1_ok2
    s_mov_b64 exec, vcc
    s_mov_b64 s[92:93], vcc
    buffer_load_dwordx4 v[56:59], v2, s[4:7], s34 offen sc1
    buffer_load_dwordx4 v[60:63], v2, s[4:7], s34 offen offset:1024 sc1
    s_mov_b64 exec, s[94:95]
    s_waitcnt vmcnt(2)
    v_and_b32 v11, v36, v40
    v_and_b32 v11, 1, v11
    v_cmp_eq_u32 vcc, 0, v11
    s_nop 0
    s_cbranch_vccnz CL_s10_p1_r
    s_mov_b64 exec, -1
    v_mfma_f32_16x16x32_bf16 v[44:47], v[36:39], v[12:15], 0
    v_mfma_f32_16x16x32_bf16 v[44:47], v[40:43], v[12:15], v[44:47]
    s_nop 6
    s_branch CL_s10_p1_j
CL_s10_p1_ok2:
    s_mov_b64 exec, -1
    v_mfma_f32_16x16x32_bf16 v[44:47], v[56:59], v[12:15], 0
    v_mfma_f32_16x16x32_bf16 v[44:47], v[60:63], v[12:15], v[44:47]
    s_nop 6
    s_branch CL_s10_p1_j
CL_s01_p2_r:
    s_mov_b64 exec, vcc
    s_mov_b64 s[94:95], vcc
    buffer_load_dwordx4 v[32:35], v2, s[4:7], s47 offen sc1
    buffer_load_dwordx4 v[36:39], v2, s[4:7], s47 offen offset:1024 sc1
    s_add_u32 s43, s43, 1
    s_cmp_gt_u32 s43, 2000000
    s_cbranch_scc1 L_end
    s_mov_b64 exec, s[92:93]
    s_waitcnt vmcnt(2)
    v_max3_u32 v44, v56, v57, v58
    v_max3_u32 v45, v59, v60, v61
    v_max3_u32 v44, v44, v62, v63
    v_max_u32 v44, v44, v45
    v_cmp_eq_u32 vcc, -1, v44
    s_nop 0
    s_cbranch_vccz CL_s01_p2_ok2
    s_mov_b64 exec, vcc
    s_mov_b64 s[92:93], vcc
    buffer_load_dwordx4 v[56:59], v2, s[4:7], s47 offen sc1
    buffer_load_dwordx4 v[60:63], v2, s[4:7], s47 offen offset:1024 sc1
    s_mov_b64 exec, s[94:95]
    s_waitcnt vmcnt(2)
    v_max3_u32 v44, v32, v33, v34
    v_max3_u32 v45, v35, v36, v37
    v_max3_u32 v44, v44, v38, v39
    v_max_u32 v44, v44, v45
    v_cmp_eq_u32 vcc, -1, v44
    s_nop 0
    s_cbranch_vccnz CL_s01_p2_r
    s_mov_b64 exec, -1
    ds_write_b128 v2, v[32:35] offset:0
    ds_write_b128 v2, v[36:39] offset:1024
    s_branch CL_s01_p2_j
CL_s01_p2_ok2:
    s_mov_b64 exec, -1
    ds_write_b128 v2, v[56:59] offset:0
    ds_write_b128 v2, v[60:63] offset:1024
    v_mov_b64 v[32:33], v[56:57]
    v_mov_b64 v[34:35], v[58:59]
    v_mov_b64 v[36:37], v[60:61]
    v_mov_b64 v[38:39], v[62:63]
    s_nop 0
    s_branch CL_s01_p2_j
CL_s01_p1_r:
    s_mov_b64 exec, vcc
    s_mov_b64 s[94:95], vcc
    buffer_load_dwordx4 v[36:39], v2, s[4:7], s34 offen sc1
    buffer_load_dwordx4 v[40:43], v2, s[4:7], s34 offen offset:1024 sc1
    s_add_u32 s43, s43, 1
    s_cmp_gt_u32 s43, 2000000
    s_cbranch_scc1 L_end
    s_mov_b64 exec, s[92:93]
    s_waitcnt vmcnt(2)
    v_or_b32 v11, v56, v60
    v_and_b32 v11, 1, v11
    v_cmp_ne_u32 vcc, 0, v11
    s_nop 0
    s_cbranch_vccz CL_s01_p1_ok2
    s_mov_b64 exec, vcc
    s_mov_b64 s[92:93], vcc
    buffer_load_dwordx4 v[56:59], v2, s[4:7], s34 offen sc1
    buffer_load_dwordx4 v[60:63], v2, s[4:7], s34 offen offset:1024 sc1
    s_mov_b64 exec, s[94:95]
    s_waitcnt vmcnt(2)
    v_or_b32 v11, v36, v40
    v_and_b32 v11, 1, v11
    v_cmp_ne_u32 vcc, 0, v11
    s_nop 0
    s_cbranch_vccnz CL_s01_p1_r
    s_mov_b64 exec, -1
    v_mfma_f32_16x16x32_bf16 v[44:47], v[36:39], v[12:15], 0
    v_mfma_f32_16x16x32_bf16 v[44:47], v[40:43], v[12:15], v[44:47]
    s_nop 6
    s_branch CL_s01_p1_j
CL_s01_p1_ok2:
    s_mov_b64 exec, -1
    v_mfma_f32_16x16x32_bf16 v[44:47], v[56:59], v[12:15], 0
    v_mfma_f32_16x16x32_bf16 v[44:47], v[60:63], v[12:15], v[44:47]
    s_nop 6
    s_branch CL_s01_p1_j
CL_s11_p2_r:
    s_mov_b64 exec, vcc
    s_mov_b64 s[94:95], vcc
    buffer_load_dwordx4 v[32:35], v2, s[4:7], s47 offen sc1
    buffer_load_dwordx4 v[36:39], v2, s[4:7], s47 offen offset:1024 sc1
    s_add_u32 s43, s43, 1
    s_cmp_gt_u32 s43, 2000000
    s_cbranch_scc1 L_end
    s_mov_b64 exec, s[92:93]
    s_waitcnt vmcnt(2)
    v_max3_u32 v44, v56, v57, v58
    v_max3_u32 v45, v59, v60, v61
    v_max3_u32 v44, v44, v62, v63
    v_max_u32 v44, v44, v45
    v_cmp_eq_u32 vcc, -1, v44
    s_nop 0
    s_cbranch_vccz CL_s11_p2_ok2
    s_mov_b64 exec, vcc
    s_mov_b64 s[92:93], vcc
    buffer_load_dwordx4 v[56:59], v2, s[4:7], s47 offen sc1
    buffer_load_dwordx4 v[60:63], v2, s[4:7], s47 offen offset:1024 sc1
    s_mov_b64 exec, s[94:95]
    s_waitcnt vmcnt(2)
    v_max3_u32 v44, v32, v33, v34
    v_max3_u32 v45, v35, v36, v37
    v_max3_u32 v44, v44, v38, v39
    v_max_u32 v44, v44, v45
    v_cmp_eq_u32 vcc, -1, v44
    s_nop 0
    s_cbranch_vccnz CL_s11_p2_r
    s_mov_b64 exec, -1
    ds_write_b128 v2, v[32:35] offset:0
    ds_write_b128 v2, v[36:39] offset:1024
    s_branch CL_s11_p2_j
CL_s11_p2_ok2:
    s_mov_b64 exec, -1
    ds_write_b128 v2, v[56:59] offset:0
    ds_write_b128 v2, v[60:63] offset:1024
    v_mov_b64 v[32:33], v[56:57]
    v_mov_b64 v[34:35], v[58:59]
    v_mov_b64 v[36:37], v[60:61]
    v_mov_b64 v[38:39], v[62:63]
    s_nop 0
    s_branch CL_s11_p2_j
CL_s11_p1_r:
    s_mov_b64 exec, vcc
    s_mov_b64 s[94:95], vcc
    buffer_load_dwordx4 v[36:39], v2, s[4:7], s34 offen sc1
    buffer_load_dwordx4 v[40:43], v2, s[4:7], s34 offen offset:1024 sc1
    s_add_u32 s43, s43, 1
    s_cmp_gt_u32 s43, 2000000
    s_cbranch_scc1 L_end
    s_mov_b64 exec, s[92:93]
    s_waitcnt vmcnt(2)
    v_and_b32 v11, v56, v60
    v_and_b32 v11, 1, v11
    v_cmp_eq_u32 vcc, 0, v11
    s_nop 0
    s_cbranch_vccz CL_s11_p1_ok2
    s_mov_b64 exec, vcc
    s_mov_b64 s[92:93], vcc
    buffer_load_dwordx4 v[56:59], v2, s[4:7], s34 offen sc1
    buffer_load_dwordx4 v[60:63], v2, s[4:7], s34 offen offset:1024 sc1
    s_mov_b64 exec, s[94:95]
    s_waitcnt vmcnt(2)
    v_and_b32 v11, v36, v40
    v_and_b32 v11, 1, v11
    v_cmp_eq_u32 vcc, 0, v11
    s_nop 0
    s_cbranch_vccnz CL_s11_p1_r
    s_mov_b64 exec, -1
    v_mfma_f32_16x16x32_bf16 v[44:47], v[36:39], v[12:15], 0
    v_mfma_f32_16x16x32_bf16 v[44:47], v[40:43], v[12:15], v[44:47]
    s_nop 6
    s_branch CL_s11_p1_j
CL_s11_p1_ok2:
    s_mov_b64 exec, -1
    v_mfma_f32_16x16x32_bf16 v[44:47], v[56:59], v[12:15], 0
    v_mfma_f32_16x16x32_bf16 v[44:47], v[60:63], v[12:15], v[44:47]
    s_nop 6
    s_branch CL_s11_p1_j
CL_last_p2_r:
    s_mov_b64 exec, vcc
    s_mov_b64 s[94:95], vcc
    buffer_load_dwordx4 v[32:35], v2, s[4:7], s47 offen sc1
    buffer_load_dwordx4 v[36:39], v2, s[4:7], s47 offen offset:1024 sc1
    s_add_u32 s43, s43, 1
    s_cmp_gt_u32 s43, 2000000
    s_cbranch_scc1 L_end
    s_mov_b64 exec, s[92:93]
    s_waitcnt vmcnt(2)
    v_max3_u32 v44, v56, v57, v58
    v_max3_u32 v45, v59, v60, v61
    v_max3_u32 v44, v44, v62, v63
    v_max_u32 v44, v44, v45
    v_cmp_eq_u32 vcc, -1, v44
    s_nop 0
    s_cbranch_vccz CL_last_p2_ok2
    s_mov_b64 exec, vcc
    s_mov_b64 s[92:93], vcc
    buffer_load_dwordx4 v[56:59], v2, s[4:7], s47 offen sc1
    buffer_load_dwordx4 v[60:63], v2, s[4:7], s47 offen offset:1024 sc1
    s_mov_b64 exec, s[94:95]
    s_waitcnt vmcnt(2)
    v_max3_u32 v44, v32, v33, v34
    v_max3_u32 v45, v35, v36, v37
    v_max3_u32 v44, v44, v38, v39
    v_max_u32 v44, v44, v45
    v_cmp_eq_u32 vcc, -1, v44
    s_nop 0
    s_cbranch_vccnz CL_last_p2_r
    s_mov_b64 exec, -1
    ds_write_b128 v2, v[32:35] offset:0
    ds_write_b128 v2, v[36:39] offset:1024
    s_branch CL_last_p2_j
CL_last_p2_ok2:
    s_mov_b64 exec, -1
    ds_write_b128 v2, v[56:59] offset:0
    ds_write_b128 v2, v[60:63] offset:1024
    v_mov_b64 v[32:33], v[56:57]
    v_mov_b64 v[34:35], v[58:59]
    v_mov_b64 v[36:37], v[60:61]
    v_mov_b64 v[38:39], v[62:63]
    s_nop 0
    s_branch CL_last_p2_j
CL_kvp:
    s_mov_b32 s43, 0
CL_kvlp:
    buffer_load_dwordx4 v[36:39], off, s[4:7], s84 sc1
    s_add_u32 s43, s43, 1
    s_cmp_gt_u32 s43, 2000000
    s_cbranch_scc1 L_end
    s_waitcnt vmcnt(0)
    v_min_u32 v36, v36, v37
    v_min3_u32 v36, v36, v38, v39
    s_nop 0
    v_readfirstlane_b32 s49, v36
    s_nop 1
    s_lshl_b32 s49, s49, 2
    s_cmp_ge_u32 s49, s45
    s_cbranch_scc0 CL_kvlp
    s_branch CL_kvbp
CL_kv00:
    s_mov_b32 s43, 0
CL_kvl00:
    buffer_load_dwordx4 v[36:39], off, s[4:7], s84 sc1
    s_add_u32 s43, s43, 1
    s_cmp_gt_u32 s43, 2000000
    s_cbranch_scc1 L_end
    s_waitcnt vmcnt(0)
    v_min_u32 v36, v36, v37
    v_min3_u32 v36, v36, v38, v39
    s_nop 0
    v_readfirstlane_b32 s49, v36
    s_nop 1
    s_lshl_b32 s49, s49, 2
    s_cmp_ge_u32 s49, s45
    s_cbranch_scc0 CL_kvl00
    s_branch CL_kvb00
CL_kv10:
    s_mov_b32 s43, 0
CL_kvl10:
    buffer_load_dwordx4 v[36:39], off, s[4:7], s84 sc1
    s_add_u32 s43, s43, 1
    s_cmp_gt_u32 s43, 2000000
    s_cbranch_scc1 L_end
    s_waitcnt vmcnt(0)
    v_min_u32 v36, v36, v37
    v_min3_u32 v36, v36, v38, v39
    s_nop 0
    v_readfirstlane_b32 s49, v36
    s_nop 1
    s_lshl_b32 s49, s49, 2
    s_cmp_ge_u32 s49, s45
    s_cbranch_scc0 CL_kvl10
    s_branch CL_kvb10
CL_kv01:
    s_mov_b32 s43, 0
CL_kvl01:
    buffer_load_dwordx4 v[36:39], off, s[4:7], s84 sc1
    s_add_u32 s43, s43, 1
    s_cmp_gt_u32 s43, 2000000
    s_cbranch_scc1 L_end
    s_waitcnt vmcnt(0)
    v_min_u32 v36, v36, v37
    v_min3_u32 v36, v36, v38, v39
    s_nop 0
    v_readfirstlane_b32 s49, v36
    s_nop 1
    s_lshl_b32 s49, s49, 2
    s_cmp_ge_u32 s49, s45
    s_cbranch_scc0 CL_kvl01
    s_branch CL_kvb01
CL_kv11:
    s_mov_b32 s43, 0
CL_kvl11:
    buffer_load_dwordx4 v[36:39], off, s[4:7], s84 sc1
    s_add_u32 s43, s43, 1
    s_cmp_gt_u32 s43, 2000000
    s_cbranch_scc1 L_end
    s_waitcnt vmcnt(0)
    v_min_u32 v36, v36, v37
    v_min3_u32 v36, v36, v38, v39
    s_nop 0
    v_readfirstlane_b32 s49, v36
    s_nop 1
    s_lshl_b32 s49, s49, 2
    s_cmp_ge_u32 s49, s45
    s_cbranch_scc0 CL_kvl11
    s_branch CL_kvb11
CL_chain_last:
    s_nop 15
    s_nop 7
    buffer_load_dwordx4 v[56:59], v2, s[4:7], s47 offen sc1
    buffer_load_dwordx4 v[60:63], v2, s[4:7], s47 offen offset:1024 sc1
    s_mov_b64 s[92:93], -1
    s_waitcnt vmcnt(2)
    ds_write_b128 v2, v[32:35] offset:0
    ds_write_b128 v2, v[36:39] offset:1024
    v_max3_u32 v44, v32, v33, v34
    v_max3_u32 v45, v35, v36, v37
    v_max3_u32 v44, v44, v38, v39
    v_max_u32 v44, v44, v45
    v_cmp_eq_u32 vcc, -1, v44
    s_cbranch_vccnz CL_last_p2_r
CL_last_p2_j:
    v_smfmac_f32_16x16x64_bf16 v[72:75], v[32:35], a[0:7], v9
    v_xor_b32 v52, 2048, v2
    v_smfmac_f32_16x16x64_bf16 v[76:79], v[32:35], a[64:71], v9
    v_xor_b32 v53, 4096, v2
    v_smfmac_f32_16x16x64_bf16 v[72:75], v[36:39], a[8:15], v9
    v_xor_b32 v11, 6144, v2
    v_smfmac_f32_16x16x64_bf16 v[76:79], v[36:39], a[72:79], v9
    s_waitcnt vmcnt(0) lgkmcnt(0)
    s_barrier
    ds_read_b128 v[40:43], v52 offset:0
    ds_read_b128 v[44:47], v52 offset:1024
    ds_read_b128 v[48:51], v53 offset:0
    ds_read_b128 v[52:55], v53 offset:1024
    ds_read_b128 v[56:59], v11 offset:0
    ds_read_b128 v[60:63], v11 offset:1024
    v_smfmac_f32_16x16x64_bf16 v[80:83], v[32:35], a[128:135], v9
    v_smfmac_f32_16x16x64_bf16 v[84:87], v[32:35], a[192:199], v9
    v_smfmac_f32_16x16x64_bf16 v[80:83], v[36:39], a[136:143], v9
    v_smfmac_f32_16x16x64_bf16 v[84:87], v[36:39], a[200:207], v9
    s_waitcnt lgkmcnt(0)
    buffer_store_dwordx4 v[16:19], v2, s[4:7], s40 offen sc0 sc1
    v_mov_b32 v11, s83
    buffer_store_dword v11, off, s[4:7], s85 sc0 sc1
    v_smfmac_f32_16x16x64_bf16 v[72:75], v[40:43], a[16:23], v9
    v_smfmac_f32_16x16x64_bf16 v[72:75], v[44:47], a[24:31], v9
    v_smfmac_f32_16x16x64_bf16 v[72:75], v[48:51], a[32:39], v9
    v_smfmac_f32_16x16x64_bf16 v[72:75], v[52:55], a[40:47], v9
    v_smfmac_f32_16x16x64_bf16 v[72:75], v[56:59], a[48:55], v9
    v_smfmac_f32_16x16x64_bf16 v[72:75], v[60:63], a[56:63], v9
    v_smfmac_f32_16x16x64_bf16 v[76:79], v[40:43], a[80:87], v9
    v_smfmac_f32_16x16x64_bf16 v[76:79], v[44:47], a[88:95], v9
    v_smfmac_f32_16x16x64_bf16 v[76:79], v[48:51], a[96:103], v9
    v_smfmac_f32_16x16x64_bf16 v[76:79], v[52:55], a[104:111], v9
    v_smfmac_f32_16x16x64_bf16 v[76:79], v[56:59], a[112:119], v9
    v_smfmac_f32_16x16x64_bf16 v[76:79], v[60:63], a[120:127], v9
    v_smfmac_f32_16x16x64_bf16 v[80:83], v[40:43], a[144:151], v9
    v_smfmac_f32_16x16x64_bf16 v[84:87], v[40:43], a[208:215], v9
    v_smfmac_f32_16x16x64_bf16 v[80:83], v[44:47], a[152:159], v9
    v_smfmac_f32_16x16x64_bf16 v[84:87], v[44:47], a[216:223], v9
    v_smfmac_f32_16x16x64_bf16 v[80:83], v[48:51], a[160:167], v9
    v_smfmac_f32_16x16x64_bf16 v[84:87], v[48:51], a[224:231], v9
    v_smfmac_f32_16x16x64_bf16 v[80:83], v[52:55], a[168:175], v9
    v_smfmac_f32_16x16x64_bf16 v[84:87], v[52:55], a[232:239], v9
    v_smfmac_f32_16x16x64_bf16 v[80:83], v[56:59], a[176:183], v9
    v_smfmac_f32_16x16x64_bf16 v[84:87], v[56:59], a[240:247], v9
    v_smfmac_f32_16x16x64_bf16 v[80:83], v[60:63], a[184:191], v9
    v_smfmac_f32_16x16x64_bf16 v[84:87], v[60:63], a[248:255], v9
    v_add_f32 v72, v72, v74
    v_add_f32 v73, v73, v75
    v_add_f32 v76, v76, v78
    v_add_f32 v77, v77, v79
    v_cvt_pk_bf16_f32 v65, v72, v73
    v_cvt_pk_bf16_f32 v67, v76, v77
    v_add_f32 v80, v80, v82
    v_add_f32 v81, v81, v83
    v_add_f32 v84, v84, v86
    v_add_f32 v85, v85, v87
    v_cvt_pk_bf16_f32 v64, v80, v81
    v_cvt_pk_bf16_f32 v66, v84, v85
    s_add_u32 s40, s40, 0x40000
    v_min_u32 v64, -2, v64
    buffer_store_dwordx4 v[64:67], v2, s[4:7], s40 offen sc0 sc1
    s_endpgm
    s_nop 0
L_worker:
    s_sub_u32 s31, s31, 32
    s_cmp_lg_u32 s31, 200
    s_cbranch_scc1 L_noinit
    s_cmp_lg_u32 s30, 0
    s_cbranch_scc1 L_end
    v_lshlrev_b32 v1, 4, v0
    v_mov_b64 v[2:3], 0
    v_mov_b64 v[4:5], 0
    s_mov_b32 s45, 1835008
    buffer_store_dwordx4 v[2:5], v1, s[4:7], s45 offen offset:0 sc0 sc1
    buffer_store_dwordx4 v[2:5], v1, s[4:7], s45 offen offset:1024 sc0 sc1
    buffer_store_dwordx4 v[2:5], v1, s[4:7], s45 offen offset:2048 sc0 sc1
    buffer_store_dwordx4 v[2:5], v1, s[4:7], s45 offen offset:3072 sc0 sc1
    s_add_u32 s45, s45, 4096
    buffer_store_dwordx4 v[2:5], v1, s[4:7], s45 offen offset:0 sc0 sc1
    s_waitcnt vmcnt(0)
    v_mov_b32 v1, 192
    v_mov_b32 v2, 1
    global_store_dword v1, v2, s[28:29] sc0 sc1
    s_endpgm
    s_nop 0
L_noinit:
    s_cmp_ge_u32 s31, 208
    s_cbranch_scc1 L_attn_tail
    s_cmp_ge_u32 s31, 192
    s_cbranch_scc1 L_end
    s_cmp_ge_u32 s31, 128
    s_cbranch_scc1 QL_pq
    s_mov_b64 s[8:9], s[68:69]
    s_mov_b64 s[12:13], s[70:71]
    s_lshr_b32 s45, s31, 2
    s_and_b32 s34, s31, 3
    s_lshl_b32 s32, s45, 8
    s_mov_b32 s33, s32
    s_lshl_b32 s35, s45, 14
    s_add_u32 s35, s35, 2097152
    s_add_u32 s36, s35, 8192
    s_mov_b32 s37, 0x80000
    s_mov_b32 s38, 1
    s_branch QL_pe
QL_pq:
    s_mov_b64 s[8:9], s[66:67]
    s_mov_b64 s[12:13], s[66:67]
    s_sub_u32 s46, s31, 128
    s_lshr_b32 s45, s46, 2
    s_and_b32 s34, s46, 3
    s_lshl_b32 s32, s45, 9
    s_add_u32 s33, s32, 256
    s_lshl_b32 s35, s45, 14
    s_add_u32 s35, s35, 35651584
    s_add_u32 s36, s35, 8192
    s_mov_b32 s37, 0x40000
    s_mov_b32 s38, 0
QL_pe:
    s_waitcnt lgkmcnt(0)
    s_mov_b32 s10, 0x400000
    s_mov_b32 s11, 0x20000
    s_mov_b32 s14, 0x400000
    s_mov_b32 s15, 0x20000
    s_cmp_eq_u32 s38, 1
    s_cselect_b32 s45, 2, 3
    s_cselect_b32 s46, 0, 2048
    s_lshr_b32 s63, s32, s45
    s_add_u32 s63, s63, s46
    s_add_u32 s63, s63, 1835008
    s_lshl_b32 s45, s34, 2
    s_add_u32 s63, s63, s45
    s_cmp_eq_u32 s30, 0
    s_cselect_b32 s63, s63, 268435456
    s_load_dwordx2 s[16:17], s[0:1], 72
    s_waitcnt lgkmcnt(0)
    s_mov_b32 s18, 2097152
    s_mov_b32 s19, 0x20000
    v_lshlrev_b32 v4, 4, v0
    v_and_b32 v20, 15, v0
    v_lshrrev_b32 v21, 4, v0
    v_bfe_u32 v22, v0, 2, 2
    v_and_b32 v23, 3, v0
    v_lshlrev_b32 v24, 1, v21
    v_xor_b32 v24, v24, v20
    v_lshlrev_b32 v24, 4, v24
    v_lshl_add_u32 v24, v21, 13, v24
    s_cmp_lt_u32 s30, 2
    s_cselect_b32 s45, s32, s33
    s_cselect_b32 s39, s35, s36
    s_and_b32 s46, s30, 1
    s_lshl_b32 s46, s46, 19
    s_add_u32 s45, s45, s46
    v_add_u32 v1, s45, v24
    v_xor_b32 v2, 128, v1
    v_lshl_add_u32 v24, v21, 3, v22
    v_lshlrev_b32 v24, 8, v24
    v_bfe_u32 v25, v0, 4, 1
    v_lshl_add_u32 v25, v25, 2, v22
    v_lshlrev_b32 v25, 1, v25
    v_lshrrev_b32 v26, 1, v23
    s_and_b32 s45, s30, 1
    s_lshl_b32 s45, s45, 3
    v_add_u32 v26, s45, v26
    v_xor_b32 v25, v25, v26
    v_lshl_add_u32 v24, v25, 4, v24
    v_and_b32 v25, 1, v23
    v_lshl_add_u32 v24, v25, 3, v24
    s_lshr_b32 s45, s30, 1
    s_lshl_b32 s45, s45, 15
    v_add_u32 v3, s45, v24
    s_lshl_b32 s45, s30, 3
    s_add_u32 s45, s45, 0
    s_and_b32 s46, s45, 15
    v_xor_b32 v24, s46, v0
    v_lshlrev_b32 v24, 4, v24
    s_lshl_b32 s45, s45, 10
    v_add_u32 v8, s45, v24
    s_lshl_b32 s45, s30, 3
    s_add_u32 s45, s45, 1
    s_and_b32 s46, s45, 15
    v_xor_b32 v24, s46, v0
    v_lshlrev_b32 v24, 4, v24
    s_lshl_b32 s45, s45, 10
    v_add_u32 v9, s45, v24
    s_lshl_b32 s45, s30, 3
    s_add_u32 s45, s45, 2
    s_and_b32 s46, s45, 15
    v_xor_b32 v24, s46, v0
    v_lshlrev_b32 v24, 4, v24
    s_lshl_b32 s45, s45, 10
    v_add_u32 v10, s45, v24
    s_lshl_b32 s45, s30, 3
    s_add_u32 s45, s45, 3
    s_and_b32 s46, s45, 15
    v_xor_b32 v24, s46, v0
    v_lshlrev_b32 v24, 4, v24
    s_lshl_b32 s45, s45, 10
    v_add_u32 v11, s45, v24
    s_lshl_b32 s45, s30, 3
    s_add_u32 s45, s45, 4
    s_and_b32 s46, s45, 15
    v_xor_b32 v24, s46, v0
    v_lshlrev_b32 v24, 4, v24
    s_lshl_b32 s45, s45, 10
    v_add_u32 v12, s45, v24
    s_lshl_b32 s45, s30, 3
    s_add_u32 s45, s45, 5
    s_and_b32 s46, s45, 15
    v_xor_b32 v24, s46, v0
    v_lshlrev_b32 v24, 4, v24
    s_lshl_b32 s45, s45, 10
    v_add_u32 v13, s45, v24
    s_lshl_b32 s45, s30, 3
    s_add_u32 s45, s45, 6
    s_and_b32 s46, s45, 15
    v_xor_b32 v24, s46, v0
    v_lshlrev_b32 v24, 4, v24
    s_lshl_b32 s45, s45, 10
    v_add_u32 v14, s45, v24
    s_lshl_b32 s45, s30, 3
    s_add_u32 s45, s45, 7
    s_and_b32 s46, s45, 15
    v_xor_b32 v24, s46, v0
    v_lshlrev_b32 v24, 4, v24
    s_lshl_b32 s45, s45, 10
    v_add_u32 v15, s45, v24
    v_add_u32 v24, 0, v21
    v_xor_b32 v24, v24, v20
    v_lshlrev_b32 v24, 4, v24
    v_lshl_add_u32 v16, v20, 10, v24
    v_add_u32 v24, 4, v21
    v_xor_b32 v24, v24, v20
    v_lshlrev_b32 v24, 4, v24
    v_lshl_add_u32 v17, v20, 10, v24
    v_add_u32 v24, 8, v21
    v_xor_b32 v24, v24, v20
    v_lshlrev_b32 v24, 4, v24
    v_lshl_add_u32 v18, v20, 10, v24
    v_add_u32 v24, 12, v21
    v_xor_b32 v24, v24, v20
    v_lshlrev_b32 v24, 4, v24
    v_lshl_add_u32 v19, v20, 10, v24
    s_lshl_b32 s45, s30, 14
    s_cmp_lt_u32 s30, 2
    s_cbranch_scc0 QL_dB0
    s_add_u32 m0, s45, 0
    s_mov_b32 s47, 0
    buffer_load_dwordx4 v1, s[8:11], s47 offen lds
    s_add_u32 m0, s45, 1024
    s_mov_b32 s47, 32768
    buffer_load_dwordx4 v1, s[8:11], s47 offen lds
    s_add_u32 m0, s45, 2048
    s_mov_b32 s47, 65536
    buffer_load_dwordx4 v2, s[8:11], s47 offen lds
    s_add_u32 m0, s45, 3072
    s_mov_b32 s47, 98304
    buffer_load_dwordx4 v2, s[8:11], s47 offen lds
    s_add_u32 m0, s45, 4096
    s_mov_b32 s47, 131072
    buffer_load_dwordx4 v1, s[8:11], s47 offen lds
    s_add_u32 m0, s45, 5120
    s_mov_b32 s47, 163840
    buffer_load_dwordx4 v1, s[8:11], s47 offen lds
    s_add_u32 m0, s45, 6144
    s_mov_b32 s47, 196608
    buffer_load_dwordx4 v2, s[8:11], s47 offen lds
    s_add_u32 m0, s45, 7168
    s_mov_b32 s47, 229376
    buffer_load_dwordx4 v2, s[8:11], s47 offen lds
    s_add_u32 m0, s45, 8192
    s_mov_b32 s47, 262144
    buffer_load_dwordx4 v1, s[8:11], s47 offen lds
    s_add_u32 m0, s45, 9216
    s_mov_b32 s47, 294912
    buffer_load_dwordx4 v1, s[8:11], s47 offen lds
    s_add_u32 m0, s45, 10240
    s_mov_b32 s47, 327680
    buffer_load_dwordx4 v2, s[8:11], s47 offen lds
    s_add_u32 m0, s45, 11264
    s_mov_b32 s47, 360448
    buffer_load_dwordx4 v2, s[8:11], s47 offen lds
    s_add_u32 m0, s45, 12288
    s_mov_b32 s47, 393216
    buffer_load_dwordx4 v1, s[8:11], s47 offen lds
    s_add_u32 m0, s45, 13312
    s_mov_b32 s47, 425984
    buffer_load_dwordx4 v1, s[8:11], s47 offen lds
    s_add_u32 m0, s45, 14336
    s_mov_b32 s47, 458752
    buffer_load_dwordx4 v2, s[8:11], s47 offen lds
    s_add_u32 m0, s45, 15360
    s_mov_b32 s47, 491520
    buffer_load_dwordx4 v2, s[8:11], s47 offen lds
    s_branch QL_dE0
QL_dB0:
    s_add_u32 m0, s45, 0
    s_mov_b32 s47, 0
    buffer_load_dwordx4 v1, s[12:15], s47 offen lds
    s_add_u32 m0, s45, 1024
    s_mov_b32 s47, 32768
    buffer_load_dwordx4 v1, s[12:15], s47 offen lds
    s_add_u32 m0, s45, 2048
    s_mov_b32 s47, 65536
    buffer_load_dwordx4 v2, s[12:15], s47 offen lds
    s_add_u32 m0, s45, 3072
    s_mov_b32 s47, 98304
    buffer_load_dwordx4 v2, s[12:15], s47 offen lds
    s_add_u32 m0, s45, 4096
    s_mov_b32 s47, 131072
    buffer_load_dwordx4 v1, s[12:15], s47 offen lds
    s_add_u32 m0, s45, 5120
    s_mov_b32 s47, 163840
    buffer_load_dwordx4 v1, s[12:15], s47 offen lds
    s_add_u32 m0, s45, 6144
    s_mov_b32 s47, 196608
    buffer_load_dwordx4 v2, s[12:15], s47 offen lds
    s_add_u32 m0, s45, 7168
    s_mov_b32 s47, 229376
    buffer_load_dwordx4 v2, s[12:15], s47 offen lds
    s_add_u32 m0, s45, 8192
    s_mov_b32 s47, 262144
    buffer_load_dwordx4 v1, s[12:15], s47 offen lds
    s_add_u32 m0, s45, 9216
    s_mov_b32 s47, 294912
    buffer_load_dwordx4 v1, s[12:15], s47 offen lds
    s_add_u32 m0, s45, 10240
    s_mov_b32 s47, 327680
    buffer_load_dwordx4 v2, s[12:15], s47 offen lds
    s_add_u32 m0, s45, 11264
    s_mov_b32 s47, 360448
    buffer_load_dwordx4 v2, s[12:15], s47 offen lds
    s_add_u32 m0, s45, 12288
    s_mov_b32 s47, 393216
    buffer_load_dwordx4 v1, s[12:15], s47 offen lds
    s_add_u32 m0, s45, 13312
    s_mov_b32 s47, 425984
    buffer_load_dwordx4 v1, s[12:15], s47 offen lds
    s_add_u32 m0, s45, 14336
    s_mov_b32 s47, 458752
    buffer_load_dwordx4 v2, s[12:15], s47 offen lds
    s_add_u32 m0, s45, 15360
    s_mov_b32 s47, 491520
    buffer_load_dwordx4 v2, s[12:15], s47 offen lds
QL_dE0:
    s_lshl_b32 s45, s30, 14
    s_cmp_lt_u32 s30, 2
    s_cbranch_scc0 QL_dB1
    s_add_u32 m0, s45, 65536
    s_mov_b32 s47, 1048576
    buffer_load_dwordx4 v1, s[8:11], s47 offen lds
    s_add_u32 m0, s45, 66560
    s_mov_b32 s47, 1081344
    buffer_load_dwordx4 v1, s[8:11], s47 offen lds
    s_add_u32 m0, s45, 67584
    s_mov_b32 s47, 1114112
    buffer_load_dwordx4 v2, s[8:11], s47 offen lds
    s_add_u32 m0, s45, 68608
    s_mov_b32 s47, 1146880
    buffer_load_dwordx4 v2, s[8:11], s47 offen lds
    s_add_u32 m0, s45, 69632
    s_mov_b32 s47, 1179648
    buffer_load_dwordx4 v1, s[8:11], s47 offen lds
    s_add_u32 m0, s45, 70656
    s_mov_b32 s47, 1212416
    buffer_load_dwordx4 v1, s[8:11], s47 offen lds
    s_add_u32 m0, s45, 71680
    s_mov_b32 s47, 1245184
    buffer_load_dwordx4 v2, s[8:11], s47 offen lds
    s_add_u32 m0, s45, 72704
    s_mov_b32 s47, 1277952
    buffer_load_dwordx4 v2, s[8:11], s47 offen lds
    s_add_u32 m0, s45, 73728
    s_mov_b32 s47, 1310720
    buffer_load_dwordx4 v1, s[8:11], s47 offen lds
    s_add_u32 m0, s45, 74752
    s_mov_b32 s47, 1343488
    buffer_load_dwordx4 v1, s[8:11], s47 offen lds
    s_add_u32 m0, s45, 75776
    s_mov_b32 s47, 1376256
    buffer_load_dwordx4 v2, s[8:11], s47 offen lds
    s_add_u32 m0, s45, 76800
    s_mov_b32 s47, 1409024
    buffer_load_dwordx4 v2, s[8:11], s47 offen lds
    s_add_u32 m0, s45, 77824
    s_mov_b32 s47, 1441792
    buffer_load_dwordx4 v1, s[8:11], s47 offen lds
    s_add_u32 m0, s45, 78848
    s_mov_b32 s47, 1474560
    buffer_load_dwordx4 v1, s[8:11], s47 offen lds
    s_add_u32 m0, s45, 79872
    s_mov_b32 s47, 1507328
    buffer_load_dwordx4 v2, s[8:11], s47 offen lds
    s_add_u32 m0, s45, 80896
    s_mov_b32 s47, 1540096
    buffer_load_dwordx4 v2, s[8:11], s47 offen lds
    s_branch QL_dE1
QL_dB1:
    s_add_u32 m0, s45, 65536
    s_mov_b32 s47, 1048576
    buffer_load_dwordx4 v1, s[12:15], s47 offen lds
    s_add_u32 m0, s45, 66560
    s_mov_b32 s47, 1081344
    buffer_load_dwordx4 v1, s[12:15], s47 offen lds
    s_add_u32 m0, s45, 67584
    s_mov_b32 s47, 1114112
    buffer_load_dwordx4 v2, s[12:15], s47 offen lds
    s_add_u32 m0, s45, 68608
    s_mov_b32 s47, 1146880
    buffer_load_dwordx4 v2, s[12:15], s47 offen lds
    s_add_u32 m0, s45, 69632
    s_mov_b32 s47, 1179648
    buffer_load_dwordx4 v1, s[12:15], s47 offen lds
    s_add_u32 m0, s45, 70656
    s_mov_b32 s47, 1212416
    buffer_load_dwordx4 v1, s[12:15], s47 offen lds
    s_add_u32 m0, s45, 71680
    s_mov_b32 s47, 1245184
    buffer_load_dwordx4 v2, s[12:15], s47 offen lds
    s_add_u32 m0, s45, 72704
    s_mov_b32 s47, 1277952
    buffer_load_dwordx4 v2, s[12:15], s47 offen lds
    s_add_u32 m0, s45, 73728
    s_mov_b32 s47, 1310720
    buffer_load_dwordx4 v1, s[12:15], s47 offen lds
    s_add_u32 m0, s45, 74752
    s_mov_b32 s47, 1343488
    buffer_load_dwordx4 v1, s[12:15], s47 offen lds
    s_add_u32 m0, s45, 75776
    s_mov_b32 s47, 1376256
    buffer_load_dwordx4 v2, s[12:15], s47 offen lds
    s_add_u32 m0, s45, 76800
    s_mov_b32 s47, 1409024
    buffer_load_dwordx4 v2, s[12:15], s47 offen lds
    s_add_u32 m0, s45, 77824
    s_mov_b32 s47, 1441792
    buffer_load_dwordx4 v1, s[12:15], s47 offen lds
    s_add_u32 m0, s45, 78848
    s_mov_b32 s47, 1474560
    buffer_load_dwordx4 v1, s[12:15], s47 offen lds
    s_add_u32 m0, s45, 79872
    s_mov_b32 s47, 1507328
    buffer_load_dwordx4 v2, s[12:15], s47 offen lds
    s_add_u32 m0, s45, 80896
    s_mov_b32 s47, 1540096
    buffer_load_dwordx4 v2, s[12:15], s47 offen lds
QL_dE1:
    v_lshrrev_b32 v24, 1, v0
    v_lshlrev_b32 v24, 13, v24
    v_and_b32 v25, 1, v0
    v_lshl_add_u32 v24, v25, 7, v24
    s_lshl_b32 s45, s34, 19
    s_and_b32 s46, s30, 1
    s_lshl_b32 s46, s46, 18
    s_add_u32 s45, s45, s46
    s_add_u32 s45, s45, 2097152
    v_lshlrev_b32 v25, 7, v0
    s_lshl_b32 s47, s34, 15
    s_lshl_b32 s46, s30, 13
    s_add_u32 s47, s47, s46
    buffer_load_dword v27, v25, s[16:19], s47 offen
    s_cmp_lt_u32 s30, 2
    s_cbranch_scc0 QL_tB
    s_add_u32 s45, s45, s32
    buffer_load_dword v26, v24, s[8:11], s45 offen
    s_branch QL_tE
QL_tB:
    s_add_u32 s45, s45, s33
    buffer_load_dword v26, v24, s[12:15], s45 offen
QL_tE:
    s_waitcnt vmcnt(18)
    s_barrier
    v_xor_b32 v24, 0, v3
    v_add_u32 v24, 0, v24
    ds_read_b64_tr_b16 a[0:1], v24 offset:0
    ds_read_b64_tr_b16 a[2:3], v24 offset:1024
    ds_read_b64_tr_b16 a[4:5], v24 offset:8192
    ds_read_b64_tr_b16 a[6:7], v24 offset:9216
    ds_read_b64_tr_b16 a[8:9], v24 offset:16384
    ds_read_b64_tr_b16 a[10:11], v24 offset:17408
    ds_read_b64_tr_b16 a[12:13], v24 offset:24576
    ds_read_b64_tr_b16 a[14:15], v24 offset:25600
    s_waitcnt lgkmcnt(8)
    v_xor_b32 v24, 32, v3
    v_add_u32 v24, 0, v24
    ds_read_b64_tr_b16 a[64:65], v24 offset:0
    ds_read_b64_tr_b16 a[66:67], v24 offset:1024
    ds_read_b64_tr_b16 a[68:69], v24 offset:8192
    ds_read_b64_tr_b16 a[70:71], v24 offset:9216
    ds_read_b64_tr_b16 a[72:73], v24 offset:16384
    ds_read_b64_tr_b16 a[74:75], v24 offset:17408
    ds_read_b64_tr_b16 a[76:77], v24 offset:24576
    ds_read_b64_tr_b16 a[78:79], v24 offset:25600
    s_waitcnt lgkmcnt(8)
    v_xor_b32 v24, 64, v3
    v_add_u32 v24, 0, v24
    ds_read_b64_tr_b16 a[128:129], v24 offset:0
    ds_read_b64_tr_b16 a[130:131], v24 offset:1024
    ds_read_b64_tr_b16 a[132:133], v24 offset:8192
    ds_read_b64_tr_b16 a[134:135], v24 offset:9216
    ds_read_b64_tr_b16 a[136:137], v24 offset:16384
    ds_read_b64_tr_b16 a[138:139], v24 offset:17408
    ds_read_b64_tr_b16 a[140:141], v24 offset:24576
    ds_read_b64_tr_b16 a[142:143], v24 offset:25600
    s_waitcnt lgkmcnt(8)
    v_xor_b32 v24, 96, v3
    v_add_u32 v24, 0, v24
    ds_read_b64_tr_b16 a[192:193], v24 offset:0
    ds_read_b64_tr_b16 a[194:195], v24 offset:1024
    ds_read_b64_tr_b16 a[196:197], v24 offset:8192
    ds_read_b64_tr_b16 a[198:199], v24 offset:9216
    ds_read_b64_tr_b16 a[200:201], v24 offset:16384
    ds_read_b64_tr_b16 a[202:203], v24 offset:17408
    ds_read_b64_tr_b16 a[204:205], v24 offset:24576
    ds_read_b64_tr_b16 a[206:207], v24 offset:25600
    s_waitcnt lgkmcnt(8)
    s_waitcnt lgkmcnt(0)
    s_barrier
    s_lshl_b32 s45, s30, 14
    s_cmp_lt_u32 s30, 2
    s_cbranch_scc0 QL_dB2
    s_add_u32 m0, s45, 0
    s_mov_b32 s47, 2097152
    buffer_load_dwordx4 v1, s[8:11], s47 offen lds
    s_add_u32 m0, s45, 1024
    s_mov_b32 s47, 2129920
    buffer_load_dwordx4 v1, s[8:11], s47 offen lds
    s_add_u32 m0, s45, 2048
    s_mov_b32 s47, 2162688
    buffer_load_dwordx4 v2, s[8:11], s47 offen lds
    s_add_u32 m0, s45, 3072
    s_mov_b32 s47, 2195456
    buffer_load_dwordx4 v2, s[8:11], s47 offen lds
    s_add_u32 m0, s45, 4096
    s_mov_b32 s47, 2228224
    buffer_load_dwordx4 v1, s[8:11], s47 offen lds
    s_add_u32 m0, s45, 5120
    s_mov_b32 s47, 2260992
    buffer_load_dwordx4 v1, s[8:11], s47 offen lds
    s_add_u32 m0, s45, 6144
    s_mov_b32 s47, 2293760
    buffer_load_dwordx4 v2, s[8:11], s47 offen lds
    s_add_u32 m0, s45, 7168
    s_mov_b32 s47, 2326528
    buffer_load_dwordx4 v2, s[8:11], s47 offen lds
    s_add_u32 m0, s45, 8192
    s_mov_b32 s47, 2359296
    buffer_load_dwordx4 v1, s[8:11], s47 offen lds
    s_add_u32 m0, s45, 9216
    s_mov_b32 s47, 2392064
    buffer_load_dwordx4 v1, s[8:11], s47 offen lds
    s_add_u32 m0, s45, 10240
    s_mov_b32 s47, 2424832
    buffer_load_dwordx4 v2, s[8:11], s47 offen lds
    s_add_u32 m0, s45, 11264
    s_mov_b32 s47, 2457600
    buffer_load_dwordx4 v2, s[8:11], s47 offen lds
    s_add_u32 m0, s45, 12288
    s_mov_b32 s47, 2490368
    buffer_load_dwordx4 v1, s[8:11], s47 offen lds
    s_add_u32 m0, s45, 13312
    s_mov_b32 s47, 2523136
    buffer_load_dwordx4 v1, s[8:11], s47 offen lds
    s_add_u32 m0, s45, 14336
    s_mov_b32 s47, 2555904
    buffer_load_dwordx4 v2, s[8:11], s47 offen lds
    s_add_u32 m0, s45, 15360
    s_mov_b32 s47, 2588672
    buffer_load_dwordx4 v2, s[8:11], s47 offen lds
    s_branch QL_dE2
QL_dB2:
    s_add_u32 m0, s45, 0
    s_mov_b32 s47, 2097152
    buffer_load_dwordx4 v1, s[12:15], s47 offen lds
    s_add_u32 m0, s45, 1024
    s_mov_b32 s47, 2129920
    buffer_load_dwordx4 v1, s[12:15], s47 offen lds
    s_add_u32 m0, s45, 2048
    s_mov_b32 s47, 2162688
    buffer_load_dwordx4 v2, s[12:15], s47 offen lds
    s_add_u32 m0, s45, 3072
    s_mov_b32 s47, 2195456
    buffer_load_dwordx4 v2, s[12:15], s47 offen lds
    s_add_u32 m0, s45, 4096
    s_mov_b32 s47, 2228224
    buffer_load_dwordx4 v1, s[12:15], s47 offen lds
    s_add_u32 m0, s45, 5120
    s_mov_b32 s47, 2260992
    buffer_load_dwordx4 v1, s[12:15], s47 offen lds
    s_add_u32 m0, s45, 6144
    s_mov_b32 s47, 2293760
    buffer_load_dwordx4 v2, s[12:15], s47 offen lds
    s_add_u32 m0, s45, 7168
    s_mov_b32 s47, 2326528
    buffer_load_dwordx4 v2, s[12:15], s47 offen lds
    s_add_u32 m0, s45, 8192
    s_mov_b32 s47, 2359296
    buffer_load_dwordx4 v1, s[12:15], s47 offen lds
    s_add_u32 m0, s45, 9216
    s_mov_b32 s47, 2392064
    buffer_load_dwordx4 v1, s[12:15], s47 offen lds
    s_add_u32 m0, s45, 10240
    s_mov_b32 s47, 2424832
    buffer_load_dwordx4 v2, s[12:15], s47 offen lds
    s_add_u32 m0, s45, 11264
    s_mov_b32 s47, 2457600
    buffer_load_dwordx4 v2, s[12:15], s47 offen lds
    s_add_u32 m0, s45, 12288
    s_mov_b32 s47, 2490368
    buffer_load_dwordx4 v1, s[12:15], s47 offen lds
    s_add_u32 m0, s45, 13312
    s_mov_b32 s47, 2523136
    buffer_load_dwordx4 v1, s[12:15], s47 offen lds
    s_add_u32 m0, s45, 14336
    s_mov_b32 s47, 2555904
    buffer_load_dwordx4 v2, s[12:15], s47 offen lds
    s_add_u32 m0, s45, 15360
    s_mov_b32 s47, 2588672
    buffer_load_dwordx4 v2, s[12:15], s47 offen lds
QL_dE2:
    s_waitcnt vmcnt(18)
    s_barrier
    v_xor_b32 v24, 0, v3
    v_add_u32 v24, 65536, v24
    ds_read_b64_tr_b16 a[16:17], v24 offset:0
    ds_read_b64_tr_b16 a[18:19], v24 offset:1024
    ds_read_b64_tr_b16 a[20:21], v24 offset:8192
    ds_read_b64_tr_b16 a[22:23], v24 offset:9216
    ds_read_b64_tr_b16 a[24:25], v24 offset:16384
    ds_read_b64_tr_b16 a[26:27], v24 offset:17408
    ds_read_b64_tr_b16 a[28:29], v24 offset:24576
    ds_read_b64_tr_b16 a[30:31], v24 offset:25600
    s_waitcnt lgkmcnt(8)
    v_xor_b32 v24, 32, v3
    v_add_u32 v24, 65536, v24
    ds_read_b64_tr_b16 a[80:81], v24 offset:0
    ds_read_b64_tr_b16 a[82:83], v24 offset:1024
    ds_read_b64_tr_b16 a[84:85], v24 offset:8192
    ds_read_b64_tr_b16 a[86:87], v24 offset:9216
    ds_read_b64_tr_b16 a[88:89], v24 offset:16384
    ds_read_b64_tr_b16 a[90:91], v24 offset:17408
    ds_read_b64_tr_b16 a[92:93], v24 offset:24576
    ds_read_b64_tr_b16 a[94:95], v24 offset:25600
    s_waitcnt lgkmcnt(8)
    v_xor_b32 v24, 64, v3
    v_add_u32 v24, 65536, v24
    ds_read_b64_tr_b16 a[144:145], v24 offset:0
    ds_read_b64_tr_b16 a[146:147], v24 offset:1024
    ds_read_b64_tr_b16 a[148:149], v24 offset:8192
    ds_read_b64_tr_b16 a[150:151], v24 offset:9216
    ds_read_b64_tr_b16 a[152:153], v24 offset:16384
    ds_read_b64_tr_b16 a[154:155], v24 offset:17408
    ds_read_b64_tr_b16 a[156:157], v24 offset:24576
    ds_read_b64_tr_b16 a[158:159], v24 offset:25600
    s_waitcnt lgkmcnt(8)
    v_xor_b32 v24, 96, v3
    v_add_u32 v24, 65536, v24
    ds_read_b64_tr_b16 a[208:209], v24 offset:0
    ds_read_b64_tr_b16 a[210:211], v24 offset:1024
    ds_read_b64_tr_b16 a[212:213], v24 offset:8192
    ds_read_b64_tr_b16 a[214:215], v24 offset:9216
    ds_read_b64_tr_b16 a[216:217], v24 offset:16384
    ds_read_b64_tr_b16 a[218:219], v24 offset:17408
    ds_read_b64_tr_b16 a[220:221], v24 offset:24576
    ds_read_b64_tr_b16 a[222:223], v24 offset:25600
    s_waitcnt lgkmcnt(8)
    s_waitcnt lgkmcnt(0)
    s_barrier
    s_lshl_b32 s45, s30, 14
    s_cmp_lt_u32 s30, 2
    s_cbranch_scc0 QL_dB3
    s_add_u32 m0, s45, 65536
    s_mov_b32 s47, 3145728
    buffer_load_dwordx4 v1, s[8:11], s47 offen lds
    s_add_u32 m0, s45, 66560
    s_mov_b32 s47, 3178496
    buffer_load_dwordx4 v1, s[8:11], s47 offen lds
    s_add_u32 m0, s45, 67584
    s_mov_b32 s47, 3211264
    buffer_load_dwordx4 v2, s[8:11], s47 offen lds
    s_add_u32 m0, s45, 68608
    s_mov_b32 s47, 3244032
    buffer_load_dwordx4 v2, s[8:11], s47 offen lds
    s_add_u32 m0, s45, 69632
    s_mov_b32 s47, 3276800
    buffer_load_dwordx4 v1, s[8:11], s47 offen lds
    s_add_u32 m0, s45, 70656
    s_mov_b32 s47, 3309568
    buffer_load_dwordx4 v1, s[8:11], s47 offen lds
    s_add_u32 m0, s45, 71680
    s_mov_b32 s47, 3342336
    buffer_load_dwordx4 v2, s[8:11], s47 offen lds
    s_add_u32 m0, s45, 72704
    s_mov_b32 s47, 3375104
    buffer_load_dwordx4 v2, s[8:11], s47 offen lds
    s_add_u32 m0, s45, 73728
    s_mov_b32 s47, 3407872
    buffer_load_dwordx4 v1, s[8:11], s47 offen lds
    s_add_u32 m0, s45, 74752
    s_mov_b32 s47, 3440640
    buffer_load_dwordx4 v1, s[8:11], s47 offen lds
    s_add_u32 m0, s45, 75776
    s_mov_b32 s47, 3473408
    buffer_load_dwordx4 v2, s[8:11], s47 offen lds
    s_add_u32 m0, s45, 76800
    s_mov_b32 s47, 3506176
    buffer_load_dwordx4 v2, s[8:11], s47 offen lds
    s_add_u32 m0, s45, 77824
    s_mov_b32 s47, 3538944
    buffer_load_dwordx4 v1, s[8:11], s47 offen lds
    s_add_u32 m0, s45, 78848
    s_mov_b32 s47, 3571712
    buffer_load_dwordx4 v1, s[8:11], s47 offen lds
    s_add_u32 m0, s45, 79872
    s_mov_b32 s47, 3604480
    buffer_load_dwordx4 v2, s[8:11], s47 offen lds
    s_add_u32 m0, s45, 80896
    s_mov_b32 s47, 3637248
    buffer_load_dwordx4 v2, s[8:11], s47 offen lds
    s_branch QL_dE3
QL_dB3:
    s_add_u32 m0, s45, 65536
    s_mov_b32 s47, 3145728
    buffer_load_dwordx4 v1, s[12:15], s47 offen lds
    s_add_u32 m0, s45, 66560
    s_mov_b32 s47, 3178496
    buffer_load_dwordx4 v1, s[12:15], s47 offen lds
    s_add_u32 m0, s45, 67584
    s_mov_b32 s47, 3211264
    buffer_load_dwordx4 v2, s[12:15], s47 offen lds
    s_add_u32 m0, s45, 68608
    s_mov_b32 s47, 3244032
    buffer_load_dwordx4 v2, s[12:15], s47 offen lds
    s_add_u32 m0, s45, 69632
    s_mov_b32 s47, 3276800
    buffer_load_dwordx4 v1, s[12:15], s47 offen lds
    s_add_u32 m0, s45, 70656
    s_mov_b32 s47, 3309568
    buffer_load_dwordx4 v1, s[12:15], s47 offen lds
    s_add_u32 m0, s45, 71680
    s_mov_b32 s47, 3342336
    buffer_load_dwordx4 v2, s[12:15], s47 offen lds
    s_add_u32 m0, s45, 72704
    s_mov_b32 s47, 3375104
    buffer_load_dwordx4 v2, s[12:15], s47 offen lds
    s_add_u32 m0, s45, 73728
    s_mov_b32 s47, 3407872
    buffer_load_dwordx4 v1, s[12:15], s47 offen lds
    s_add_u32 m0, s45, 74752
    s_mov_b32 s47, 3440640
    buffer_load_dwordx4 v1, s[12:15], s47 offen lds
    s_add_u32 m0, s45, 75776
    s_mov_b32 s47, 3473408
    buffer_load_dwordx4 v2, s[12:15], s47 offen lds
    s_add_u32 m0, s45, 76800
    s_mov_b32 s47, 3506176
    buffer_load_dwordx4 v2, s[12:15], s47 offen lds
    s_add_u32 m0, s45, 77824
    s_mov_b32 s47, 3538944
    buffer_load_dwordx4 v1, s[12:15], s47 offen lds
    s_add_u32 m0, s45, 78848
    s_mov_b32 s47, 3571712
    buffer_load_dwordx4 v1, s[12:15], s47 offen lds
    s_add_u32 m0, s45, 79872
    s_mov_b32 s47, 3604480
    buffer_load_dwordx4 v2, s[12:15], s47 offen lds
    s_add_u32 m0, s45, 80896
    s_mov_b32 s47, 3637248
    buffer_load_dwordx4 v2, s[12:15], s47 offen lds
QL_dE3:
    s_waitcnt vmcnt(16)
    s_barrier
    v_xor_b32 v24, 0, v3
    v_add_u32 v24, 0, v24
    ds_read_b64_tr_b16 a[32:33], v24 offset:0
    ds_read_b64_tr_b16 a[34:35], v24 offset:1024
    ds_read_b64_tr_b16 a[36:37], v24 offset:8192
    ds_read_b64_tr_b16 a[38:39], v24 offset:9216
    ds_read_b64_tr_b16 a[40:41], v24 offset:16384
    ds_read_b64_tr_b16 a[42:43], v24 offset:17408
    ds_read_b64_tr_b16 a[44:45], v24 offset:24576
    ds_read_b64_tr_b16 a[46:47], v24 offset:25600
    s_waitcnt lgkmcnt(8)
    v_xor_b32 v24, 32, v3
    v_add_u32 v24, 0, v24
    ds_read_b64_tr_b16 a[96:97], v24 offset:0
    ds_read_b64_tr_b16 a[98:99], v24 offset:1024
    ds_read_b64_tr_b16 a[100:101], v24 offset:8192
    ds_read_b64_tr_b16 a[102:103], v24 offset:9216
    ds_read_b64_tr_b16 a[104:105], v24 offset:16384
    ds_read_b64_tr_b16 a[106:107], v24 offset:17408
    ds_read_b64_tr_b16 a[108:109], v24 offset:24576
    ds_read_b64_tr_b16 a[110:111], v24 offset:25600
    s_waitcnt lgkmcnt(8)
    v_xor_b32 v24, 64, v3
    v_add_u32 v24, 0, v24
    ds_read_b64_tr_b16 a[160:161], v24 offset:0
    ds_read_b64_tr_b16 a[162:163], v24 offset:1024
    ds_read_b64_tr_b16 a[164:165], v24 offset:8192
    ds_read_b64_tr_b16 a[166:167], v24 offset:9216
    ds_read_b64_tr_b16 a[168:169], v24 offset:16384
    ds_read_b64_tr_b16 a[170:171], v24 offset:17408
    ds_read_b64_tr_b16 a[172:173], v24 offset:24576
    ds_read_b64_tr_b16 a[174:175], v24 offset:25600
    s_waitcnt lgkmcnt(8)
    v_xor_b32 v24, 96, v3
    v_add_u32 v24, 0, v24
    ds_read_b64_tr_b16 a[224:225], v24 offset:0
    ds_read_b64_tr_b16 a[226:227], v24 offset:1024
    ds_read_b64_tr_b16 a[228:229], v24 offset:8192
    ds_read_b64_tr_b16 a[230:231], v24 offset:9216
    ds_read_b64_tr_b16 a[232:233], v24 offset:16384
    ds_read_b64_tr_b16 a[234:235], v24 offset:17408
    ds_read_b64_tr_b16 a[236:237], v24 offset:24576
    ds_read_b64_tr_b16 a[238:239], v24 offset:25600
    s_waitcnt lgkmcnt(8)
    s_waitcnt lgkmcnt(0)
    s_barrier
    s_lshl_b32 s40, s34, 15
    s_lshl_b32 s45, s30, 13
    s_add_u32 m0, s45, 0
    s_nop 0
    buffer_load_dwordx4 v8, s[16:19], s40 offen lds
    s_lshl_b32 s45, s30, 13
    s_add_u32 m0, s45, 1024
    s_nop 0
    buffer_load_dwordx4 v9, s[16:19], s40 offen lds
    s_lshl_b32 s45, s30, 13
    s_add_u32 m0, s45, 2048
    s_nop 0
    buffer_load_dwordx4 v10, s[16:19], s40 offen lds
    s_lshl_b32 s45, s30, 13
    s_add_u32 m0, s45, 3072
    s_nop 0
    buffer_load_dwordx4 v11, s[16:19], s40 offen lds
    s_lshl_b32 s45, s30, 13
    s_add_u32 m0, s45, 4096
    s_nop 0
    buffer_load_dwordx4 v12, s[16:19], s40 offen lds
    s_lshl_b32 s45, s30, 13
    s_add_u32 m0, s45, 5120
    s_nop 0
    buffer_load_dwordx4 v13, s[16:19], s40 offen lds
    s_lshl_b32 s45, s30, 13
    s_add_u32 m0, s45, 6144
    s_nop 0
    buffer_load_dwordx4 v14, s[16:19], s40 offen lds
    s_lshl_b32 s45, s30, 13
    s_add_u32 m0, s45, 7168
    s_nop 0
    buffer_load_dwordx4 v15, s[16:19], s40 offen lds
    s_waitcnt vmcnt(0)
    s_barrier
    v_xor_b32 v24, 0, v3
    v_add_u32 v24, 65536, v24
    ds_read_b64_tr_b16 a[48:49], v24 offset:0
    ds_read_b64_tr_b16 a[50:51], v24 offset:1024
    ds_read_b64_tr_b16 a[52:53], v24 offset:8192
    ds_read_b64_tr_b16 a[54:55], v24 offset:9216
    ds_read_b64_tr_b16 a[56:57], v24 offset:16384
    ds_read_b64_tr_b16 a[58:59], v24 offset:17408
    ds_read_b64_tr_b16 a[60:61], v24 offset:24576
    ds_read_b64_tr_b16 a[62:63], v24 offset:25600
    s_waitcnt lgkmcnt(8)
    v_xor_b32 v24, 32, v3
    v_add_u32 v24, 65536, v24
    ds_read_b64_tr_b16 a[112:113], v24 offset:0
    ds_read_b64_tr_b16 a[114:115], v24 offset:1024
    ds_read_b64_tr_b16 a[116:117], v24 offset:8192
    ds_read_b64_tr_b16 a[118:119], v24 offset:9216
    ds_read_b64_tr_b16 a[120:121], v24 offset:16384
    ds_read_b64_tr_b16 a[122:123], v24 offset:17408
    ds_read_b64_tr_b16 a[124:125], v24 offset:24576
    ds_read_b64_tr_b16 a[126:127], v24 offset:25600
    s_waitcnt lgkmcnt(8)
    v_xor_b32 v24, 64, v3
    v_add_u32 v24, 65536, v24
    ds_read_b64_tr_b16 a[176:177], v24 offset:0
    ds_read_b64_tr_b16 a[178:179], v24 offset:1024
    ds_read_b64_tr_b16 a[180:181], v24 offset:8192
    ds_read_b64_tr_b16 a[182:183], v24 offset:9216
    ds_read_b64_tr_b16 a[184:185], v24 offset:16384
    ds_read_b64_tr_b16 a[186:187], v24 offset:17408
    ds_read_b64_tr_b16 a[188:189], v24 offset:24576
    ds_read_b64_tr_b16 a[190:191], v24 offset:25600
    s_waitcnt lgkmcnt(8)
    v_xor_b32 v24, 96, v3
    v_add_u32 v24, 65536, v24
    ds_read_b64_tr_b16 a[240:241], v24 offset:0
    ds_read_b64_tr_b16 a[242:243], v24 offset:1024
    ds_read_b64_tr_b16 a[244:245], v24 offset:8192
    ds_read_b64_tr_b16 a[246:247], v24 offset:9216
    ds_read_b64_tr_b16 a[248:249], v24 offset:16384
    ds_read_b64_tr_b16 a[250:251], v24 offset:17408
    ds_read_b64_tr_b16 a[252:253], v24 offset:24576
    ds_read_b64_tr_b16 a[254:255], v24 offset:25600
    s_waitcnt lgkmcnt(8)
    s_waitcnt lgkmcnt(0)
    s_barrier
    v_mov_b32 v254, 192
    s_mov_b32 s62, 0
    s_nop 0
L_w0:
    global_load_dword v255, v254, s[28:29] sc1
    s_add_u32 s62, s62, 1
    s_cmp_gt_u32 s62, 2000000
    s_cbranch_scc1 L_end
    s_waitcnt vmcnt(0)
    v_cmp_eq_u32 vcc, 0, v255
    s_nop 0
    s_cbranch_vccnz L_w0
    s_mul_i32 s45, s34, s37
    s_add_u32 s39, s39, s45
    s_lshl_b32 s37, s37, 2
    s_and_b32 s45, s30, 1
    s_mov_b32 s41, 0
    s_mov_b32 s42, 1040356334
    s_cmp_lt_u32 s30, 2
    s_cselect_b32 s46, 0, s38
    s_cmp_eq_u32 s46, 1
    s_cbranch_scc1 QL_vtype
    s_lshl_b32 s45, s45, 11
    s_add_u32 s39, s39, s45
QL_k0:
    s_sub_u32 s43, s41, 1
    s_cmp_gt_u32 s41, 1
    s_cbranch_scc1 QL_k0_w
    s_mov_b32 s43, s41
    s_waitcnt vmcnt(0)
QL_k0_w:
    s_waitcnt vmcnt(4)
    s_barrier
    v_mov_b32 v255, s43
    buffer_store_dword v255, off, s[4:7], s63 sc0 sc1
    s_add_u32 s40, s40, 131072
    ds_read_b128 v[64:67], v16 offset:0
    ds_read_b128 v[68:71], v16 offset:16384
    ds_read_b128 v[72:75], v17 offset:0
    ds_read_b128 v[76:79], v17 offset:16384
    ds_read_b128 v[80:83], v18 offset:0
    ds_read_b128 v[84:87], v18 offset:16384
    s_waitcnt lgkmcnt(4)
    v_mfma_f32_16x16x32_bf16 v[32:35], a[0:3], v[64:67], 0
    v_mfma_f32_16x16x32_bf16 v[40:43], a[64:67], v[64:67], 0
    ds_read_b128 v[88:91], v19 offset:0
    v_mfma_f32_16x16x32_bf16 v[48:51], a[128:131], v[64:67], 0
    v_mfma_f32_16x16x32_bf16 v[56:59], a[192:195], v[64:67], 0
    s_lshl_b32 s45, s30, 13
    s_add_u32 m0, s45, 32768
    s_nop 0
    buffer_load_dwordx4 v8, s[16:19], s40 offen lds
    v_mfma_f32_16x16x32_bf16 v[36:39], a[0:3], v[68:71], 0
    v_mfma_f32_16x16x32_bf16 v[44:47], a[64:67], v[68:71], 0
    ds_read_b128 v[92:95], v19 offset:16384
    v_mfma_f32_16x16x32_bf16 v[52:55], a[128:131], v[68:71], 0
    v_mfma_f32_16x16x32_bf16 v[60:63], a[192:195], v[68:71], 0
    s_waitcnt lgkmcnt(4)
    v_mfma_f32_16x16x32_bf16 v[32:35], a[4:7], v[72:75], v[32:35]
    v_mfma_f32_16x16x32_bf16 v[40:43], a[68:71], v[72:75], v[40:43]
    ds_read_b128 v[64:67], v16 offset:256
    v_mfma_f32_16x16x32_bf16 v[48:51], a[132:135], v[72:75], v[48:51]
    v_mfma_f32_16x16x32_bf16 v[56:59], a[196:199], v[72:75], v[56:59]
    s_lshl_b32 s45, s30, 13
    s_add_u32 m0, s45, 33792
    s_nop 0
    buffer_load_dwordx4 v9, s[16:19], s40 offen lds
    v_mfma_f32_16x16x32_bf16 v[36:39], a[4:7], v[76:79], v[36:39]
    v_mfma_f32_16x16x32_bf16 v[44:47], a[68:71], v[76:79], v[44:47]
    ds_read_b128 v[68:71], v16 offset:16640
    v_mfma_f32_16x16x32_bf16 v[52:55], a[132:135], v[76:79], v[52:55]
    v_mfma_f32_16x16x32_bf16 v[60:63], a[196:199], v[76:79], v[60:63]
    s_waitcnt lgkmcnt(4)
    v_mfma_f32_16x16x32_bf16 v[32:35], a[8:11], v[80:83], v[32:35]
    v_mfma_f32_16x16x32_bf16 v[40:43], a[72:75], v[80:83], v[40:43]
    ds_read_b128 v[72:75], v17 offset:256
    v_mfma_f32_16x16x32_bf16 v[48:51], a[136:139], v[80:83], v[48:51]
    v_mfma_f32_16x16x32_bf16 v[56:59], a[200:203], v[80:83], v[56:59]
    s_lshl_b32 s45, s30, 13
    s_add_u32 m0, s45, 34816
    s_nop 0
    buffer_load_dwordx4 v10, s[16:19], s40 offen lds
    v_mfma_f32_16x16x32_bf16 v[36:39], a[8:11], v[84:87], v[36:39]
    v_mfma_f32_16x16x32_bf16 v[44:47], a[72:75], v[84:87], v[44:47]
    ds_read_b128 v[76:79], v17 offset:16640
    v_mfma_f32_16x16x32_bf16 v[52:55], a[136:139], v[84:87], v[52:55]
    v_mfma_f32_16x16x32_bf16 v[60:63], a[200:203], v[84:87], v[60:63]
    s_waitcnt lgkmcnt(4)
    v_mfma_f32_16x16x32_bf16 v[32:35], a[12:15], v[88:91], v[32:35]
    v_mfma_f32_16x16x32_bf16 v[40:43], a[76:79], v[88:91], v[40:43]
    ds_read_b128 v[80:83], v18 offset:256
    v_mfma_f32_16x16x32_bf16 v[48:51], a[140:143], v[88:91], v[48:51]
    v_mfma_f32_16x16x32_bf16 v[56:59], a[204:207], v[88:91], v[56:59]
    s_lshl_b32 s45, s30, 13
    s_add_u32 m0, s45, 35840
    s_nop 0
    buffer_load_dwordx4 v11, s[16:19], s40 offen lds
    v_mfma_f32_16x16x32_bf16 v[36:39], a[12:15], v[92:95], v[36:39]
    v_mfma_f32_16x16x32_bf16 v[44:47], a[76:79], v[92:95], v[44:47]
    ds_read_b128 v[84:87], v18 offset:16640
    v_mfma_f32_16x16x32_bf16 v[52:55], a[140:143], v[92:95], v[52:55]
    v_mfma_f32_16x16x32_bf16 v[60:63], a[204:207], v[92:95], v[60:63]
    s_waitcnt lgkmcnt(4)
    v_mfma_f32_16x16x32_bf16 v[32:35], a[16:19], v[64:67], v[32:35]
    v_mfma_f32_16x16x32_bf16 v[40:43], a[80:83], v[64:67], v[40:43]
    ds_read_b128 v[88:91], v19 offset:256
    v_mfma_f32_16x16x32_bf16 v[48:51], a[144:147], v[64:67], v[48:51]
    v_mfma_f32_16x16x32_bf16 v[56:59], a[208:211], v[64:67], v[56:59]
    s_lshl_b32 s45, s30, 13
    s_add_u32 m0, s45, 36864
    s_nop 0
    buffer_load_dwordx4 v12, s[16:19], s40 offen lds
    v_mfma_f32_16x16x32_bf16 v[36:39], a[16:19], v[68:71], v[36:39]
    v_mfma_f32_16x16x32_bf16 v[44:47], a[80:83], v[68:71], v[44:47]
    ds_read_b128 v[92:95], v19 offset:16640
    v_mfma_f32_16x16x32_bf16 v[52:55], a[144:147], v[68:71], v[52:55]
    v_mfma_f32_16x16x32_bf16 v[60:63], a[208:211], v[68:71], v[60:63]
    s_waitcnt lgkmcnt(4)
    v_mfma_f32_16x16x32_bf16 v[32:35], a[20:23], v[72:75], v[32:35]
    v_mfma_f32_16x16x32_bf16 v[40:43], a[84:87], v[72:75], v[40:43]
    ds_read_b128 v[64:67], v16 offset:512
    v_mfma_f32_16x16x32_bf16 v[48:51], a[148:151], v[72:75], v[48:51]
    v_mfma_f32_16x16x32_bf16 v[56:59], a[212:215], v[72:75], v[56:59]
    s_lshl_b32 s45, s30, 13
    s_add_u32 m0, s45, 37888
    s_nop 0
    buffer_load_dwordx4 v13, s[16:19], s40 offen lds
    v_mfma_f32_16x16x32_bf16 v[36:39], a[20:23], v[76:79], v[36:39]
    v_mfma_f32_16x16x32_bf16 v[44:47], a[84:87], v[76:79], v[44:47]
    ds_read_b128 v[68:71], v16 offset:16896
    v_mfma_f32_16x16x32_bf16 v[52:55], a[148:151], v[76:79], v[52:55]
    v_mfma_f32_16x16x32_bf16 v[60:63], a[212:215], v[76:79], v[60:63]
    s_waitcnt lgkmcnt(4)
    v_mfma_f32_16x16x32_bf16 v[32:35], a[24:27], v[80:83], v[32:35]
    v_mfma_f32_16x16x32_bf16 v[40:43], a[88:91], v[80:83], v[40:43]
    ds_read_b128 v[72:75], v17 offset:512
    v_mfma_f32_16x16x32_bf16 v[48:51], a[152:155], v[80:83], v[48:51]
    v_mfma_f32_16x16x32_bf16 v[56:59], a[216:219], v[80:83], v[56:59]
    s_lshl_b32 s45, s30, 13
    s_add_u32 m0, s45, 38912
    s_nop 0
    buffer_load_dwordx4 v14, s[16:19], s40 offen lds
    v_mfma_f32_16x16x32_bf16 v[36:39], a[24:27], v[84:87], v[36:39]
    v_mfma_f32_16x16x32_bf16 v[44:47], a[88:91], v[84:87], v[44:47]
    ds_read_b128 v[76:79], v17 offset:16896
    v_mfma_f32_16x16x32_bf16 v[52:55], a[152:155], v[84:87], v[52:55]
    v_mfma_f32_16x16x32_bf16 v[60:63], a[216:219], v[84:87], v[60:63]
    s_waitcnt lgkmcnt(4)
    v_mfma_f32_16x16x32_bf16 v[32:35], a[28:31], v[88:91], v[32:35]
    v_mfma_f32_16x16x32_bf16 v[40:43], a[92:95], v[88:91], v[40:43]
    ds_read_b128 v[80:83], v18 offset:512
    v_mfma_f32_16x16x32_bf16 v[48:51], a[156:159], v[88:91], v[48:51]
    v_mfma_f32_16x16x32_bf16 v[56:59], a[220:223], v[88:91], v[56:59]
    s_lshl_b32 s45, s30, 13
    s_add_u32 m0, s45, 39936
    s_nop 0
    buffer_load_dwordx4 v15, s[16:19], s40 offen lds
    v_mfma_f32_16x16x32_bf16 v[36:39], a[28:31], v[92:95], v[36:39]
    v_mfma_f32_16x16x32_bf16 v[44:47], a[92:95], v[92:95], v[44:47]
    ds_read_b128 v[84:87], v18 offset:16896
    v_mfma_f32_16x16x32_bf16 v[52:55], a[156:159], v[92:95], v[52:55]
    v_mfma_f32_16x16x32_bf16 v[60:63], a[220:223], v[92:95], v[60:63]
    s_waitcnt lgkmcnt(4)
    v_mfma_f32_16x16x32_bf16 v[32:35], a[32:35], v[64:67], v[32:35]
    v_mfma_f32_16x16x32_bf16 v[40:43], a[96:99], v[64:67], v[40:43]
    ds_read_b128 v[88:91], v19 offset:512
    v_mfma_f32_16x16x32_bf16 v[48:51], a[160:163], v[64:67], v[48:51]
    v_mfma_f32_16x16x32_bf16 v[56:59], a[224:227], v[64:67], v[56:59]
    v_mfma_f32_16x16x32_bf16 v[36:39], a[32:35], v[68:71], v[36:39]
    v_mfma_f32_16x16x32_bf16 v[44:47], a[96:99], v[68:71], v[44:47]
    ds_read_b128 v[92:95], v19 offset:16896
    v_mfma_f32_16x16x32_bf16 v[52:55], a[160:163], v[68:71], v[52:55]
    v_mfma_f32_16x16x32_bf16 v[60:63], a[224:227], v[68:71], v[60:63]
    s_waitcnt lgkmcnt(4)
    v_mfma_f32_16x16x32_bf16 v[32:35], a[36:39], v[72:75], v[32:35]
    v_mfma_f32_16x16x32_bf16 v[40:43], a[100:103], v[72:75], v[40:43]
    ds_read_b128 v[64:67], v16 offset:768
    v_mfma_f32_16x16x32_bf16 v[48:51], a[164:167], v[72:75], v[48:51]
    v_mfma_f32_16x16x32_bf16 v[56:59], a[228:231], v[72:75], v[56:59]
    v_mfma_f32_16x16x32_bf16 v[36:39], a[36:39], v[76:79], v[36:39]
    v_mfma_f32_16x16x32_bf16 v[44:47], a[100:103], v[76:79], v[44:47]
    ds_read_b128 v[68:71], v16 offset:17152
    v_mfma_f32_16x16x32_bf16 v[52:55], a[164:167], v[76:79], v[52:55]
    v_mfma_f32_16x16x32_bf16 v[60:63], a[228:231], v[76:79], v[60:63]
    s_waitcnt lgkmcnt(4)
    v_mfma_f32_16x16x32_bf16 v[32:35], a[40:43], v[80:83], v[32:35]
    v_mfma_f32_16x16x32_bf16 v[40:43], a[104:107], v[80:83], v[40:43]
    ds_read_b128 v[72:75], v17 offset:768
    v_mfma_f32_16x16x32_bf16 v[48:51], a[168:171], v[80:83], v[48:51]
    v_mfma_f32_16x16x32_bf16 v[56:59], a[232:235], v[80:83], v[56:59]
    v_mfma_f32_16x16x32_bf16 v[36:39], a[40:43], v[84:87], v[36:39]
    v_mfma_f32_16x16x32_bf16 v[44:47], a[104:107], v[84:87], v[44:47]
    ds_read_b128 v[76:79], v17 offset:17152
    v_mfma_f32_16x16x32_bf16 v[52:55], a[168:171], v[84:87], v[52:55]
    v_mfma_f32_16x16x32_bf16 v[60:63], a[232:235], v[84:87], v[60:63]
    s_waitcnt lgkmcnt(4)
    v_mfma_f32_16x16x32_bf16 v[32:35], a[44:47], v[88:91], v[32:35]
    v_mfma_f32_16x16x32_bf16 v[40:43], a[108:111], v[88:91], v[40:43]
    ds_read_b128 v[80:83], v18 offset:768
    v_mfma_f32_16x16x32_bf16 v[48:51], a[172:175], v[88:91], v[48:51]
    v_mfma_f32_16x16x32_bf16 v[56:59], a[236:239], v[88:91], v[56:59]
    v_mfma_f32_16x16x32_bf16 v[36:39], a[44:47], v[92:95], v[36:39]
    v_mfma_f32_16x16x32_bf16 v[44:47], a[108:111], v[92:95], v[44:47]
    ds_read_b128 v[84:87], v18 offset:17152
    v_mfma_f32_16x16x32_bf16 v[52:55], a[172:175], v[92:95], v[52:55]
    v_mfma_f32_16x16x32_bf16 v[60:63], a[236:239], v[92:95], v[60:63]
    s_waitcnt lgkmcnt(4)
    v_mfma_f32_16x16x32_bf16 v[32:35], a[48:51], v[64:67], v[32:35]
    v_mfma_f32_16x16x32_bf16 v[40:43], a[112:115], v[64:67], v[40:43]
    ds_read_b128 v[88:91], v19 offset:768
    v_mfma_f32_16x16x32_bf16 v[48:51], a[176:179], v[64:67], v[48:51]
    v_mfma_f32_16x16x32_bf16 v[56:59], a[240:243], v[64:67], v[56:59]
    v_mfma_f32_16x16x32_bf16 v[36:39], a[48:51], v[68:71], v[36:39]
    v_mfma_f32_16x16x32_bf16 v[44:47], a[112:115], v[68:71], v[44:47]
    ds_read_b128 v[92:95], v19 offset:17152
    v_mfma_f32_16x16x32_bf16 v[52:55], a[176:179], v[68:71], v[52:55]
    v_mfma_f32_16x16x32_bf16 v[60:63], a[240:243], v[68:71], v[60:63]
    s_waitcnt lgkmcnt(4)
    v_mfma_f32_16x16x32_bf16 v[32:35], a[52:55], v[72:75], v[32:35]
    v_mfma_f32_16x16x32_bf16 v[40:43], a[116:119], v[72:75], v[40:43]
    v_mfma_f32_16x16x32_bf16 v[48:51], a[180:183], v[72:75], v[48:51]
    v_mfma_f32_16x16x32_bf16 v[56:59], a[244:247], v[72:75], v[56:59]
    v_mfma_f32_16x16x32_bf16 v[36:39], a[52:55], v[76:79], v[36:39]
    v_mfma_f32_16x16x32_bf16 v[44:47], a[116:119], v[76:79], v[44:47]
    v_mfma_f32_16x16x32_bf16 v[52:55], a[180:183], v[76:79], v[52:55]
    v_mfma_f32_16x16x32_bf16 v[60:63], a[244:247], v[76:79], v[60:63]
    s_waitcnt lgkmcnt(2)
    v_mfma_f32_16x16x32_bf16 v[32:35], a[56:59], v[80:83], v[32:35]
    v_mfma_f32_16x16x32_bf16 v[40:43], a[120:123], v[80:83], v[40:43]
    v_mfma_f32_16x16x32_bf16 v[48:51], a[184:187], v[80:83], v[48:51]
    v_mfma_f32_16x16x32_bf16 v[56:59], a[248:251], v[80:83], v[56:59]
    v_mfma_f32_16x16x32_bf16 v[36:39], a[56:59], v[84:87], v[36:39]
    v_mfma_f32_16x16x32_bf16 v[44:47], a[120:123], v[84:87], v[44:47]
    v_mfma_f32_16x16x32_bf16 v[52:55], a[184:187], v[84:87], v[52:55]
    v_mfma_f32_16x16x32_bf16 v[60:63], a[248:251], v[84:87], v[60:63]
    s_waitcnt lgkmcnt(0)
    v_mfma_f32_16x16x32_bf16 v[32:35], a[60:63], v[88:91], v[32:35]
    v_mfma_f32_16x16x32_bf16 v[40:43], a[124:127], v[88:91], v[40:43]
    v_mfma_f32_16x16x32_bf16 v[48:51], a[188:191], v[88:91], v[48:51]
    v_mfma_f32_16x16x32_bf16 v[56:59], a[252:255], v[88:91], v[56:59]
    v_mfma_f32_16x16x32_bf16 v[36:39], a[60:63], v[92:95], v[36:39]
    v_mfma_f32_16x16x32_bf16 v[44:47], a[124:127], v[92:95], v[44:47]
    v_mfma_f32_16x16x32_bf16 v[52:55], a[188:191], v[92:95], v[52:55]
    v_mfma_f32_16x16x32_bf16 v[60:63], a[252:255], v[92:95], v[60:63]
    s_cmp_eq_u32 s38, 1
    s_nop 5
    s_cbranch_scc1 QL_k0_ns
    v_mul_f32 v32, s42, v32
    v_mul_f32 v33, s42, v33
    v_mul_f32 v34, s42, v34
    v_mul_f32 v35, s42, v35
    v_mul_f32 v36, s42, v36
    v_mul_f32 v37, s42, v37
    v_mul_f32 v38, s42, v38
    v_mul_f32 v39, s42, v39
    v_mul_f32 v40, s42, v40
    v_mul_f32 v41, s42, v41
    v_mul_f32 v42, s42, v42
    v_mul_f32 v43, s42, v43
    v_mul_f32 v44, s42, v44
    v_mul_f32 v45, s42, v45
    v_mul_f32 v46, s42, v46
    v_mul_f32 v47, s42, v47
    v_mul_f32 v48, s42, v48
    v_mul_f32 v49, s42, v49
    v_mul_f32 v50, s42, v50
    v_mul_f32 v51, s42, v51
    v_mul_f32 v52, s42, v52
    v_mul_f32 v53, s42, v53
    v_mul_f32 v54, s42, v54
    v_mul_f32 v55, s42, v55
    v_mul_f32 v56, s42, v56
    v_mul_f32 v57, s42, v57
    v_mul_f32 v58, s42, v58
    v_mul_f32 v59, s42, v59
    v_mul_f32 v60, s42, v60
    v_mul_f32 v61, s42, v61
    v_mul_f32 v62, s42, v62
    v_mul_f32 v63, s42, v63
    s_nop 1
QL_k0_ns:
    v_cvt_pk_bf16_f32 v96, v32, v33
    v_cvt_pk_bf16_f32 v97, v34, v35
    v_cvt_pk_bf16_f32 v98, v40, v41
    v_cvt_pk_bf16_f32 v99, v42, v43
    buffer_store_dwordx4 v[96:99], v4, s[4:7], s39 offen offset:0 sc0 sc1
    v_cvt_pk_bf16_f32 v100, v48, v49
    v_cvt_pk_bf16_f32 v101, v50, v51
    v_cvt_pk_bf16_f32 v102, v56, v57
    v_cvt_pk_bf16_f32 v103, v58, v59
    buffer_store_dwordx4 v[100:103], v4, s[4:7], s39 offen offset:1024 sc0 sc1
    v_cvt_pk_bf16_f32 v104, v36, v37
    v_cvt_pk_bf16_f32 v105, v38, v39
    v_cvt_pk_bf16_f32 v106, v44, v45
    v_cvt_pk_bf16_f32 v107, v46, v47
    s_add_u32 s46, s39, 4096
    buffer_store_dwordx4 v[104:107], v4, s[4:7], s46 offen offset:0 sc0 sc1
    v_cvt_pk_bf16_f32 v108, v52, v53
    v_cvt_pk_bf16_f32 v109, v54, v55
    v_cvt_pk_bf16_f32 v110, v60, v61
    v_cvt_pk_bf16_f32 v111, v62, v63
    s_add_u32 s46, s39, 4096
    buffer_store_dwordx4 v[108:111], v4, s[4:7], s46 offen offset:1024 sc0 sc1
    s_add_u32 s39, s39, s37
    s_add_u32 s41, s41, 1
QL_k1:
    s_sub_u32 s43, s41, 1
    s_cmp_gt_u32 s41, 1
    s_cbranch_scc1 QL_k1_w
    s_mov_b32 s43, s41
    s_waitcnt vmcnt(0)
QL_k1_w:
    s_waitcnt vmcnt(4)
    s_barrier
    v_mov_b32 v255, s43
    buffer_store_dword v255, off, s[4:7], s63 sc0 sc1
    s_add_u32 s40, s40, 131072
    ds_read_b128 v[64:67], v16 offset:32768
    ds_read_b128 v[68:71], v16 offset:49152
    ds_read_b128 v[72:75], v17 offset:32768
    ds_read_b128 v[76:79], v17 offset:49152
    ds_read_b128 v[80:83], v18 offset:32768
    ds_read_b128 v[84:87], v18 offset:49152
    s_waitcnt lgkmcnt(4)
    v_mfma_f32_16x16x32_bf16 v[32:35], a[0:3], v[64:67], 0
    v_mfma_f32_16x16x32_bf16 v[40:43], a[64:67], v[64:67], 0
    ds_read_b128 v[88:91], v19 offset:32768
    v_mfma_f32_16x16x32_bf16 v[48:51], a[128:131], v[64:67], 0
    v_mfma_f32_16x16x32_bf16 v[56:59], a[192:195], v[64:67], 0
    s_lshl_b32 s45, s30, 13
    s_add_u32 m0, s45, 0
    s_nop 0
    buffer_load_dwordx4 v8, s[16:19], s40 offen lds
    v_mfma_f32_16x16x32_bf16 v[36:39], a[0:3], v[68:71], 0
    v_mfma_f32_16x16x32_bf16 v[44:47], a[64:67], v[68:71], 0
    ds_read_b128 v[92:95], v19 offset:49152
    v_mfma_f32_16x16x32_bf16 v[52:55], a[128:131], v[68:71], 0
    v_mfma_f32_16x16x32_bf16 v[60:63], a[192:195], v[68:71], 0
    s_waitcnt lgkmcnt(4)
    v_mfma_f32_16x16x32_bf16 v[32:35], a[4:7], v[72:75], v[32:35]
    v_mfma_f32_16x16x32_bf16 v[40:43], a[68:71], v[72:75], v[40:43]
    ds_read_b128 v[64:67], v16 offset:33024
    v_mfma_f32_16x16x32_bf16 v[48:51], a[132:135], v[72:75], v[48:51]
    v_mfma_f32_16x16x32_bf16 v[56:59], a[196:199], v[72:75], v[56:59]
    s_lshl_b32 s45, s30, 13
    s_add_u32 m0, s45, 1024
    s_nop 0
    buffer_load_dwordx4 v9, s[16:19], s40 offen lds
    v_mfma_f32_16x16x32_bf16 v[36:39], a[4:7], v[76:79], v[36:39]
    v_mfma_f32_16x16x32_bf16 v[44:47], a[68:71], v[76:79], v[44:47]
    ds_read_b128 v[68:71], v16 offset:49408
    v_mfma_f32_16x16x32_bf16 v[52:55], a[132:135], v[76:79], v[52:55]
    v_mfma_f32_16x16x32_bf16 v[60:63], a[196:199], v[76:79], v[60:63]
    s_waitcnt lgkmcnt(4)
    v_mfma_f32_16x16x32_bf16 v[32:35], a[8:11], v[80:83], v[32:35]
    v_mfma_f32_16x16x32_bf16 v[40:43], a[72:75], v[80:83], v[40:43]
    ds_read_b128 v[72:75], v17 offset:33024
    v_mfma_f32_16x16x32_bf16 v[48:51], a[136:139], v[80:83], v[48:51]
    v_mfma_f32_16x16x32_bf16 v[56:59], a[200:203], v[80:83], v[56:59]
    s_lshl_b32 s45, s30, 13
    s_add_u32 m0, s45, 2048
    s_nop 0
    buffer_load_dwordx4 v10, s[16:19], s40 offen lds
    v_mfma_f32_16x16x32_bf16 v[36:39], a[8:11], v[84:87], v[36:39]
    v_mfma_f32_16x16x32_bf16 v[44:47], a[72:75], v[84:87], v[44:47]
    ds_read_b128 v[76:79], v17 offset:49408
    v_mfma_f32_16x16x32_bf16 v[52:55], a[136:139], v[84:87], v[52:55]
    v_mfma_f32_16x16x32_bf16 v[60:63], a[200:203], v[84:87], v[60:63]
    s_waitcnt lgkmcnt(4)
    v_mfma_f32_16x16x32_bf16 v[32:35], a[12:15], v[88:91], v[32:35]
    v_mfma_f32_16x16x32_bf16 v[40:43], a[76:79], v[88:91], v[40:43]
    ds_read_b128 v[80:83], v18 offset:33024
    v_mfma_f32_16x16x32_bf16 v[48:51], a[140:143], v[88:91], v[48:51]
    v_mfma_f32_16x16x32_bf16 v[56:59], a[204:207], v[88:91], v[56:59]
    s_lshl_b32 s45, s30, 13
    s_add_u32 m0, s45, 3072
    s_nop 0
    buffer_load_dwordx4 v11, s[16:19], s40 offen lds
    v_mfma_f32_16x16x32_bf16 v[36:39], a[12:15], v[92:95], v[36:39]
    v_mfma_f32_16x16x32_bf16 v[44:47], a[76:79], v[92:95], v[44:47]
    ds_read_b128 v[84:87], v18 offset:49408
    v_mfma_f32_16x16x32_bf16 v[52:55], a[140:143], v[92:95], v[52:55]
    v_mfma_f32_16x16x32_bf16 v[60:63], a[204:207], v[92:95], v[60:63]
    s_waitcnt lgkmcnt(4)
    v_mfma_f32_16x16x32_bf16 v[32:35], a[16:19], v[64:67], v[32:35]
    v_mfma_f32_16x16x32_bf16 v[40:43], a[80:83], v[64:67], v[40:43]
    ds_read_b128 v[88:91], v19 offset:33024
    v_mfma_f32_16x16x32_bf16 v[48:51], a[144:147], v[64:67], v[48:51]
    v_mfma_f32_16x16x32_bf16 v[56:59], a[208:211], v[64:67], v[56:59]
    s_lshl_b32 s45, s30, 13
    s_add_u32 m0, s45, 4096
    s_nop 0
    buffer_load_dwordx4 v12, s[16:19], s40 offen lds
    v_mfma_f32_16x16x32_bf16 v[36:39], a[16:19], v[68:71], v[36:39]
    v_mfma_f32_16x16x32_bf16 v[44:47], a[80:83], v[68:71], v[44:47]
    ds_read_b128 v[92:95], v19 offset:49408
    v_mfma_f32_16x16x32_bf16 v[52:55], a[144:147], v[68:71], v[52:55]
    v_mfma_f32_16x16x32_bf16 v[60:63], a[208:211], v[68:71], v[60:63]
    s_waitcnt lgkmcnt(4)
    v_mfma_f32_16x16x32_bf16 v[32:35], a[20:23], v[72:75], v[32:35]
    v_mfma_f32_16x16x32_bf16 v[40:43], a[84:87], v[72:75], v[40:43]
    ds_read_b128 v[64:67], v16 offset:33280
    v_mfma_f32_16x16x32_bf16 v[48:51], a[148:151], v[72:75], v[48:51]
    v_mfma_f32_16x16x32_bf16 v[56:59], a[212:215], v[72:75], v[56:59]
    s_lshl_b32 s45, s30, 13
    s_add_u32 m0, s45, 5120
    s_nop 0
    buffer_load_dwordx4 v13, s[16:19], s40 offen lds
    v_mfma_f32_16x16x32_bf16 v[36:39], a[20:23], v[76:79], v[36:39]
    v_mfma_f32_16x16x32_bf16 v[44:47], a[84:87], v[76:79], v[44:47]
    ds_read_b128 v[68:71], v16 offset:49664
    v_mfma_f32_16x16x32_bf16 v[52:55], a[148:151], v[76:79], v[52:55]
    v_mfma_f32_16x16x32_bf16 v[60:63], a[212:215], v[76:79], v[60:63]
    s_waitcnt lgkmcnt(4)
    v_mfma_f32_16x16x32_bf16 v[32:35], a[24:27], v[80:83], v[32:35]
    v_mfma_f32_16x16x32_bf16 v[40:43], a[88:91], v[80:83], v[40:43]
    ds_read_b128 v[72:75], v17 offset:33280
    v_mfma_f32_16x16x32_bf16 v[48:51], a[152:155], v[80:83], v[48:51]
    v_mfma_f32_16x16x32_bf16 v[56:59], a[216:219], v[80:83], v[56:59]
    s_lshl_b32 s45, s30, 13
    s_add_u32 m0, s45, 6144
    s_nop 0
    buffer_load_dwordx4 v14, s[16:19], s40 offen lds
    v_mfma_f32_16x16x32_bf16 v[36:39], a[24:27], v[84:87], v[36:39]
    v_mfma_f32_16x16x32_bf16 v[44:47], a[88:91], v[84:87], v[44:47]
    ds_read_b128 v[76:79], v17 offset:49664
    v_mfma_f32_16x16x32_bf16 v[52:55], a[152:155], v[84:87], v[52:55]
    v_mfma_f32_16x16x32_bf16 v[60:63], a[216:219], v[84:87], v[60:63]
    s_waitcnt lgkmcnt(4)
    v_mfma_f32_16x16x32_bf16 v[32:35], a[28:31], v[88:91], v[32:35]
    v_mfma_f32_16x16x32_bf16 v[40:43], a[92:95], v[88:91], v[40:43]
    ds_read_b128 v[80:83], v18 offset:33280
    v_mfma_f32_16x16x32_bf16 v[48:51], a[156:159], v[88:91], v[48:51]
    v_mfma_f32_16x16x32_bf16 v[56:59], a[220:223], v[88:91], v[56:59]
    s_lshl_b32 s45, s30, 13
    s_add_u32 m0, s45, 7168
    s_nop 0
    buffer_load_dwordx4 v15, s[16:19], s40 offen lds
    v_mfma_f32_16x16x32_bf16 v[36:39], a[28:31], v[92:95], v[36:39]
    v_mfma_f32_16x16x32_bf16 v[44:47], a[92:95], v[92:95], v[44:47]
    ds_read_b128 v[84:87], v18 offset:49664
    v_mfma_f32_16x16x32_bf16 v[52:55], a[156:159], v[92:95], v[52:55]
    v_mfma_f32_16x16x32_bf16 v[60:63], a[220:223], v[92:95], v[60:63]
    s_waitcnt lgkmcnt(4)
    v_mfma_f32_16x16x32_bf16 v[32:35], a[32:35], v[64:67], v[32:35]
    v_mfma_f32_16x16x32_bf16 v[40:43], a[96:99], v[64:67], v[40:43]
    ds_read_b128 v[88:91], v19 offset:33280
    v_mfma_f32_16x16x32_bf16 v[48:51], a[160:163], v[64:67], v[48:51]
    v_mfma_f32_16x16x32_bf16 v[56:59], a[224:227], v[64:67], v[56:59]
    v_mfma_f32_16x16x32_bf16 v[36:39], a[32:35], v[68:71], v[36:39]
    v_mfma_f32_16x16x32_bf16 v[44:47], a[96:99], v[68:71], v[44:47]
    ds_read_b128 v[92:95], v19 offset:49664
    v_mfma_f32_16x16x32_bf16 v[52:55], a[160:163], v[68:71], v[52:55]
    v_mfma_f32_16x16x32_bf16 v[60:63], a[224:227], v[68:71], v[60:63]
    s_waitcnt lgkmcnt(4)
    v_mfma_f32_16x16x32_bf16 v[32:35], a[36:39], v[72:75], v[32:35]
    v_mfma_f32_16x16x32_bf16 v[40:43], a[100:103], v[72:75], v[40:43]
    ds_read_b128 v[64:67], v16 offset:33536
    v_mfma_f32_16x16x32_bf16 v[48:51], a[164:167], v[72:75], v[48:51]
    v_mfma_f32_16x16x32_bf16 v[56:59], a[228:231], v[72:75], v[56:59]
    v_mfma_f32_16x16x32_bf16 v[36:39], a[36:39], v[76:79], v[36:39]
    v_mfma_f32_16x16x32_bf16 v[44:47], a[100:103], v[76:79], v[44:47]
    ds_read_b128 v[68:71], v16 offset:49920
    v_mfma_f32_16x16x32_bf16 v[52:55], a[164:167], v[76:79], v[52:55]
    v_mfma_f32_16x16x32_bf16 v[60:63], a[228:231], v[76:79], v[60:63]
    s_waitcnt lgkmcnt(4)
    v_mfma_f32_16x16x32_bf16 v[32:35], a[40:43], v[80:83], v[32:35]
    v_mfma_f32_16x16x32_bf16 v[40:43], a[104:107], v[80:83], v[40:43]
    ds_read_b128 v[72:75], v17 offset:33536
    v_mfma_f32_16x16x32_bf16 v[48:51], a[168:171], v[80:83], v[48:51]
    v_mfma_f32_16x16x32_bf16 v[56:59], a[232:235], v[80:83], v[56:59]
    v_mfma_f32_16x16x32_bf16 v[36:39], a[40:43], v[84:87], v[36:39]
    v_mfma_f32_16x16x32_bf16 v[44:47], a[104:107], v[84:87], v[44:47]
    ds_read_b128 v[76:79], v17 offset:49920
    v_mfma_f32_16x16x32_bf16 v[52:55], a[168:171], v[84:87], v[52:55]
    v_mfma_f32_16x16x32_bf16 v[60:63], a[232:235], v[84:87], v[60:63]
    s_waitcnt lgkmcnt(4)
    v_mfma_f32_16x16x32_bf16 v[32:35], a[44:47], v[88:91], v[32:35]
    v_mfma_f32_16x16x32_bf16 v[40:43], a[108:111], v[88:91], v[40:43]
    ds_read_b128 v[80:83], v18 offset:33536
    v_mfma_f32_16x16x32_bf16 v[48:51], a[172:175], v[88:91], v[48:51]
    v_mfma_f32_16x16x32_bf16 v[56:59], a[236:239], v[88:91], v[56:59]
    v_mfma_f32_16x16x32_bf16 v[36:39], a[44:47], v[92:95], v[36:39]
    v_mfma_f32_16x16x32_bf16 v[44:47], a[108:111], v[92:95], v[44:47]
    ds_read_b128 v[84:87], v18 offset:49920
    v_mfma_f32_16x16x32_bf16 v[52:55], a[172:175], v[92:95], v[52:55]
    v_mfma_f32_16x16x32_bf16 v[60:63], a[236:239], v[92:95], v[60:63]
    s_waitcnt lgkmcnt(4)
    v_mfma_f32_16x16x32_bf16 v[32:35], a[48:51], v[64:67], v[32:35]
    v_mfma_f32_16x16x32_bf16 v[40:43], a[112:115], v[64:67], v[40:43]
    ds_read_b128 v[88:91], v19 offset:33536
    v_mfma_f32_16x16x32_bf16 v[48:51], a[176:179], v[64:67], v[48:51]
    v_mfma_f32_16x16x32_bf16 v[56:59], a[240:243], v[64:67], v[56:59]
    v_mfma_f32_16x16x32_bf16 v[36:39], a[48:51], v[68:71], v[36:39]
    v_mfma_f32_16x16x32_bf16 v[44:47], a[112:115], v[68:71], v[44:47]
    ds_read_b128 v[92:95], v19 offset:49920
    v_mfma_f32_16x16x32_bf16 v[52:55], a[176:179], v[68:71], v[52:55]
    v_mfma_f32_16x16x32_bf16 v[60:63], a[240:243], v[68:71], v[60:63]
    s_waitcnt lgkmcnt(4)
    v_mfma_f32_16x16x32_bf16 v[32:35], a[52:55], v[72:75], v[32:35]
    v_mfma_f32_16x16x32_bf16 v[40:43], a[116:119], v[72:75], v[40:43]
    v_mfma_f32_16x16x32_bf16 v[48:51], a[180:183], v[72:75], v[48:51]
    v_mfma_f32_16x16x32_bf16 v[56:59], a[244:247], v[72:75], v[56:59]
    v_mfma_f32_16x16x32_bf16 v[36:39], a[52:55], v[76:79], v[36:39]
    v_mfma_f32_16x16x32_bf16 v[44:47], a[116:119], v[76:79], v[44:47]
    v_mfma_f32_16x16x32_bf16 v[52:55], a[180:183], v[76:79], v[52:55]
    v_mfma_f32_16x16x32_bf16 v[60:63], a[244:247], v[76:79], v[60:63]
    s_waitcnt lgkmcnt(2)
    v_mfma_f32_16x16x32_bf16 v[32:35], a[56:59], v[80:83], v[32:35]
    v_mfma_f32_16x16x32_bf16 v[40:43], a[120:123], v[80:83], v[40:43]
    v_mfma_f32_16x16x32_bf16 v[48:51], a[184:187], v[80:83], v[48:51]
    v_mfma_f32_16x16x32_bf16 v[56:59], a[248:251], v[80:83], v[56:59]
    v_mfma_f32_16x16x32_bf16 v[36:39], a[56:59], v[84:87], v[36:39]
    v_mfma_f32_16x16x32_bf16 v[44:47], a[120:123], v[84:87], v[44:47]
    v_mfma_f32_16x16x32_bf16 v[52:55], a[184:187], v[84:87], v[52:55]
    v_mfma_f32_16x16x32_bf16 v[60:63], a[248:251], v[84:87], v[60:63]
    s_waitcnt lgkmcnt(0)
    v_mfma_f32_16x16x32_bf16 v[32:35], a[60:63], v[88:91], v[32:35]
    v_mfma_f32_16x16x32_bf16 v[40:43], a[124:127], v[88:91], v[40:43]
    v_mfma_f32_16x16x32_bf16 v[48:51], a[188:191], v[88:91], v[48:51]
    v_mfma_f32_16x16x32_bf16 v[56:59], a[252:255], v[88:91], v[56:59]
    v_mfma_f32_16x16x32_bf16 v[36:39], a[60:63], v[92:95], v[36:39]
    v_mfma_f32_16x16x32_bf16 v[44:47], a[124:127], v[92:95], v[44:47]
    v_mfma_f32_16x16x32_bf16 v[52:55], a[188:191], v[92:95], v[52:55]
    v_mfma_f32_16x16x32_bf16 v[60:63], a[252:255], v[92:95], v[60:63]
    s_cmp_eq_u32 s38, 1
    s_nop 5
    s_cbranch_scc1 QL_k1_ns
    v_mul_f32 v32, s42, v32
    v_mul_f32 v33, s42, v33
    v_mul_f32 v34, s42, v34
    v_mul_f32 v35, s42, v35
    v_mul_f32 v36, s42, v36
    v_mul_f32 v37, s42, v37
    v_mul_f32 v38, s42, v38
    v_mul_f32 v39, s42, v39
    v_mul_f32 v40, s42, v40
    v_mul_f32 v41, s42, v41
    v_mul_f32 v42, s42, v42
    v_mul_f32 v43, s42, v43
    v_mul_f32 v44, s42, v44
    v_mul_f32 v45, s42, v45
    v_mul_f32 v46, s42, v46
    v_mul_f32 v47, s42, v47
    v_mul_f32 v48, s42, v48
    v_mul_f32 v49, s42, v49
    v_mul_f32 v50, s42, v50
    v_mul_f32 v51, s42, v51
    v_mul_f32 v52, s42, v52
    v_mul_f32 v53, s42, v53
    v_mul_f32 v54, s42, v54
    v_mul_f32 v55, s42, v55
    v_mul_f32 v56, s42, v56
    v_mul_f32 v57, s42, v57
    v_mul_f32 v58, s42, v58
    v_mul_f32 v59, s42, v59
    v_mul_f32 v60, s42, v60
    v_mul_f32 v61, s42, v61
    v_mul_f32 v62, s42, v62
    v_mul_f32 v63, s42, v63
    s_nop 1
QL_k1_ns:
    v_cvt_pk_bf16_f32 v96, v32, v33
    v_cvt_pk_bf16_f32 v97, v34, v35
    v_cvt_pk_bf16_f32 v98, v40, v41
    v_cvt_pk_bf16_f32 v99, v42, v43
    buffer_store_dwordx4 v[96:99], v4, s[4:7], s39 offen offset:0 sc0 sc1
    v_cvt_pk_bf16_f32 v100, v48, v49
    v_cvt_pk_bf16_f32 v101, v50, v51
    v_cvt_pk_bf16_f32 v102, v56, v57
    v_cvt_pk_bf16_f32 v103, v58, v59
    buffer_store_dwordx4 v[100:103], v4, s[4:7], s39 offen offset:1024 sc0 sc1
    v_cvt_pk_bf16_f32 v104, v36, v37
    v_cvt_pk_bf16_f32 v105, v38, v39
    v_cvt_pk_bf16_f32 v106, v44, v45
    v_cvt_pk_bf16_f32 v107, v46, v47
    s_add_u32 s46, s39, 4096
    buffer_store_dwordx4 v[104:107], v4, s[4:7], s46 offen offset:0 sc0 sc1
    v_cvt_pk_bf16_f32 v108, v52, v53
    v_cvt_pk_bf16_f32 v109, v54, v55
    v_cvt_pk_bf16_f32 v110, v60, v61
    v_cvt_pk_bf16_f32 v111, v62, v63
    s_add_u32 s46, s39, 4096
    buffer_store_dwordx4 v[108:111], v4, s[4:7], s46 offen offset:1024 sc0 sc1
    s_add_u32 s39, s39, s37
    s_add_u32 s41, s41, 1
    s_cmp_lt_u32 s41, 16
    s_cbranch_scc1 QL_k0
    s_branch QL_fin
QL_vtype:
    s_lshl_b32 s45, s45, 12
    s_add_u32 s39, s39, s45
QL_v0:
    s_sub_u32 s43, s41, 1
    s_cmp_gt_u32 s41, 1
    s_cbranch_scc1 QL_v0_w
    s_mov_b32 s43, s41
    s_waitcnt vmcnt(0)
QL_v0_w:
    s_waitcnt vmcnt(4)
    s_barrier
    v_mov_b32 v255, s43
    buffer_store_dword v255, off, s[4:7], s63 sc0 sc1
    s_add_u32 s40, s40, 131072
    ds_read_b128 v[64:67], v16 offset:0
    ds_read_b128 v[68:71], v16 offset:16384
    ds_read_b128 v[72:75], v17 offset:0
    ds_read_b128 v[76:79], v17 offset:16384
    ds_read_b128 v[80:83], v18 offset:0
    ds_read_b128 v[84:87], v18 offset:16384
    s_waitcnt lgkmcnt(4)
    v_mfma_f32_16x16x32_bf16 v[32:35], v[64:67], a[0:3], 0
    v_mfma_f32_16x16x32_bf16 v[40:43], v[64:67], a[64:67], 0
    ds_read_b128 v[88:91], v19 offset:0
    v_mfma_f32_16x16x32_bf16 v[48:51], v[64:67], a[128:131], 0
    v_mfma_f32_16x16x32_bf16 v[56:59], v[64:67], a[192:195], 0
    s_lshl_b32 s45, s30, 13
    s_add_u32 m0, s45, 32768
    s_nop 0
    buffer_load_dwordx4 v8, s[16:19], s40 offen lds
    v_mfma_f32_16x16x32_bf16 v[36:39], v[68:71], a[0:3], 0
    v_mfma_f32_16x16x32_bf16 v[44:47], v[68:71], a[64:67], 0
    ds_read_b128 v[92:95], v19 offset:16384
    v_mfma_f32_16x16x32_bf16 v[52:55], v[68:71], a[128:131], 0
    v_mfma_f32_16x16x32_bf16 v[60:63], v[68:71], a[192:195], 0
    s_waitcnt lgkmcnt(4)
    v_mfma_f32_16x16x32_bf16 v[32:35], v[72:75], a[4:7], v[32:35]
    v_mfma_f32_16x16x32_bf16 v[40:43], v[72:75], a[68:71], v[40:43]
    ds_read_b128 v[64:67], v16 offset:256
    v_mfma_f32_16x16x32_bf16 v[48:51], v[72:75], a[132:135], v[48:51]
    v_mfma_f32_16x16x32_bf16 v[56:59], v[72:75], a[196:199], v[56:59]
    s_lshl_b32 s45, s30, 13
    s_add_u32 m0, s45, 33792
    s_nop 0
    buffer_load_dwordx4 v9, s[16:19], s40 offen lds
    v_mfma_f32_16x16x32_bf16 v[36:39], v[76:79], a[4:7], v[36:39]
    v_mfma_f32_16x16x32_bf16 v[44:47], v[76:79], a[68:71], v[44:47]
    ds_read_b128 v[68:71], v16 offset:16640
    v_mfma_f32_16x16x32_bf16 v[52:55], v[76:79], a[132:135], v[52:55]
    v_mfma_f32_16x16x32_bf16 v[60:63], v[76:79], a[196:199], v[60:63]
    s_waitcnt lgkmcnt(4)
    v_mfma_f32_16x16x32_bf16 v[32:35], v[80:83], a[8:11], v[32:35]
    v_mfma_f32_16x16x32_bf16 v[40:43], v[80:83], a[72:75], v[40:43]
    ds_read_b128 v[72:75], v17 offset:256
    v_mfma_f32_16x16x32_bf16 v[48:51], v[80:83], a[136:139], v[48:51]
    v_mfma_f32_16x16x32_bf16 v[56:59], v[80:83], a[200:203], v[56:59]
    s_lshl_b32 s45, s30, 13
    s_add_u32 m0, s45, 34816
    s_nop 0
    buffer_load_dwordx4 v10, s[16:19], s40 offen lds
    v_mfma_f32_16x16x32_bf16 v[36:39], v[84:87], a[8:11], v[36:39]
    v_mfma_f32_16x16x32_bf16 v[44:47], v[84:87], a[72:75], v[44:47]
    ds_read_b128 v[76:79], v17 offset:16640
    v_mfma_f32_16x16x32_bf16 v[52:55], v[84:87], a[136:139], v[52:55]
    v_mfma_f32_16x16x32_bf16 v[60:63], v[84:87], a[200:203], v[60:63]
    s_waitcnt lgkmcnt(4)
    v_mfma_f32_16x16x32_bf16 v[32:35], v[88:91], a[12:15], v[32:35]
    v_mfma_f32_16x16x32_bf16 v[40:43], v[88:91], a[76:79], v[40:43]
    ds_read_b128 v[80:83], v18 offset:256
    v_mfma_f32_16x16x32_bf16 v[48:51], v[88:91], a[140:143], v[48:51]
    v_mfma_f32_16x16x32_bf16 v[56:59], v[88:91], a[204:207], v[56:59]
    s_lshl_b32 s45, s30, 13
    s_add_u32 m0, s45, 35840
    s_nop 0
    buffer_load_dwordx4 v11, s[16:19], s40 offen lds
    v_mfma_f32_16x16x32_bf16 v[36:39], v[92:95], a[12:15], v[36:39]
    v_mfma_f32_16x16x32_bf16 v[44:47], v[92:95], a[76:79], v[44:47]
    ds_read_b128 v[84:87], v18 offset:16640
    v_mfma_f32_16x16x32_bf16 v[52:55], v[92:95], a[140:143], v[52:55]
    v_mfma_f32_16x16x32_bf16 v[60:63], v[92:95], a[204:207], v[60:63]
    s_waitcnt lgkmcnt(4)
    v_mfma_f32_16x16x32_bf16 v[32:35], v[64:67], a[16:19], v[32:35]
    v_mfma_f32_16x16x32_bf16 v[40:43], v[64:67], a[80:83], v[40:43]
    ds_read_b128 v[88:91], v19 offset:256
    v_mfma_f32_16x16x32_bf16 v[48:51], v[64:67], a[144:147], v[48:51]
    v_mfma_f32_16x16x32_bf16 v[56:59], v[64:67], a[208:211], v[56:59]
    s_lshl_b32 s45, s30, 13
    s_add_u32 m0, s45, 36864
    s_nop 0
    buffer_load_dwordx4 v12, s[16:19], s40 offen lds
    v_mfma_f32_16x16x32_bf16 v[36:39], v[68:71], a[16:19], v[36:39]
    v_mfma_f32_16x16x32_bf16 v[44:47], v[68:71], a[80:83], v[44:47]
    ds_read_b128 v[92:95], v19 offset:16640
    v_mfma_f32_16x16x32_bf16 v[52:55], v[68:71], a[144:147], v[52:55]
    v_mfma_f32_16x16x32_bf16 v[60:63], v[68:71], a[208:211], v[60:63]
    s_waitcnt lgkmcnt(4)
    v_mfma_f32_16x16x32_bf16 v[32:35], v[72:75], a[20:23], v[32:35]
    v_mfma_f32_16x16x32_bf16 v[40:43], v[72:75], a[84:87], v[40:43]
    ds_read_b128 v[64:67], v16 offset:512
    v_mfma_f32_16x16x32_bf16 v[48:51], v[72:75], a[148:151], v[48:51]
    v_mfma_f32_16x16x32_bf16 v[56:59], v[72:75], a[212:215], v[56:59]
    s_lshl_b32 s45, s30, 13
    s_add_u32 m0, s45, 37888
    s_nop 0
    buffer_load_dwordx4 v13, s[16:19], s40 offen lds
    v_mfma_f32_16x16x32_bf16 v[36:39], v[76:79], a[20:23], v[36:39]
    v_mfma_f32_16x16x32_bf16 v[44:47], v[76:79], a[84:87], v[44:47]
    ds_read_b128 v[68:71], v16 offset:16896
    v_mfma_f32_16x16x32_bf16 v[52:55], v[76:79], a[148:151], v[52:55]
    v_mfma_f32_16x16x32_bf16 v[60:63], v[76:79], a[212:215], v[60:63]
    s_waitcnt lgkmcnt(4)
    v_mfma_f32_16x16x32_bf16 v[32:35], v[80:83], a[24:27], v[32:35]
    v_mfma_f32_16x16x32_bf16 v[40:43], v[80:83], a[88:91], v[40:43]
    ds_read_b128 v[72:75], v17 offset:512
    v_mfma_f32_16x16x32_bf16 v[48:51], v[80:83], a[152:155], v[48:51]
    v_mfma_f32_16x16x32_bf16 v[56:59], v[80:83], a[216:219], v[56:59]
    s_lshl_b32 s45, s30, 13
    s_add_u32 m0, s45, 38912
    s_nop 0
    buffer_load_dwordx4 v14, s[16:19], s40 offen lds
    v_mfma_f32_16x16x32_bf16 v[36:39], v[84:87], a[24:27], v[36:39]
    v_mfma_f32_16x16x32_bf16 v[44:47], v[84:87], a[88:91], v[44:47]
    ds_read_b128 v[76:79], v17 offset:16896
    v_mfma_f32_16x16x32_bf16 v[52:55], v[84:87], a[152:155], v[52:55]
    v_mfma_f32_16x16x32_bf16 v[60:63], v[84:87], a[216:219], v[60:63]
    s_waitcnt lgkmcnt(4)
    v_mfma_f32_16x16x32_bf16 v[32:35], v[88:91], a[28:31], v[32:35]
    v_mfma_f32_16x16x32_bf16 v[40:43], v[88:91], a[92:95], v[40:43]
    ds_read_b128 v[80:83], v18 offset:512
    v_mfma_f32_16x16x32_bf16 v[48:51], v[88:91], a[156:159], v[48:51]
    v_mfma_f32_16x16x32_bf16 v[56:59], v[88:91], a[220:223], v[56:59]
    s_lshl_b32 s45, s30, 13
    s_add_u32 m0, s45, 39936
    s_nop 0
    buffer_load_dwordx4 v15, s[16:19], s40 offen lds
    v_mfma_f32_16x16x32_bf16 v[36:39], v[92:95], a[28:31], v[36:39]
    v_mfma_f32_16x16x32_bf16 v[44:47], v[92:95], a[92:95], v[44:47]
    ds_read_b128 v[84:87], v18 offset:16896
    v_mfma_f32_16x16x32_bf16 v[52:55], v[92:95], a[156:159], v[52:55]
    v_mfma_f32_16x16x32_bf16 v[60:63], v[92:95], a[220:223], v[60:63]
    s_waitcnt lgkmcnt(4)
    v_mfma_f32_16x16x32_bf16 v[32:35], v[64:67], a[32:35], v[32:35]
    v_mfma_f32_16x16x32_bf16 v[40:43], v[64:67], a[96:99], v[40:43]
    ds_read_b128 v[88:91], v19 offset:512
    v_mfma_f32_16x16x32_bf16 v[48:51], v[64:67], a[160:163], v[48:51]
    v_mfma_f32_16x16x32_bf16 v[56:59], v[64:67], a[224:227], v[56:59]
    v_mfma_f32_16x16x32_bf16 v[36:39], v[68:71], a[32:35], v[36:39]
    v_mfma_f32_16x16x32_bf16 v[44:47], v[68:71], a[96:99], v[44:47]
    ds_read_b128 v[92:95], v19 offset:16896
    v_mfma_f32_16x16x32_bf16 v[52:55], v[68:71], a[160:163], v[52:55]
    v_mfma_f32_16x16x32_bf16 v[60:63], v[68:71], a[224:227], v[60:63]
    s_waitcnt lgkmcnt(4)
    v_mfma_f32_16x16x32_bf16 v[32:35], v[72:75], a[36:39], v[32:35]
    v_mfma_f32_16x16x32_bf16 v[40:43], v[72:75], a[100:103], v[40:43]
    ds_read_b128 v[64:67], v16 offset:768
    v_mfma_f32_16x16x32_bf16 v[48:51], v[72:75], a[164:167], v[48:51]
    v_mfma_f32_16x16x32_bf16 v[56:59], v[72:75], a[228:231], v[56:59]
    v_mfma_f32_16x16x32_bf16 v[36:39], v[76:79], a[36:39], v[36:39]
    v_mfma_f32_16x16x32_bf16 v[44:47], v[76:79], a[100:103], v[44:47]
    ds_read_b128 v[68:71], v16 offset:17152
    v_mfma_f32_16x16x32_bf16 v[52:55], v[76:79], a[164:167], v[52:55]
    v_mfma_f32_16x16x32_bf16 v[60:63], v[76:79], a[228:231], v[60:63]
    s_waitcnt lgkmcnt(4)
    v_mfma_f32_16x16x32_bf16 v[32:35], v[80:83], a[40:43], v[32:35]
    v_mfma_f32_16x16x32_bf16 v[40:43], v[80:83], a[104:107], v[40:43]
    ds_read_b128 v[72:75], v17 offset:768
    v_mfma_f32_16x16x32_bf16 v[48:51], v[80:83], a[168:171], v[48:51]
    v_mfma_f32_16x16x32_bf16 v[56:59], v[80:83], a[232:235], v[56:59]
    v_mfma_f32_16x16x32_bf16 v[36:39], v[84:87], a[40:43], v[36:39]
    v_mfma_f32_16x16x32_bf16 v[44:47], v[84:87], a[104:107], v[44:47]
    ds_read_b128 v[76:79], v17 offset:17152
    v_mfma_f32_16x16x32_bf16 v[52:55], v[84:87], a[168:171], v[52:55]
    v_mfma_f32_16x16x32_bf16 v[60:63], v[84:87], a[232:235], v[60:63]
    s_waitcnt lgkmcnt(4)
    v_mfma_f32_16x16x32_bf16 v[32:35], v[88:91], a[44:47], v[32:35]
    v_mfma_f32_16x16x32_bf16 v[40:43], v[88:91], a[108:111], v[40:43]
    ds_read_b128 v[80:83], v18 offset:768
    v_mfma_f32_16x16x32_bf16 v[48:51], v[88:91], a[172:175], v[48:51]
    v_mfma_f32_16x16x32_bf16 v[56:59], v[88:91], a[236:239], v[56:59]
    v_mfma_f32_16x16x32_bf16 v[36:39], v[92:95], a[44:47], v[36:39]
    v_mfma_f32_16x16x32_bf16 v[44:47], v[92:95], a[108:111], v[44:47]
    ds_read_b128 v[84:87], v18 offset:17152
    v_mfma_f32_16x16x32_bf16 v[52:55], v[92:95], a[172:175], v[52:55]
    v_mfma_f32_16x16x32_bf16 v[60:63], v[92:95], a[236:239], v[60:63]
    s_waitcnt lgkmcnt(4)
    v_mfma_f32_16x16x32_bf16 v[32:35], v[64:67], a[48:51], v[32:35]
    v_mfma_f32_16x16x32_bf16 v[40:43], v[64:67], a[112:115], v[40:43]
    ds_read_b128 v[88:91], v19 offset:768
    v_mfma_f32_16x16x32_bf16 v[48:51], v[64:67], a[176:179], v[48:51]
    v_mfma_f32_16x16x32_bf16 v[56:59], v[64:67], a[240:243], v[56:59]
    v_mfma_f32_16x16x32_bf16 v[36:39], v[68:71], a[48:51], v[36:39]
    v_mfma_f32_16x16x32_bf16 v[44:47], v[68:71], a[112:115], v[44:47]
    ds_read_b128 v[92:95], v19 offset:17152
    v_mfma_f32_16x16x32_bf16 v[52:55], v[68:71], a[176:179], v[52:55]
    v_mfma_f32_16x16x32_bf16 v[60:63], v[68:71], a[240:243], v[60:63]
    s_waitcnt lgkmcnt(4)
    v_mfma_f32_16x16x32_bf16 v[32:35], v[72:75], a[52:55], v[32:35]
    v_mfma_f32_16x16x32_bf16 v[40:43], v[72:75], a[116:119], v[40:43]
    v_mfma_f32_16x16x32_bf16 v[48:51], v[72:75], a[180:183], v[48:51]
    v_mfma_f32_16x16x32_bf16 v[56:59], v[72:75], a[244:247], v[56:59]
    v_mfma_f32_16x16x32_bf16 v[36:39], v[76:79], a[52:55], v[36:39]
    v_mfma_f32_16x16x32_bf16 v[44:47], v[76:79], a[116:119], v[44:47]
    v_mfma_f32_16x16x32_bf16 v[52:55], v[76:79], a[180:183], v[52:55]
    v_mfma_f32_16x16x32_bf16 v[60:63], v[76:79], a[244:247], v[60:63]
    s_waitcnt lgkmcnt(2)
    v_mfma_f32_16x16x32_bf16 v[32:35], v[80:83], a[56:59], v[32:35]
    v_mfma_f32_16x16x32_bf16 v[40:43], v[80:83], a[120:123], v[40:43]
    v_mfma_f32_16x16x32_bf16 v[48:51], v[80:83], a[184:187], v[48:51]
    v_mfma_f32_16x16x32_bf16 v[56:59], v[80:83], a[248:251], v[56:59]
    v_mfma_f32_16x16x32_bf16 v[36:39], v[84:87], a[56:59], v[36:39]
    v_mfma_f32_16x16x32_bf16 v[44:47], v[84:87], a[120:123], v[44:47]
    v_mfma_f32_16x16x32_bf16 v[52:55], v[84:87], a[184:187], v[52:55]
    v_mfma_f32_16x16x32_bf16 v[60:63], v[84:87], a[248:251], v[60:63]
    s_waitcnt lgkmcnt(0)
    v_mfma_f32_16x16x32_bf16 v[32:35], v[88:91], a[60:63], v[32:35]
    v_mfma_f32_16x16x32_bf16 v[40:43], v[88:91], a[124:127], v[40:43]
    v_mfma_f32_16x16x32_bf16 v[48:51], v[88:91], a[188:191], v[48:51]
    v_mfma_f32_16x16x32_bf16 v[56:59], v[88:91], a[252:255], v[56:59]
    v_mfma_f32_16x16x32_bf16 v[36:39], v[92:95], a[60:63], v[36:39]
    v_mfma_f32_16x16x32_bf16 v[44:47], v[92:95], a[124:127], v[44:47]
    v_mfma_f32_16x16x32_bf16 v[52:55], v[92:95], a[188:191], v[52:55]
    v_mfma_f32_16x16x32_bf16 v[60:63], v[92:95], a[252:255], v[60:63]
    v_cvt_pk_bf16_f32 v96, v32, v33
    v_cvt_pk_bf16_f32 v97, v34, v35
    v_cvt_pk_bf16_f32 v98, v36, v37
    v_cvt_pk_bf16_f32 v99, v38, v39
    buffer_store_dwordx4 v[96:99], v4, s[4:7], s39 offen offset:0 sc0 sc1
    v_cvt_pk_bf16_f32 v100, v40, v41
    v_cvt_pk_bf16_f32 v101, v42, v43
    v_cvt_pk_bf16_f32 v102, v44, v45
    v_cvt_pk_bf16_f32 v103, v46, v47
    buffer_store_dwordx4 v[100:103], v4, s[4:7], s39 offen offset:1024 sc0 sc1
    v_cvt_pk_bf16_f32 v104, v48, v49
    v_cvt_pk_bf16_f32 v105, v50, v51
    v_cvt_pk_bf16_f32 v106, v52, v53
    v_cvt_pk_bf16_f32 v107, v54, v55
    buffer_store_dwordx4 v[104:107], v4, s[4:7], s39 offen offset:2048 sc0 sc1
    v_cvt_pk_bf16_f32 v108, v56, v57
    v_cvt_pk_bf16_f32 v109, v58, v59
    v_cvt_pk_bf16_f32 v110, v60, v61
    v_cvt_pk_bf16_f32 v111, v62, v63
    buffer_store_dwordx4 v[108:111], v4, s[4:7], s39 offen offset:3072 sc0 sc1
    s_add_u32 s39, s39, s37
    s_add_u32 s41, s41, 1
QL_v1:
    s_sub_u32 s43, s41, 1
    s_cmp_gt_u32 s41, 1
    s_cbranch_scc1 QL_v1_w
    s_mov_b32 s43, s41
    s_waitcnt vmcnt(0)
QL_v1_w:
    s_waitcnt vmcnt(4)
    s_barrier
    v_mov_b32 v255, s43
    buffer_store_dword v255, off, s[4:7], s63 sc0 sc1
    s_add_u32 s40, s40, 131072
    ds_read_b128 v[64:67], v16 offset:32768
    ds_read_b128 v[68:71], v16 offset:49152
    ds_read_b128 v[72:75], v17 offset:32768
    ds_read_b128 v[76:79], v17 offset:49152
    ds_read_b128 v[80:83], v18 offset:32768
    ds_read_b128 v[84:87], v18 offset:49152
    s_waitcnt lgkmcnt(4)
    v_mfma_f32_16x16x32_bf16 v[32:35], v[64:67], a[0:3], 0
    v_mfma_f32_16x16x32_bf16 v[40:43], v[64:67], a[64:67], 0
    ds_read_b128 v[88:91], v19 offset:32768
    v_mfma_f32_16x16x32_bf16 v[48:51], v[64:67], a[128:131], 0
    v_mfma_f32_16x16x32_bf16 v[56:59], v[64:67], a[192:195], 0
    s_lshl_b32 s45, s30, 13
    s_add_u32 m0, s45, 0
    s_nop 0
    buffer_load_dwordx4 v8, s[16:19], s40 offen lds
    v_mfma_f32_16x16x32_bf16 v[36:39], v[68:71], a[0:3], 0
    v_mfma_f32_16x16x32_bf16 v[44:47], v[68:71], a[64:67], 0
    ds_read_b128 v[92:95], v19 offset:49152
    v_mfma_f32_16x16x32_bf16 v[52:55], v[68:71], a[128:131], 0
    v_mfma_f32_16x16x32_bf16 v[60:63], v[68:71], a[192:195], 0
    s_waitcnt lgkmcnt(4)
    v_mfma_f32_16x16x32_bf16 v[32:35], v[72:75], a[4:7], v[32:35]
    v_mfma_f32_16x16x32_bf16 v[40:43], v[72:75], a[68:71], v[40:43]
    ds_read_b128 v[64:67], v16 offset:33024
    v_mfma_f32_16x16x32_bf16 v[48:51], v[72:75], a[132:135], v[48:51]
    v_mfma_f32_16x16x32_bf16 v[56:59], v[72:75], a[196:199], v[56:59]
    s_lshl_b32 s45, s30, 13
    s_add_u32 m0, s45, 1024
    s_nop 0
    buffer_load_dwordx4 v9, s[16:19], s40 offen lds
    v_mfma_f32_16x16x32_bf16 v[36:39], v[76:79], a[4:7], v[36:39]
    v_mfma_f32_16x16x32_bf16 v[44:47], v[76:79], a[68:71], v[44:47]
    ds_read_b128 v[68:71], v16 offset:49408
    v_mfma_f32_16x16x32_bf16 v[52:55], v[76:79], a[132:135], v[52:55]
    v_mfma_f32_16x16x32_bf16 v[60:63], v[76:79], a[196:199], v[60:63]
    s_waitcnt lgkmcnt(4)
    v_mfma_f32_16x16x32_bf16 v[32:35], v[80:83], a[8:11], v[32:35]
    v_mfma_f32_16x16x32_bf16 v[40:43], v[80:83], a[72:75], v[40:43]
    ds_read_b128 v[72:75], v17 offset:33024
    v_mfma_f32_16x16x32_bf16 v[48:51], v[80:83], a[136:139], v[48:51]
    v_mfma_f32_16x16x32_bf16 v[56:59], v[80:83], a[200:203], v[56:59]
    s_lshl_b32 s45, s30, 13
    s_add_u32 m0, s45, 2048
    s_nop 0
    buffer_load_dwordx4 v10, s[16:19], s40 offen lds
    v_mfma_f32_16x16x32_bf16 v[36:39], v[84:87], a[8:11], v[36:39]
    v_mfma_f32_16x16x32_bf16 v[44:47], v[84:87], a[72:75], v[44:47]
    ds_read_b128 v[76:79], v17 offset:49408
    v_mfma_f32_16x16x32_bf16 v[52:55], v[84:87], a[136:139], v[52:55]
    v_mfma_f32_16x16x32_bf16 v[60:63], v[84:87], a[200:203], v[60:63]
    s_waitcnt lgkmcnt(4)
    v_mfma_f32_16x16x32_bf16 v[32:35], v[88:91], a[12:15], v[32:35]
    v_mfma_f32_16x16x32_bf16 v[40:43], v[88:91], a[76:79], v[40:43]
    ds_read_b128 v[80:83], v18 offset:33024
    v_mfma_f32_16x16x32_bf16 v[48:51], v[88:91], a[140:143], v[48:51]
    v_mfma_f32_16x16x32_bf16 v[56:59], v[88:91], a[204:207], v[56:59]
    s_lshl_b32 s45, s30, 13
    s_add_u32 m0, s45, 3072
    s_nop 0
    buffer_load_dwordx4 v11, s[16:19], s40 offen lds
    v_mfma_f32_16x16x32_bf16 v[36:39], v[92:95], a[12:15], v[36:39]
    v_mfma_f32_16x16x32_bf16 v[44:47], v[92:95], a[76:79], v[44:47]
    ds_read_b128 v[84:87], v18 offset:49408
    v_mfma_f32_16x16x32_bf16 v[52:55], v[92:95], a[140:143], v[52:55]
    v_mfma_f32_16x16x32_bf16 v[60:63], v[92:95], a[204:207], v[60:63]
    s_waitcnt lgkmcnt(4)
    v_mfma_f32_16x16x32_bf16 v[32:35], v[64:67], a[16:19], v[32:35]
    v_mfma_f32_16x16x32_bf16 v[40:43], v[64:67], a[80:83], v[40:43]
    ds_read_b128 v[88:91], v19 offset:33024
    v_mfma_f32_16x16x32_bf16 v[48:51], v[64:67], a[144:147], v[48:51]
    v_mfma_f32_16x16x32_bf16 v[56:59], v[64:67], a[208:211], v[56:59]
    s_lshl_b32 s45, s30, 13
    s_add_u32 m0, s45, 4096
    s_nop 0
    buffer_load_dwordx4 v12, s[16:19], s40 offen lds
    v_mfma_f32_16x16x32_bf16 v[36:39], v[68:71], a[16:19], v[36:39]
    v_mfma_f32_16x16x32_bf16 v[44:47], v[68:71], a[80:83], v[44:47]
    ds_read_b128 v[92:95], v19 offset:49408
    v_mfma_f32_16x16x32_bf16 v[52:55], v[68:71], a[144:147], v[52:55]
    v_mfma_f32_16x16x32_bf16 v[60:63], v[68:71], a[208:211], v[60:63]
    s_waitcnt lgkmcnt(4)
    v_mfma_f32_16x16x32_bf16 v[32:35], v[72:75], a[20:23], v[32:35]
    v_mfma_f32_16x16x32_bf16 v[40:43], v[72:75], a[84:87], v[40:43]
    ds_read_b128 v[64:67], v16 offset:33280
    v_mfma_f32_16x16x32_bf16 v[48:51], v[72:75], a[148:151], v[48:51]
    v_mfma_f32_16x16x32_bf16 v[56:59], v[72:75], a[212:215], v[56:59]
    s_lshl_b32 s45, s30, 13
    s_add_u32 m0, s45, 5120
    s_nop 0
    buffer_load_dwordx4 v13, s[16:19], s40 offen lds
    v_mfma_f32_16x16x32_bf16 v[36:39], v[76:79], a[20:23], v[36:39]
    v_mfma_f32_16x16x32_bf16 v[44:47], v[76:79], a[84:87], v[44:47]
    ds_read_b128 v[68:71], v16 offset:49664
    v_mfma_f32_16x16x32_bf16 v[52:55], v[76:79], a[148:151], v[52:55]
    v_mfma_f32_16x16x32_bf16 v[60:63], v[76:79], a[212:215], v[60:63]
    s_waitcnt lgkmcnt(4)
    v_mfma_f32_16x16x32_bf16 v[32:35], v[80:83], a[24:27], v[32:35]
    v_mfma_f32_16x16x32_bf16 v[40:43], v[80:83], a[88:91], v[40:43]
    ds_read_b128 v[72:75], v17 offset:33280
    v_mfma_f32_16x16x32_bf16 v[48:51], v[80:83], a[152:155], v[48:51]
    v_mfma_f32_16x16x32_bf16 v[56:59], v[80:83], a[216:219], v[56:59]
    s_lshl_b32 s45, s30, 13
    s_add_u32 m0, s45, 6144
    s_nop 0
    buffer_load_dwordx4 v14, s[16:19], s40 offen lds
    v_mfma_f32_16x16x32_bf16 v[36:39], v[84:87], a[24:27], v[36:39]
    v_mfma_f32_16x16x32_bf16 v[44:47], v[84:87], a[88:91], v[44:47]
    ds_read_b128 v[76:79], v17 offset:49664
    v_mfma_f32_16x16x32_bf16 v[52:55], v[84:87], a[152:155], v[52:55]
    v_mfma_f32_16x16x32_bf16 v[60:63], v[84:87], a[216:219], v[60:63]
    s_waitcnt lgkmcnt(4)
    v_mfma_f32_16x16x32_bf16 v[32:35], v[88:91], a[28:31], v[32:35]
    v_mfma_f32_16x16x32_bf16 v[40:43], v[88:91], a[92:95], v[40:43]
    ds_read_b128 v[80:83], v18 offset:33280
    v_mfma_f32_16x16x32_bf16 v[48:51], v[88:91], a[156:159], v[48:51]
    v_mfma_f32_16x16x32_bf16 v[56:59], v[88:91], a[220:223], v[56:59]
    s_lshl_b32 s45, s30, 13
    s_add_u32 m0, s45, 7168
    s_nop 0
    buffer_load_dwordx4 v15, s[16:19], s40 offen lds
    v_mfma_f32_16x16x32_bf16 v[36:39], v[92:95], a[28:31], v[36:39]
    v_mfma_f32_16x16x32_bf16 v[44:47], v[92:95], a[92:95], v[44:47]
    ds_read_b128 v[84:87], v18 offset:49664
    v_mfma_f32_16x16x32_bf16 v[52:55], v[92:95], a[156:159], v[52:55]
    v_mfma_f32_16x16x32_bf16 v[60:63], v[92:95], a[220:223], v[60:63]
    s_waitcnt lgkmcnt(4)
    v_mfma_f32_16x16x32_bf16 v[32:35], v[64:67], a[32:35], v[32:35]
    v_mfma_f32_16x16x32_bf16 v[40:43], v[64:67], a[96:99], v[40:43]
    ds_read_b128 v[88:91], v19 offset:33280
    v_mfma_f32_16x16x32_bf16 v[48:51], v[64:67], a[160:163], v[48:51]
    v_mfma_f32_16x16x32_bf16 v[56:59], v[64:67], a[224:227], v[56:59]
    v_mfma_f32_16x16x32_bf16 v[36:39], v[68:71], a[32:35], v[36:39]
    v_mfma_f32_16x16x32_bf16 v[44:47], v[68:71], a[96:99], v[44:47]
    ds_read_b128 v[92:95], v19 offset:49664
    v_mfma_f32_16x16x32_bf16 v[52:55], v[68:71], a[160:163], v[52:55]
    v_mfma_f32_16x16x32_bf16 v[60:63], v[68:71], a[224:227], v[60:63]
    s_waitcnt lgkmcnt(4)
    v_mfma_f32_16x16x32_bf16 v[32:35], v[72:75], a[36:39], v[32:35]
    v_mfma_f32_16x16x32_bf16 v[40:43], v[72:75], a[100:103], v[40:43]
    ds_read_b128 v[64:67], v16 offset:33536
    v_mfma_f32_16x16x32_bf16 v[48:51], v[72:75], a[164:167], v[48:51]
    v_mfma_f32_16x16x32_bf16 v[56:59], v[72:75], a[228:231], v[56:59]
    v_mfma_f32_16x16x32_bf16 v[36:39], v[76:79], a[36:39], v[36:39]
    v_mfma_f32_16x16x32_bf16 v[44:47], v[76:79], a[100:103], v[44:47]
    ds_read_b128 v[68:71], v16 offset:49920
    v_mfma_f32_16x16x32_bf16 v[52:55], v[76:79], a[164:167], v[52:55]
    v_mfma_f32_16x16x32_bf16 v[60:63], v[76:79], a[228:231], v[60:63]
    s_waitcnt lgkmcnt(4)
    v_mfma_f32_16x16x32_bf16 v[32:35], v[80:83], a[40:43], v[32:35]
    v_mfma_f32_16x16x32_bf16 v[40:43], v[80:83], a[104:107], v[40:43]
    ds_read_b128 v[72:75], v17 offset:33536
    v_mfma_f32_16x16x32_bf16 v[48:51], v[80:83], a[168:171], v[48:51]
    v_mfma_f32_16x16x32_bf16 v[56:59], v[80:83], a[232:235], v[56:59]
    v_mfma_f32_16x16x32_bf16 v[36:39], v[84:87], a[40:43], v[36:39]
    v_mfma_f32_16x16x32_bf16 v[44:47], v[84:87], a[104:107], v[44:47]
    ds_read_b128 v[76:79], v17 offset:49920
    v_mfma_f32_16x16x32_bf16 v[52:55], v[84:87], a[168:171], v[52:55]
    v_mfma_f32_16x16x32_bf16 v[60:63], v[84:87], a[232:235], v[60:63]
    s_waitcnt lgkmcnt(4)
    v_mfma_f32_16x16x32_bf16 v[32:35], v[88:91], a[44:47], v[32:35]
    v_mfma_f32_16x16x32_bf16 v[40:43], v[88:91], a[108:111], v[40:43]
    ds_read_b128 v[80:83], v18 offset:33536
    v_mfma_f32_16x16x32_bf16 v[48:51], v[88:91], a[172:175], v[48:51]
    v_mfma_f32_16x16x32_bf16 v[56:59], v[88:91], a[236:239], v[56:59]
    v_mfma_f32_16x16x32_bf16 v[36:39], v[92:95], a[44:47], v[36:39]
    v_mfma_f32_16x16x32_bf16 v[44:47], v[92:95], a[108:111], v[44:47]
    ds_read_b128 v[84:87], v18 offset:49920
    v_mfma_f32_16x16x32_bf16 v[52:55], v[92:95], a[172:175], v[52:55]
    v_mfma_f32_16x16x32_bf16 v[60:63], v[92:95], a[236:239], v[60:63]
    s_waitcnt lgkmcnt(4)
    v_mfma_f32_16x16x32_bf16 v[32:35], v[64:67], a[48:51], v[32:35]
    v_mfma_f32_16x16x32_bf16 v[40:43], v[64:67], a[112:115], v[40:43]
    ds_read_b128 v[88:91], v19 offset:33536
    v_mfma_f32_16x16x32_bf16 v[48:51], v[64:67], a[176:179], v[48:51]
    v_mfma_f32_16x16x32_bf16 v[56:59], v[64:67], a[240:243], v[56:59]
    v_mfma_f32_16x16x32_bf16 v[36:39], v[68:71], a[48:51], v[36:39]
    v_mfma_f32_16x16x32_bf16 v[44:47], v[68:71], a[112:115], v[44:47]
    ds_read_b128 v[92:95], v19 offset:49920
    v_mfma_f32_16x16x32_bf16 v[52:55], v[68:71], a[176:179], v[52:55]
    v_mfma_f32_16x16x32_bf16 v[60:63], v[68:71], a[240:243], v[60:63]
    s_waitcnt lgkmcnt(4)
    v_mfma_f32_16x16x32_bf16 v[32:35], v[72:75], a[52:55], v[32:35]
    v_mfma_f32_16x16x32_bf16 v[40:43], v[72:75], a[116:119], v[40:43]
    v_mfma_f32_16x16x32_bf16 v[48:51], v[72:75], a[180:183], v[48:51]
    v_mfma_f32_16x16x32_bf16 v[56:59], v[72:75], a[244:247], v[56:59]
    v_mfma_f32_16x16x32_bf16 v[36:39], v[76:79], a[52:55], v[36:39]
    v_mfma_f32_16x16x32_bf16 v[44:47], v[76:79], a[116:119], v[44:47]
    v_mfma_f32_16x16x32_bf16 v[52:55], v[76:79], a[180:183], v[52:55]
    v_mfma_f32_16x16x32_bf16 v[60:63], v[76:79], a[244:247], v[60:63]
    s_waitcnt lgkmcnt(2)
    v_mfma_f32_16x16x32_bf16 v[32:35], v[80:83], a[56:59], v[32:35]
    v_mfma_f32_16x16x32_bf16 v[40:43], v[80:83], a[120:123], v[40:43]
    v_mfma_f32_16x16x32_bf16 v[48:51], v[80:83], a[184:187], v[48:51]
    v_mfma_f32_16x16x32_bf16 v[56:59], v[80:83], a[248:251], v[56:59]
    v_mfma_f32_16x16x32_bf16 v[36:39], v[84:87], a[56:59], v[36:39]
    v_mfma_f32_16x16x32_bf16 v[44:47], v[84:87], a[120:123], v[44:47]
    v_mfma_f32_16x16x32_bf16 v[52:55], v[84:87], a[184:187], v[52:55]
    v_mfma_f32_16x16x32_bf16 v[60:63], v[84:87], a[248:251], v[60:63]
    s_waitcnt lgkmcnt(0)
    v_mfma_f32_16x16x32_bf16 v[32:35], v[88:91], a[60:63], v[32:35]
    v_mfma_f32_16x16x32_bf16 v[40:43], v[88:91], a[124:127], v[40:43]
    v_mfma_f32_16x16x32_bf16 v[48:51], v[88:91], a[188:191], v[48:51]
    v_mfma_f32_16x16x32_bf16 v[56:59], v[88:91], a[252:255], v[56:59]
    v_mfma_f32_16x16x32_bf16 v[36:39], v[92:95], a[60:63], v[36:39]
    v_mfma_f32_16x16x32_bf16 v[44:47], v[92:95], a[124:127], v[44:47]
    v_mfma_f32_16x16x32_bf16 v[52:55], v[92:95], a[188:191], v[52:55]
    v_mfma_f32_16x16x32_bf16 v[60:63], v[92:95], a[252:255], v[60:63]
    v_cvt_pk_bf16_f32 v96, v32, v33
    v_cvt_pk_bf16_f32 v97, v34, v35
    v_cvt_pk_bf16_f32 v98, v36, v37
    v_cvt_pk_bf16_f32 v99, v38, v39
    buffer_store_dwordx4 v[96:99], v4, s[4:7], s39 offen offset:0 sc0 sc1
    v_cvt_pk_bf16_f32 v100, v40, v41
    v_cvt_pk_bf16_f32 v101, v42, v43
    v_cvt_pk_bf16_f32 v102, v44, v45
    v_cvt_pk_bf16_f32 v103, v46, v47
    buffer_store_dwordx4 v[100:103], v4, s[4:7], s39 offen offset:1024 sc0 sc1
    v_cvt_pk_bf16_f32 v104, v48, v49
    v_cvt_pk_bf16_f32 v105, v50, v51
    v_cvt_pk_bf16_f32 v106, v52, v53
    v_cvt_pk_bf16_f32 v107, v54, v55
    buffer_store_dwordx4 v[104:107], v4, s[4:7], s39 offen offset:2048 sc0 sc1
    v_cvt_pk_bf16_f32 v108, v56, v57
    v_cvt_pk_bf16_f32 v109, v58, v59
    v_cvt_pk_bf16_f32 v110, v60, v61
    v_cvt_pk_bf16_f32 v111, v62, v63
    buffer_store_dwordx4 v[108:111], v4, s[4:7], s39 offen offset:3072 sc0 sc1
    s_add_u32 s39, s39, s37
    s_add_u32 s41, s41, 1
    s_cmp_lt_u32 s41, 16
    s_cbranch_scc1 QL_v0
QL_fin:
    s_waitcnt vmcnt(0)
    s_barrier
    v_mov_b32 v255, s41
    buffer_store_dword v255, off, s[4:7], s63 sc0 sc1
    s_cmp_lt_u32 s31, 32
    s_cbranch_scc1 L_attn
    s_cmp_lt_u32 s31, 160
    s_cbranch_scc1 L_wo
    s_cmp_lt_u32 s31, 176
    s_cbranch_scc1 L_s1
    s_sub_u32 s33, s31, 176
    s_and_b32 s32, s33, 3
    s_lshr_b32 s33, s33, 2
    s_mov_b32 s34, 4
    s_load_dwordx2 s[8:9], s[0:1], 40
    s_waitcnt lgkmcnt(0)
    s_mov_b32 s10, 524288
    s_mov_b32 s11, 0x20000
    s_load_dwordx2 s[12:13], s[0:1], 48
    s_waitcnt lgkmcnt(0)
    s_mov_b32 s14, 524288
    s_mov_b32 s15, 0x20000
    s_load_dwordx2 s[16:17], s[0:1], 0
    s_waitcnt lgkmcnt(0)
    s_mov_b32 s18, 2097152
    s_mov_b32 s19, 0x20000
    s_load_dwordx2 s[20:21], s[0:1], 128
    s_waitcnt lgkmcnt(0)
    s_mov_b32 s22, 8388608
    s_mov_b32 s23, 0x20000
    s_load_dwordx2 s[24:25], s[0:1], 64
    s_waitcnt lgkmcnt(0)
    s_mov_b32 s26, 1024
    s_mov_b32 s27, 0x20000
    v_lshlrev_b32 v1, 4, v0
    v_and_b32 v80, 15, v0
    v_lshrrev_b32 v81, 4, v0
    v_bfe_u32 v82, v0, 2, 2
    v_and_b32 v83, 3, v0
    s_lshl_b32 s45, s32, 7
    s_lshl_b32 s46, s30, 5
    s_add_u32 s48, s45, s46
    v_add_u32 v84, s48, v80
    v_lshlrev_b32 v84, 10, v84
    v_lshl_add_u32 v84, v81, 4, v84
    s_mov_b32 s47, 16384
    buffer_load_dwordx4 a[0:3], v84, s[8:11], 0 offen offset:0
    buffer_load_dwordx4 a[4:7], v84, s[8:11], 0 offen offset:64
    buffer_load_dwordx4 a[8:11], v84, s[8:11], 0 offen offset:128
    buffer_load_dwordx4 a[12:15], v84, s[8:11], 0 offen offset:192
    buffer_load_dwordx4 a[16:19], v84, s[8:11], 0 offen offset:256
    buffer_load_dwordx4 a[20:23], v84, s[8:11], 0 offen offset:320
    buffer_load_dwordx4 a[24:27], v84, s[8:11], 0 offen offset:384
    buffer_load_dwordx4 a[28:31], v84, s[8:11], 0 offen offset:448
    buffer_load_dwordx4 a[32:35], v84, s[8:11], 0 offen offset:512
    buffer_load_dwordx4 a[36:39], v84, s[8:11], 0 offen offset:576
    buffer_load_dwordx4 a[40:43], v84, s[8:11], 0 offen offset:640
    buffer_load_dwordx4 a[44:47], v84, s[8:11], 0 offen offset:704
    buffer_load_dwordx4 a[48:51], v84, s[8:11], 0 offen offset:768
    buffer_load_dwordx4 a[52:55], v84, s[8:11], 0 offen offset:832
    buffer_load_dwordx4 a[56:59], v84, s[8:11], 0 offen offset:896
    buffer_load_dwordx4 a[60:63], v84, s[8:11], 0 offen offset:960
    buffer_load_dwordx4 a[64:67], v84, s[12:15], 0 offen offset:0
    buffer_load_dwordx4 a[68:71], v84, s[12:15], 0 offen offset:64
    buffer_load_dwordx4 a[72:75], v84, s[12:15], 0 offen offset:128
    buffer_load_dwordx4 a[76:79], v84, s[12:15], 0 offen offset:192
    buffer_load_dwordx4 a[80:83], v84, s[12:15], 0 offen offset:256
    buffer_load_dwordx4 a[84:87], v84, s[12:15], 0 offen offset:320
    buffer_load_dwordx4 a[88:91], v84, s[12:15], 0 offen offset:384
    buffer_load_dwordx4 a[92:95], v84, s[12:15], 0 offen offset:448
    buffer_load_dwordx4 a[96:99], v84, s[12:15], 0 offen offset:512
    buffer_load_dwordx4 a[100:103], v84, s[12:15], 0 offen offset:576
    buffer_load_dwordx4 a[104:107], v84, s[12:15], 0 offen offset:640
    buffer_load_dwordx4 a[108:111], v84, s[12:15], 0 offen offset:704
    buffer_load_dwordx4 a[112:115], v84, s[12:15], 0 offen offset:768
    buffer_load_dwordx4 a[116:119], v84, s[12:15], 0 offen offset:832
    buffer_load_dwordx4 a[120:123], v84, s[12:15], 0 offen offset:896
    buffer_load_dwordx4 a[124:127], v84, s[12:15], 0 offen offset:960
    buffer_load_dwordx4 a[128:131], v84, s[8:11], s47 offen offset:0
    buffer_load_dwordx4 a[132:135], v84, s[8:11], s47 offen offset:64
    buffer_load_dwordx4 a[136:139], v84, s[8:11], s47 offen offset:128
    buffer_load_dwordx4 a[140:143], v84, s[8:11], s47 offen offset:192
    buffer_load_dwordx4 a[144:147], v84, s[8:11], s47 offen offset:256
    buffer_load_dwordx4 a[148:151], v84, s[8:11], s47 offen offset:320
    buffer_load_dwordx4 a[152:155], v84, s[8:11], s47 offen offset:384
    buffer_load_dwordx4 a[156:159], v84, s[8:11], s47 offen offset:448
    buffer_load_dwordx4 a[160:163], v84, s[8:11], s47 offen offset:512
    buffer_load_dwordx4 a[164:167], v84, s[8:11], s47 offen offset:576
    buffer_load_dwordx4 a[168:171], v84, s[8:11], s47 offen offset:640
    buffer_load_dwordx4 a[172:175], v84, s[8:11], s47 offen offset:704
    buffer_load_dwordx4 a[176:179], v84, s[8:11], s47 offen offset:768
    buffer_load_dwordx4 a[180:183], v84, s[8:11], s47 offen offset:832
    buffer_load_dwordx4 a[184:187], v84, s[8:11], s47 offen offset:896
    buffer_load_dwordx4 a[188:191], v84, s[8:11], s47 offen offset:960
    buffer_load_dwordx4 a[192:195], v84, s[12:15], s47 offen offset:0
    buffer_load_dwordx4 a[196:199], v84, s[12:15], s47 offen offset:64
    buffer_load_dwordx4 a[200:203], v84, s[12:15], s47 offen offset:128
    buffer_load_dwordx4 a[204:207], v84, s[12:15], s47 offen offset:192
    buffer_load_dwordx4 a[208:211], v84, s[12:15], s47 offen offset:256
    buffer_load_dwordx4 a[212:215], v84, s[12:15], s47 offen offset:320
    buffer_load_dwordx4 a[216:219], v84, s[12:15], s47 offen offset:384
    buffer_load_dwordx4 a[220:223], v84, s[12:15], s47 offen offset:448
    buffer_load_dwordx4 a[224:227], v84, s[12:15], s47 offen offset:512
    buffer_load_dwordx4 a[228:231], v84, s[12:15], s47 offen offset:576
    buffer_load_dwordx4 a[232:235], v84, s[12:15], s47 offen offset:640
    buffer_load_dwordx4 a[236:239], v84, s[12:15], s47 offen offset:704
    buffer_load_dwordx4 a[240:243], v84, s[12:15], s47 offen offset:768
    buffer_load_dwordx4 a[244:247], v84, s[12:15], s47 offen offset:832
    buffer_load_dwordx4 a[248:251], v84, s[12:15], s47 offen offset:896
    buffer_load_dwordx4 a[252:255], v84, s[12:15], s47 offen offset:960
    v_lshlrev_b32 v85, 2, v81
    v_add_u32 v85, s48, v85
    v_lshlrev_b32 v86, 1, v85
    buffer_load_dwordx2 v[88:89], v86, s[24:27], 0 offen
    buffer_load_dwordx2 v[90:91], v86, s[24:27], 0 offen offset:32
    v_lshlrev_b32 v87, 12, v80
    v_lshl_add_u32 v3, v85, 2, v87
    v_lshl_add_u32 v4, v80, 10, v86
    v_lshl_add_u32 v87, v81, 3, v82
    v_lshlrev_b32 v87, 6, v87
    v_and_b32 v85, 1, v81
    v_lshl_add_u32 v87, v85, 5, v87
    v_lshl_add_u32 v2, v83, 3, v87
    v_xor_b32 v5, 32, v2
    v_add_u32 v6, 65536, v2
    v_add_u32 v7, 65536, v5
    s_waitcnt vmcnt(0)
    v_lshlrev_b32 v8, 16, v88
    v_and_b32 v9, 0xffff0000, v88
    v_lshlrev_b32 v10, 16, v89
    v_and_b32 v11, 0xffff0000, v89
    v_lshlrev_b32 v12, 16, v90
    v_and_b32 v13, 0xffff0000, v90
    v_lshlrev_b32 v14, 16, v91
    v_and_b32 v15, 0xffff0000, v91
    s_min_u32 s61, s33, 63
    s_lshr_b32 s61, s61, 1
    s_add_u32 s61, s61, 1
    s_mov_b32 s60, 1838976
    s_cmp_lg_u32 s30, 0
    s_cbranch_scc1 L_wb1
    v_lshlrev_b32 v254, 2, v0
    s_mov_b64 exec, 65535
    s_mov_b32 s62, 0
L_w1:
    buffer_load_dword v255, v254, s[4:7], s60 offen sc1
    s_add_u32 s62, s62, 1
    s_cmp_gt_u32 s62, 2000000
    s_cbranch_scc1 L_end
    s_waitcnt vmcnt(0)
    v_cmp_gt_u32 vcc, s61, v255
    s_nop 0
    s_cbranch_vccz L_wd1
    s_sleep 32
    s_branch L_w1
    s_nop 0
L_wd1:
    s_mov_b64 exec, -1
L_wb1:
    s_barrier
    s_lshl_b32 s35, s33, 16
    s_add_u32 s35, s35, 87031808
    s_lshl_b32 s45, s30, 14
    s_add_u32 s46, s35, s45
    s_add_u32 m0, s45, 0
    s_add_u32 s46, s46, 0
    buffer_load_dwordx4 v1, s[4:7], s46 offen sc1 lds
    s_lshl_b32 s45, s30, 14
    s_add_u32 s46, s35, s45
    s_add_u32 m0, s45, 1024
    s_add_u32 s46, s46, 1024
    buffer_load_dwordx4 v1, s[4:7], s46 offen sc1 lds
    s_lshl_b32 s45, s30, 14
    s_add_u32 s46, s35, s45
    s_add_u32 m0, s45, 2048
    s_add_u32 s46, s46, 2048
    buffer_load_dwordx4 v1, s[4:7], s46 offen sc1 lds
    s_lshl_b32 s45, s30, 14
    s_add_u32 s46, s35, s45
    s_add_u32 m0, s45, 3072
    s_add_u32 s46, s46, 3072
    buffer_load_dwordx4 v1, s[4:7], s46 offen sc1 lds
    s_lshl_b32 s45, s30, 14
    s_add_u32 s46, s35, s45
    s_add_u32 m0, s45, 4096
    s_add_u32 s46, s46, 4096
    buffer_load_dwordx4 v1, s[4:7], s46 offen sc1 lds
    s_lshl_b32 s45, s30, 14
    s_add_u32 s46, s35, s45
    s_add_u32 m0, s45, 5120
    s_add_u32 s46, s46, 5120
    buffer_load_dwordx4 v1, s[4:7], s46 offen sc1 lds
    s_lshl_b32 s45, s30, 14
    s_add_u32 s46, s35, s45
    s_add_u32 m0, s45, 6144
    s_add_u32 s46, s46, 6144
    buffer_load_dwordx4 v1, s[4:7], s46 offen sc1 lds
    s_lshl_b32 s45, s30, 14
    s_add_u32 s46, s35, s45
    s_add_u32 m0, s45, 7168
    s_add_u32 s46, s46, 7168
    buffer_load_dwordx4 v1, s[4:7], s46 offen sc1 lds
    s_lshl_b32 s45, s30, 14
    s_add_u32 s46, s35, s45
    s_add_u32 m0, s45, 8192
    s_add_u32 s46, s46, 8192
    buffer_load_dwordx4 v1, s[4:7], s46 offen sc1 lds
    s_lshl_b32 s45, s30, 14
    s_add_u32 s46, s35, s45
    s_add_u32 m0, s45, 9216
    s_add_u32 s46, s46, 9216
    buffer_load_dwordx4 v1, s[4:7], s46 offen sc1 lds
    s_lshl_b32 s45, s30, 14
    s_add_u32 s46, s35, s45
    s_add_u32 m0, s45, 10240
    s_add_u32 s46, s46, 10240
    buffer_load_dwordx4 v1, s[4:7], s46 offen sc1 lds
    s_lshl_b32 s45, s30, 14
    s_add_u32 s46, s35, s45
    s_add_u32 m0, s45, 11264
    s_add_u32 s46, s46, 11264
    buffer_load_dwordx4 v1, s[4:7], s46 offen sc1 lds
    s_lshl_b32 s45, s30, 14
    s_add_u32 s46, s35, s45
    s_add_u32 m0, s45, 12288
    s_add_u32 s46, s46, 12288
    buffer_load_dwordx4 v1, s[4:7], s46 offen sc1 lds
    s_lshl_b32 s45, s30, 14
    s_add_u32 s46, s35, s45
    s_add_u32 m0, s45, 13312
    s_add_u32 s46, s46, 13312
    buffer_load_dwordx4 v1, s[4:7], s46 offen sc1 lds
    s_lshl_b32 s45, s30, 14
    s_add_u32 s46, s35, s45
    s_add_u32 m0, s45, 14336
    s_add_u32 s46, s46, 14336
    buffer_load_dwordx4 v1, s[4:7], s46 offen sc1 lds
    s_lshl_b32 s45, s30, 14
    s_add_u32 s46, s35, s45
    s_add_u32 m0, s45, 15360
    s_add_u32 s46, s46, 15360
    buffer_load_dwordx4 v1, s[4:7], s46 offen sc1 lds
S3L_b0:
    s_lshl_b32 s36, s33, 17
    s_lshl_b32 s37, s33, 15
    s_add_u32 s33, s33, s34
    s_min_u32 s61, s33, 63
    s_lshr_b32 s61, s61, 1
    s_add_u32 s61, s61, 1
    s_mov_b32 s60, 1838976
    s_cmp_lg_u32 s30, 0
    s_cbranch_scc1 L_wb2
    v_lshlrev_b32 v254, 2, v0
    s_mov_b64 exec, 65535
    s_mov_b32 s62, 0
L_w2:
    buffer_load_dword v255, v254, s[4:7], s60 offen sc1
    s_add_u32 s62, s62, 1
    s_cmp_gt_u32 s62, 2000000
    s_cbranch_scc1 L_end
    s_waitcnt vmcnt(0)
    v_cmp_gt_u32 vcc, s61, v255
    s_nop 0
    s_cbranch_vccz L_wd2
    s_sleep 32
    s_branch L_w2
    s_nop 0
L_wd2:
    s_mov_b64 exec, -1
L_wb2:
    s_barrier
    s_lshl_b32 s35, s33, 16
    s_add_u32 s35, s35, 87031808
    s_waitcnt vmcnt(0)
    s_barrier
    s_add_u32 s47, s37, 16384
    buffer_load_dwordx2 v[64:65], v4, s[16:19], s37 offen offset:0
    buffer_load_dwordx2 v[68:69], v4, s[16:19], s37 offen offset:32
    buffer_load_dwordx2 v[66:67], v4, s[16:19], s47 offen offset:0
    buffer_load_dwordx2 v[70:71], v4, s[16:19], s47 offen offset:32
    ds_read_b64_tr_b16 v[32:33], v2 offset:0
    ds_read_b64_tr_b16 v[34:35], v2 offset:256
    ds_read_b64_tr_b16 v[36:37], v5 offset:0
    ds_read_b64_tr_b16 v[38:39], v5 offset:256
    ds_read_b64_tr_b16 v[40:41], v2 offset:2048
    ds_read_b64_tr_b16 v[42:43], v2 offset:2304
    ds_read_b64_tr_b16 v[44:45], v5 offset:2048
    ds_read_b64_tr_b16 v[46:47], v5 offset:2304
    ds_read_b64_tr_b16 v[48:49], v2 offset:4096
    ds_read_b64_tr_b16 v[50:51], v2 offset:4352
    ds_read_b64_tr_b16 v[52:53], v5 offset:4096
    ds_read_b64_tr_b16 v[54:55], v5 offset:4352
    s_waitcnt lgkmcnt(8)
    v_mfma_f32_16x16x32_bf16 v[16:19], a[0:3], v[32:35], 0
    ds_read_b64_tr_b16 v[56:57], v2 offset:6144
    v_mfma_f32_16x16x32_bf16 v[24:27], a[128:131], v[32:35], 0
    ds_read_b64_tr_b16 v[58:59], v2 offset:6400
    v_mfma_f32_16x16x32_bf16 v[20:23], a[0:3], v[36:39], 0
    ds_read_b64_tr_b16 v[60:61], v5 offset:6144
    v_mfma_f32_16x16x32_bf16 v[28:31], a[128:131], v[36:39], 0
    ds_read_b64_tr_b16 v[62:63], v5 offset:6400
    s_lshl_b32 s45, s30, 14
    s_add_u32 s46, s35, s45
    s_add_u32 m0, s45, 65536
    s_add_u32 s46, s46, 0
    buffer_load_dwordx4 v1, s[4:7], s46 offen sc1 lds
    s_waitcnt lgkmcnt(8)
    v_mfma_f32_16x16x32_bf16 v[16:19], a[4:7], v[40:43], v[16:19]
    ds_read_b64_tr_b16 v[32:33], v2 offset:8192
    v_mfma_f32_16x16x32_bf16 v[24:27], a[132:135], v[40:43], v[24:27]
    ds_read_b64_tr_b16 v[34:35], v2 offset:8448
    v_mfma_f32_16x16x32_bf16 v[20:23], a[4:7], v[44:47], v[20:23]
    ds_read_b64_tr_b16 v[36:37], v5 offset:8192
    v_mfma_f32_16x16x32_bf16 v[28:31], a[132:135], v[44:47], v[28:31]
    ds_read_b64_tr_b16 v[38:39], v5 offset:8448
    s_waitcnt lgkmcnt(8)
    v_mfma_f32_16x16x32_bf16 v[16:19], a[8:11], v[48:51], v[16:19]
    ds_read_b64_tr_b16 v[40:41], v2 offset:10240
    v_mfma_f32_16x16x32_bf16 v[24:27], a[136:139], v[48:51], v[24:27]
    ds_read_b64_tr_b16 v[42:43], v2 offset:10496
    v_mfma_f32_16x16x32_bf16 v[20:23], a[8:11], v[52:55], v[20:23]
    ds_read_b64_tr_b16 v[44:45], v5 offset:10240
    v_mfma_f32_16x16x32_bf16 v[28:31], a[136:139], v[52:55], v[28:31]
    ds_read_b64_tr_b16 v[46:47], v5 offset:10496
    s_lshl_b32 s45, s30, 14
    s_add_u32 s46, s35, s45
    s_add_u32 m0, s45, 66560
    s_add_u32 s46, s46, 1024
    buffer_load_dwordx4 v1, s[4:7], s46 offen sc1 lds
    s_waitcnt lgkmcnt(8)
    v_mfma_f32_16x16x32_bf16 v[16:19], a[12:15], v[56:59], v[16:19]
    ds_read_b64_tr_b16 v[48:49], v2 offset:12288
    v_mfma_f32_16x16x32_bf16 v[24:27], a[140:143], v[56:59], v[24:27]
    ds_read_b64_tr_b16 v[50:51], v2 offset:12544
    v_mfma_f32_16x16x32_bf16 v[20:23], a[12:15], v[60:63], v[20:23]
    ds_read_b64_tr_b16 v[52:53], v5 offset:12288
    v_mfma_f32_16x16x32_bf16 v[28:31], a[140:143], v[60:63], v[28:31]
    ds_read_b64_tr_b16 v[54:55], v5 offset:12544
    s_waitcnt lgkmcnt(8)
    v_mfma_f32_16x16x32_bf16 v[16:19], a[16:19], v[32:35], v[16:19]
    ds_read_b64_tr_b16 v[56:57], v2 offset:14336
    v_mfma_f32_16x16x32_bf16 v[24:27], a[144:147], v[32:35], v[24:27]
    ds_read_b64_tr_b16 v[58:59], v2 offset:14592
    v_mfma_f32_16x16x32_bf16 v[20:23], a[16:19], v[36:39], v[20:23]
    ds_read_b64_tr_b16 v[60:61], v5 offset:14336
    v_mfma_f32_16x16x32_bf16 v[28:31], a[144:147], v[36:39], v[28:31]
    ds_read_b64_tr_b16 v[62:63], v5 offset:14592
    s_lshl_b32 s45, s30, 14
    s_add_u32 s46, s35, s45
    s_add_u32 m0, s45, 67584
    s_add_u32 s46, s46, 2048
    buffer_load_dwordx4 v1, s[4:7], s46 offen sc1 lds
    s_waitcnt lgkmcnt(8)
    v_mfma_f32_16x16x32_bf16 v[16:19], a[20:23], v[40:43], v[16:19]
    ds_read_b64_tr_b16 v[32:33], v2 offset:16384
    v_mfma_f32_16x16x32_bf16 v[24:27], a[148:151], v[40:43], v[24:27]
    ds_read_b64_tr_b16 v[34:35], v2 offset:16640
    v_mfma_f32_16x16x32_bf16 v[20:23], a[20:23], v[44:47], v[20:23]
    ds_read_b64_tr_b16 v[36:37], v5 offset:16384
    v_mfma_f32_16x16x32_bf16 v[28:31], a[148:151], v[44:47], v[28:31]
    ds_read_b64_tr_b16 v[38:39], v5 offset:16640
    s_waitcnt lgkmcnt(8)
    v_mfma_f32_16x16x32_bf16 v[16:19], a[24:27], v[48:51], v[16:19]
    ds_read_b64_tr_b16 v[40:41], v2 offset:18432
    v_mfma_f32_16x16x32_bf16 v[24:27], a[152:155], v[48:51], v[24:27]
    ds_read_b64_tr_b16 v[42:43], v2 offset:18688
    v_mfma_f32_16x16x32_bf16 v[20:23], a[24:27], v[52:55], v[20:23]
    ds_read_b64_tr_b16 v[44:45], v5 offset:18432
    v_mfma_f32_16x16x32_bf16 v[28:31], a[152:155], v[52:55], v[28:31]
    ds_read_b64_tr_b16 v[46:47], v5 offset:18688
    s_lshl_b32 s45, s30, 14
    s_add_u32 s46, s35, s45
    s_add_u32 m0, s45, 68608
    s_add_u32 s46, s46, 3072
    buffer_load_dwordx4 v1, s[4:7], s46 offen sc1 lds
    s_waitcnt lgkmcnt(8)
    v_mfma_f32_16x16x32_bf16 v[16:19], a[28:31], v[56:59], v[16:19]
    ds_read_b64_tr_b16 v[48:49], v2 offset:20480
    v_mfma_f32_16x16x32_bf16 v[24:27], a[156:159], v[56:59], v[24:27]
    ds_read_b64_tr_b16 v[50:51], v2 offset:20736
    v_mfma_f32_16x16x32_bf16 v[20:23], a[28:31], v[60:63], v[20:23]
    ds_read_b64_tr_b16 v[52:53], v5 offset:20480
    v_mfma_f32_16x16x32_bf16 v[28:31], a[156:159], v[60:63], v[28:31]
    ds_read_b64_tr_b16 v[54:55], v5 offset:20736
    s_waitcnt lgkmcnt(8)
    v_mfma_f32_16x16x32_bf16 v[16:19], a[32:35], v[32:35], v[16:19]
    ds_read_b64_tr_b16 v[56:57], v2 offset:22528
    v_mfma_f32_16x16x32_bf16 v[24:27], a[160:163], v[32:35], v[24:27]
    ds_read_b64_tr_b16 v[58:59], v2 offset:22784
    v_mfma_f32_16x16x32_bf16 v[20:23], a[32:35], v[36:39], v[20:23]
    ds_read_b64_tr_b16 v[60:61], v5 offset:22528
    v_mfma_f32_16x16x32_bf16 v[28:31], a[160:163], v[36:39], v[28:31]
    ds_read_b64_tr_b16 v[62:63], v5 offset:22784
    s_lshl_b32 s45, s30, 14
    s_add_u32 s46, s35, s45
    s_add_u32 m0, s45, 69632
    s_add_u32 s46, s46, 4096
    buffer_load_dwordx4 v1, s[4:7], s46 offen sc1 lds
    s_waitcnt lgkmcnt(8)
    v_mfma_f32_16x16x32_bf16 v[16:19], a[36:39], v[40:43], v[16:19]
    ds_read_b64_tr_b16 v[32:33], v2 offset:24576
    v_mfma_f32_16x16x32_bf16 v[24:27], a[164:167], v[40:43], v[24:27]
    ds_read_b64_tr_b16 v[34:35], v2 offset:24832
    v_mfma_f32_16x16x32_bf16 v[20:23], a[36:39], v[44:47], v[20:23]
    ds_read_b64_tr_b16 v[36:37], v5 offset:24576
    v_mfma_f32_16x16x32_bf16 v[28:31], a[164:167], v[44:47], v[28:31]
    ds_read_b64_tr_b16 v[38:39], v5 offset:24832
    s_waitcnt lgkmcnt(8)
    v_mfma_f32_16x16x32_bf16 v[16:19], a[40:43], v[48:51], v[16:19]
    ds_read_b64_tr_b16 v[40:41], v2 offset:26624
    v_mfma_f32_16x16x32_bf16 v[24:27], a[168:171], v[48:51], v[24:27]
    ds_read_b64_tr_b16 v[42:43], v2 offset:26880
    v_mfma_f32_16x16x32_bf16 v[20:23], a[40:43], v[52:55], v[20:23]
    ds_read_b64_tr_b16 v[44:45], v5 offset:26624
    v_mfma_f32_16x16x32_bf16 v[28:31], a[168:171], v[52:55], v[28:31]
    ds_read_b64_tr_b16 v[46:47], v5 offset:26880
    s_lshl_b32 s45, s30, 14
    s_add_u32 s46, s35, s45
    s_add_u32 m0, s45, 70656
    s_add_u32 s46, s46, 5120
    buffer_load_dwordx4 v1, s[4:7], s46 offen sc1 lds
    s_waitcnt lgkmcnt(8)
    v_mfma_f32_16x16x32_bf16 v[16:19], a[44:47], v[56:59], v[16:19]
    ds_read_b64_tr_b16 v[48:49], v2 offset:28672
    v_mfma_f32_16x16x32_bf16 v[24:27], a[172:175], v[56:59], v[24:27]
    ds_read_b64_tr_b16 v[50:51], v2 offset:28928
    v_mfma_f32_16x16x32_bf16 v[20:23], a[44:47], v[60:63], v[20:23]
    ds_read_b64_tr_b16 v[52:53], v5 offset:28672
    v_mfma_f32_16x16x32_bf16 v[28:31], a[172:175], v[60:63], v[28:31]
    ds_read_b64_tr_b16 v[54:55], v5 offset:28928
    s_waitcnt lgkmcnt(8)
    v_mfma_f32_16x16x32_bf16 v[16:19], a[48:51], v[32:35], v[16:19]
    ds_read_b64_tr_b16 v[56:57], v2 offset:30720
    v_mfma_f32_16x16x32_bf16 v[24:27], a[176:179], v[32:35], v[24:27]
    ds_read_b64_tr_b16 v[58:59], v2 offset:30976
    v_mfma_f32_16x16x32_bf16 v[20:23], a[48:51], v[36:39], v[20:23]
    ds_read_b64_tr_b16 v[60:61], v5 offset:30720
    v_mfma_f32_16x16x32_bf16 v[28:31], a[176:179], v[36:39], v[28:31]
    ds_read_b64_tr_b16 v[62:63], v5 offset:30976
    s_lshl_b32 s45, s30, 14
    s_add_u32 s46, s35, s45
    s_add_u32 m0, s45, 71680
    s_add_u32 s46, s46, 6144
    buffer_load_dwordx4 v1, s[4:7], s46 offen sc1 lds
    s_waitcnt lgkmcnt(8)
    v_mfma_f32_16x16x32_bf16 v[16:19], a[52:55], v[40:43], v[16:19]
    ds_read_b64_tr_b16 v[32:33], v2 offset:32768
    v_mfma_f32_16x16x32_bf16 v[24:27], a[180:183], v[40:43], v[24:27]
    ds_read_b64_tr_b16 v[34:35], v2 offset:33024
    v_mfma_f32_16x16x32_bf16 v[20:23], a[52:55], v[44:47], v[20:23]
    ds_read_b64_tr_b16 v[36:37], v5 offset:32768
    v_mfma_f32_16x16x32_bf16 v[28:31], a[180:183], v[44:47], v[28:31]
    ds_read_b64_tr_b16 v[38:39], v5 offset:33024
    s_waitcnt lgkmcnt(8)
    v_mfma_f32_16x16x32_bf16 v[16:19], a[56:59], v[48:51], v[16:19]
    ds_read_b64_tr_b16 v[40:41], v2 offset:34816
    v_mfma_f32_16x16x32_bf16 v[24:27], a[184:187], v[48:51], v[24:27]
    ds_read_b64_tr_b16 v[42:43], v2 offset:35072
    v_mfma_f32_16x16x32_bf16 v[20:23], a[56:59], v[52:55], v[20:23]
    ds_read_b64_tr_b16 v[44:45], v5 offset:34816
    v_mfma_f32_16x16x32_bf16 v[28:31], a[184:187], v[52:55], v[28:31]
    ds_read_b64_tr_b16 v[46:47], v5 offset:35072
    s_lshl_b32 s45, s30, 14
    s_add_u32 s46, s35, s45
    s_add_u32 m0, s45, 72704
    s_add_u32 s46, s46, 7168
    buffer_load_dwordx4 v1, s[4:7], s46 offen sc1 lds
    s_waitcnt lgkmcnt(8)
    v_mfma_f32_16x16x32_bf16 v[16:19], a[60:63], v[56:59], v[16:19]
    ds_read_b64_tr_b16 v[48:49], v2 offset:36864
    v_mfma_f32_16x16x32_bf16 v[24:27], a[188:191], v[56:59], v[24:27]
    ds_read_b64_tr_b16 v[50:51], v2 offset:37120
    v_mfma_f32_16x16x32_bf16 v[20:23], a[60:63], v[60:63], v[20:23]
    ds_read_b64_tr_b16 v[52:53], v5 offset:36864
    v_mfma_f32_16x16x32_bf16 v[28:31], a[188:191], v[60:63], v[28:31]
    ds_read_b64_tr_b16 v[54:55], v5 offset:37120
    s_waitcnt lgkmcnt(8)
    v_mfma_f32_16x16x32_bf16 v[16:19], a[64:67], v[32:35], v[16:19]
    ds_read_b64_tr_b16 v[56:57], v2 offset:38912
    v_mfma_f32_16x16x32_bf16 v[24:27], a[192:195], v[32:35], v[24:27]
    ds_read_b64_tr_b16 v[58:59], v2 offset:39168
    v_mfma_f32_16x16x32_bf16 v[20:23], a[64:67], v[36:39], v[20:23]
    ds_read_b64_tr_b16 v[60:61], v5 offset:38912
    v_mfma_f32_16x16x32_bf16 v[28:31], a[192:195], v[36:39], v[28:31]
    ds_read_b64_tr_b16 v[62:63], v5 offset:39168
    s_lshl_b32 s45, s30, 14
    s_add_u32 s46, s35, s45
    s_add_u32 m0, s45, 73728
    s_add_u32 s46, s46, 8192
    buffer_load_dwordx4 v1, s[4:7], s46 offen sc1 lds
    s_waitcnt lgkmcnt(8)
    v_mfma_f32_16x16x32_bf16 v[16:19], a[68:71], v[40:43], v[16:19]
    ds_read_b64_tr_b16 v[32:33], v2 offset:40960
    v_mfma_f32_16x16x32_bf16 v[24:27], a[196:199], v[40:43], v[24:27]
    ds_read_b64_tr_b16 v[34:35], v2 offset:41216
    v_mfma_f32_16x16x32_bf16 v[20:23], a[68:71], v[44:47], v[20:23]
    ds_read_b64_tr_b16 v[36:37], v5 offset:40960
    v_mfma_f32_16x16x32_bf16 v[28:31], a[196:199], v[44:47], v[28:31]
    ds_read_b64_tr_b16 v[38:39], v5 offset:41216
    s_waitcnt lgkmcnt(8)
    v_mfma_f32_16x16x32_bf16 v[16:19], a[72:75], v[48:51], v[16:19]
    ds_read_b64_tr_b16 v[40:41], v2 offset:43008
    v_mfma_f32_16x16x32_bf16 v[24:27], a[200:203], v[48:51], v[24:27]
    ds_read_b64_tr_b16 v[42:43], v2 offset:43264
    v_mfma_f32_16x16x32_bf16 v[20:23], a[72:75], v[52:55], v[20:23]
    ds_read_b64_tr_b16 v[44:45], v5 offset:43008
    v_mfma_f32_16x16x32_bf16 v[28:31], a[200:203], v[52:55], v[28:31]
    ds_read_b64_tr_b16 v[46:47], v5 offset:43264
    s_lshl_b32 s45, s30, 14
    s_add_u32 s46, s35, s45
    s_add_u32 m0, s45, 74752
    s_add_u32 s46, s46, 9216
    buffer_load_dwordx4 v1, s[4:7], s46 offen sc1 lds
    s_waitcnt lgkmcnt(8)
    v_mfma_f32_16x16x32_bf16 v[16:19], a[76:79], v[56:59], v[16:19]
    ds_read_b64_tr_b16 v[48:49], v2 offset:45056
    v_mfma_f32_16x16x32_bf16 v[24:27], a[204:207], v[56:59], v[24:27]
    ds_read_b64_tr_b16 v[50:51], v2 offset:45312
    v_mfma_f32_16x16x32_bf16 v[20:23], a[76:79], v[60:63], v[20:23]
    ds_read_b64_tr_b16 v[52:53], v5 offset:45056
    v_mfma_f32_16x16x32_bf16 v[28:31], a[204:207], v[60:63], v[28:31]
    ds_read_b64_tr_b16 v[54:55], v5 offset:45312
    s_waitcnt lgkmcnt(8)
    v_mfma_f32_16x16x32_bf16 v[16:19], a[80:83], v[32:35], v[16:19]
    ds_read_b64_tr_b16 v[56:57], v2 offset:47104
    v_mfma_f32_16x16x32_bf16 v[24:27], a[208:211], v[32:35], v[24:27]
    ds_read_b64_tr_b16 v[58:59], v2 offset:47360
    v_mfma_f32_16x16x32_bf16 v[20:23], a[80:83], v[36:39], v[20:23]
    ds_read_b64_tr_b16 v[60:61], v5 offset:47104
    v_mfma_f32_16x16x32_bf16 v[28:31], a[208:211], v[36:39], v[28:31]
    ds_read_b64_tr_b16 v[62:63], v5 offset:47360
    s_lshl_b32 s45, s30, 14
    s_add_u32 s46, s35, s45
    s_add_u32 m0, s45, 75776
    s_add_u32 s46, s46, 10240
    buffer_load_dwordx4 v1, s[4:7], s46 offen sc1 lds
    s_waitcnt lgkmcnt(8)
    v_mfma_f32_16x16x32_bf16 v[16:19], a[84:87], v[40:43], v[16:19]
    ds_read_b64_tr_b16 v[32:33], v2 offset:49152
    v_mfma_f32_16x16x32_bf16 v[24:27], a[212:215], v[40:43], v[24:27]
    ds_read_b64_tr_b16 v[34:35], v2 offset:49408
    v_mfma_f32_16x16x32_bf16 v[20:23], a[84:87], v[44:47], v[20:23]
    ds_read_b64_tr_b16 v[36:37], v5 offset:49152
    v_mfma_f32_16x16x32_bf16 v[28:31], a[212:215], v[44:47], v[28:31]
    ds_read_b64_tr_b16 v[38:39], v5 offset:49408
    s_waitcnt lgkmcnt(8)
    v_mfma_f32_16x16x32_bf16 v[16:19], a[88:91], v[48:51], v[16:19]
    ds_read_b64_tr_b16 v[40:41], v2 offset:51200
    v_mfma_f32_16x16x32_bf16 v[24:27], a[216:219], v[48:51], v[24:27]
    ds_read_b64_tr_b16 v[42:43], v2 offset:51456
    v_mfma_f32_16x16x32_bf16 v[20:23], a[88:91], v[52:55], v[20:23]
    ds_read_b64_tr_b16 v[44:45], v5 offset:51200
    v_mfma_f32_16x16x32_bf16 v[28:31], a[216:219], v[52:55], v[28:31]
    ds_read_b64_tr_b16 v[46:47], v5 offset:51456
    s_lshl_b32 s45, s30, 14
    s_add_u32 s46, s35, s45
    s_add_u32 m0, s45, 76800
    s_add_u32 s46, s46, 11264
    buffer_load_dwordx4 v1, s[4:7], s46 offen sc1 lds
    s_waitcnt lgkmcnt(8)
    v_mfma_f32_16x16x32_bf16 v[16:19], a[92:95], v[56:59], v[16:19]
    ds_read_b64_tr_b16 v[48:49], v2 offset:53248
    v_mfma_f32_16x16x32_bf16 v[24:27], a[220:223], v[56:59], v[24:27]
    ds_read_b64_tr_b16 v[50:51], v2 offset:53504
    v_mfma_f32_16x16x32_bf16 v[20:23], a[92:95], v[60:63], v[20:23]
    ds_read_b64_tr_b16 v[52:53], v5 offset:53248
    v_mfma_f32_16x16x32_bf16 v[28:31], a[220:223], v[60:63], v[28:31]
    ds_read_b64_tr_b16 v[54:55], v5 offset:53504
    s_waitcnt lgkmcnt(8)
    v_mfma_f32_16x16x32_bf16 v[16:19], a[96:99], v[32:35], v[16:19]
    ds_read_b64_tr_b16 v[56:57], v2 offset:55296
    v_mfma_f32_16x16x32_bf16 v[24:27], a[224:227], v[32:35], v[24:27]
    ds_read_b64_tr_b16 v[58:59], v2 offset:55552
    v_mfma_f32_16x16x32_bf16 v[20:23], a[96:99], v[36:39], v[20:23]
    ds_read_b64_tr_b16 v[60:61], v5 offset:55296
    v_mfma_f32_16x16x32_bf16 v[28:31], a[224:227], v[36:39], v[28:31]
    ds_read_b64_tr_b16 v[62:63], v5 offset:55552
    s_lshl_b32 s45, s30, 14
    s_add_u32 s46, s35, s45
    s_add_u32 m0, s45, 77824
    s_add_u32 s46, s46, 12288
    buffer_load_dwordx4 v1, s[4:7], s46 offen sc1 lds
    s_waitcnt lgkmcnt(8)
    v_mfma_f32_16x16x32_bf16 v[16:19], a[100:103], v[40:43], v[16:19]
    ds_read_b64_tr_b16 v[32:33], v2 offset:57344
    v_mfma_f32_16x16x32_bf16 v[24:27], a[228:231], v[40:43], v[24:27]
    ds_read_b64_tr_b16 v[34:35], v2 offset:57600
    v_mfma_f32_16x16x32_bf16 v[20:23], a[100:103], v[44:47], v[20:23]
    ds_read_b64_tr_b16 v[36:37], v5 offset:57344
    v_mfma_f32_16x16x32_bf16 v[28:31], a[228:231], v[44:47], v[28:31]
    ds_read_b64_tr_b16 v[38:39], v5 offset:57600
    s_waitcnt lgkmcnt(8)
    v_mfma_f32_16x16x32_bf16 v[16:19], a[104:107], v[48:51], v[16:19]
    ds_read_b64_tr_b16 v[40:41], v2 offset:59392
    v_mfma_f32_16x16x32_bf16 v[24:27], a[232:235], v[48:51], v[24:27]
    ds_read_b64_tr_b16 v[42:43], v2 offset:59648
    v_mfma_f32_16x16x32_bf16 v[20:23], a[104:107], v[52:55], v[20:23]
    ds_read_b64_tr_b16 v[44:45], v5 offset:59392
    v_mfma_f32_16x16x32_bf16 v[28:31], a[232:235], v[52:55], v[28:31]
    ds_read_b64_tr_b16 v[46:47], v5 offset:59648
    s_lshl_b32 s45, s30, 14
    s_add_u32 s46, s35, s45
    s_add_u32 m0, s45, 78848
    s_add_u32 s46, s46, 13312
    buffer_load_dwordx4 v1, s[4:7], s46 offen sc1 lds
    s_waitcnt lgkmcnt(8)
    v_mfma_f32_16x16x32_bf16 v[16:19], a[108:111], v[56:59], v[16:19]
    ds_read_b64_tr_b16 v[48:49], v2 offset:61440
    v_mfma_f32_16x16x32_bf16 v[24:27], a[236:239], v[56:59], v[24:27]
    ds_read_b64_tr_b16 v[50:51], v2 offset:61696
    v_mfma_f32_16x16x32_bf16 v[20:23], a[108:111], v[60:63], v[20:23]
    ds_read_b64_tr_b16 v[52:53], v5 offset:61440
    v_mfma_f32_16x16x32_bf16 v[28:31], a[236:239], v[60:63], v[28:31]
    ds_read_b64_tr_b16 v[54:55], v5 offset:61696
    s_waitcnt lgkmcnt(8)
    v_mfma_f32_16x16x32_bf16 v[16:19], a[112:115], v[32:35], v[16:19]
    ds_read_b64_tr_b16 v[56:57], v2 offset:63488
    v_mfma_f32_16x16x32_bf16 v[24:27], a[240:243], v[32:35], v[24:27]
    ds_read_b64_tr_b16 v[58:59], v2 offset:63744
    v_mfma_f32_16x16x32_bf16 v[20:23], a[112:115], v[36:39], v[20:23]
    ds_read_b64_tr_b16 v[60:61], v5 offset:63488
    v_mfma_f32_16x16x32_bf16 v[28:31], a[240:243], v[36:39], v[28:31]
    ds_read_b64_tr_b16 v[62:63], v5 offset:63744
    s_lshl_b32 s45, s30, 14
    s_add_u32 s46, s35, s45
    s_add_u32 m0, s45, 79872
    s_add_u32 s46, s46, 14336
    buffer_load_dwordx4 v1, s[4:7], s46 offen sc1 lds
    s_waitcnt lgkmcnt(8)
    v_mfma_f32_16x16x32_bf16 v[16:19], a[116:119], v[40:43], v[16:19]
    v_mfma_f32_16x16x32_bf16 v[24:27], a[244:247], v[40:43], v[24:27]
    v_mfma_f32_16x16x32_bf16 v[20:23], a[116:119], v[44:47], v[20:23]
    v_mfma_f32_16x16x32_bf16 v[28:31], a[244:247], v[44:47], v[28:31]
    s_waitcnt lgkmcnt(4)
    v_mfma_f32_16x16x32_bf16 v[16:19], a[120:123], v[48:51], v[16:19]
    v_mfma_f32_16x16x32_bf16 v[24:27], a[248:251], v[48:51], v[24:27]
    v_mfma_f32_16x16x32_bf16 v[20:23], a[120:123], v[52:55], v[20:23]
    v_mfma_f32_16x16x32_bf16 v[28:31], a[248:251], v[52:55], v[28:31]
    s_lshl_b32 s45, s30, 14
    s_add_u32 s46, s35, s45
    s_add_u32 m0, s45, 80896
    s_add_u32 s46, s46, 15360
    buffer_load_dwordx4 v1, s[4:7], s46 offen sc1 lds
    s_waitcnt lgkmcnt(0)
    v_mfma_f32_16x16x32_bf16 v[16:19], a[124:127], v[56:59], v[16:19]
    v_mfma_f32_16x16x32_bf16 v[24:27], a[252:255], v[56:59], v[24:27]
    v_mfma_f32_16x16x32_bf16 v[20:23], a[124:127], v[60:63], v[20:23]
    v_mfma_f32_16x16x32_bf16 v[28:31], a[252:255], v[60:63], v[28:31]
    s_waitcnt vmcnt(16)
    s_add_u32 s47, s36, 65536
    v_lshlrev_b32 v80, 16, v64
    v_and_b32 v81, 0xffff0000, v64
    v_lshlrev_b32 v82, 16, v65
    v_and_b32 v83, 0xffff0000, v65
    v_mul_f32 v80, v80, v8
    v_mul_f32 v81, v81, v9
    v_mul_f32 v82, v82, v10
    v_mul_f32 v83, v83, v11
    v_cvt_pk_bf16_f32 v84, v80, v81
    v_cvt_pk_bf16_f32 v85, v82, v83
    v_lshlrev_b32 v80, 16, v84
    v_and_b32 v81, 0xffff0000, v84
    v_lshlrev_b32 v82, 16, v85
    v_and_b32 v83, 0xffff0000, v85
    v_add_f32 v16, v16, v80
    v_add_f32 v17, v17, v81
    v_add_f32 v18, v18, v82
    v_add_f32 v19, v19, v83
    buffer_store_dwordx4 v[16:19], v3, s[20:23], s36 offen offset:0 nt
    v_lshlrev_b32 v80, 16, v68
    v_and_b32 v81, 0xffff0000, v68
    v_lshlrev_b32 v82, 16, v69
    v_and_b32 v83, 0xffff0000, v69
    v_mul_f32 v80, v80, v12
    v_mul_f32 v81, v81, v13
    v_mul_f32 v82, v82, v14
    v_mul_f32 v83, v83, v15
    v_cvt_pk_bf16_f32 v84, v80, v81
    v_cvt_pk_bf16_f32 v85, v82, v83
    v_lshlrev_b32 v80, 16, v84
    v_and_b32 v81, 0xffff0000, v84
    v_lshlrev_b32 v82, 16, v85
    v_and_b32 v83, 0xffff0000, v85
    v_add_f32 v24, v24, v80
    v_add_f32 v25, v25, v81
    v_add_f32 v26, v26, v82
    v_add_f32 v27, v27, v83
    buffer_store_dwordx4 v[24:27], v3, s[20:23], s36 offen offset:64 nt
    v_lshlrev_b32 v80, 16, v66
    v_and_b32 v81, 0xffff0000, v66
    v_lshlrev_b32 v82, 16, v67
    v_and_b32 v83, 0xffff0000, v67
    v_mul_f32 v80, v80, v8
    v_mul_f32 v81, v81, v9
    v_mul_f32 v82, v82, v10
    v_mul_f32 v83, v83, v11
    v_cvt_pk_bf16_f32 v84, v80, v81
    v_cvt_pk_bf16_f32 v85, v82, v83
    v_lshlrev_b32 v80, 16, v84
    v_and_b32 v81, 0xffff0000, v84
    v_lshlrev_b32 v82, 16, v85
    v_and_b32 v83, 0xffff0000, v85
    v_add_f32 v20, v20, v80
    v_add_f32 v21, v21, v81
    v_add_f32 v22, v22, v82
    v_add_f32 v23, v23, v83
    buffer_store_dwordx4 v[20:23], v3, s[20:23], s47 offen offset:0 nt
    v_lshlrev_b32 v80, 16, v70
    v_and_b32 v81, 0xffff0000, v70
    v_lshlrev_b32 v82, 16, v71
    v_and_b32 v83, 0xffff0000, v71
    v_mul_f32 v80, v80, v12
    v_mul_f32 v81, v81, v13
    v_mul_f32 v82, v82, v14
    v_mul_f32 v83, v83, v15
    v_cvt_pk_bf16_f32 v84, v80, v81
    v_cvt_pk_bf16_f32 v85, v82, v83
    v_lshlrev_b32 v80, 16, v84
    v_and_b32 v81, 0xffff0000, v84
    v_lshlrev_b32 v82, 16, v85
    v_and_b32 v83, 0xffff0000, v85
    v_add_f32 v28, v28, v80
    v_add_f32 v29, v29, v81
    v_add_f32 v30, v30, v82
    v_add_f32 v31, v31, v83
    buffer_store_dwordx4 v[28:31], v3, s[20:23], s47 offen offset:64 nt
    s_cmp_ge_u32 s33, 64
    s_cbranch_scc1 S3L_fin
S3L_b1:
    s_lshl_b32 s36, s33, 17
    s_lshl_b32 s37, s33, 15
    s_add_u32 s33, s33, s34
    s_min_u32 s61, s33, 63
    s_lshr_b32 s61, s61, 1
    s_add_u32 s61, s61, 1
    s_mov_b32 s60, 1838976
    s_cmp_lg_u32 s30, 0
    s_cbranch_scc1 L_wb3
    v_lshlrev_b32 v254, 2, v0
    s_mov_b64 exec, 65535
    s_mov_b32 s62, 0
L_w3:
    buffer_load_dword v255, v254, s[4:7], s60 offen sc1
    s_add_u32 s62, s62, 1
    s_cmp_gt_u32 s62, 2000000
    s_cbranch_scc1 L_end
    s_waitcnt vmcnt(0)
    v_cmp_gt_u32 vcc, s61, v255
    s_nop 0
    s_cbranch_vccz L_wd3
    s_sleep 32
    s_branch L_w3
    s_nop 0
L_wd3:
    s_mov_b64 exec, -1
L_wb3:
    s_barrier
    s_lshl_b32 s35, s33, 16
    s_add_u32 s35, s35, 87031808
    s_waitcnt vmcnt(0)
    s_barrier
    s_add_u32 s47, s37, 16384
    buffer_load_dwordx2 v[64:65], v4, s[16:19], s37 offen offset:0
    buffer_load_dwordx2 v[68:69], v4, s[16:19], s37 offen offset:32
    buffer_load_dwordx2 v[66:67], v4, s[16:19], s47 offen offset:0
    buffer_load_dwordx2 v[70:71], v4, s[16:19], s47 offen offset:32
    ds_read_b64_tr_b16 v[32:33], v6 offset:0
    ds_read_b64_tr_b16 v[34:35], v6 offset:256
    ds_read_b64_tr_b16 v[36:37], v7 offset:0
    ds_read_b64_tr_b16 v[38:39], v7 offset:256
    ds_read_b64_tr_b16 v[40:41], v6 offset:2048
    ds_read_b64_tr_b16 v[42:43], v6 offset:2304
    ds_read_b64_tr_b16 v[44:45], v7 offset:2048
    ds_read_b64_tr_b16 v[46:47], v7 offset:2304
    ds_read_b64_tr_b16 v[48:49], v6 offset:4096
    ds_read_b64_tr_b16 v[50:51], v6 offset:4352
    ds_read_b64_tr_b16 v[52:53], v7 offset:4096
    ds_read_b64_tr_b16 v[54:55], v7 offset:4352
    s_waitcnt lgkmcnt(8)
    v_mfma_f32_16x16x32_bf16 v[16:19], a[0:3], v[32:35], 0
    ds_read_b64_tr_b16 v[56:57], v6 offset:6144
    v_mfma_f32_16x16x32_bf16 v[24:27], a[128:131], v[32:35], 0
    ds_read_b64_tr_b16 v[58:59], v6 offset:6400
    v_mfma_f32_16x16x32_bf16 v[20:23], a[0:3], v[36:39], 0
    ds_read_b64_tr_b16 v[60:61], v7 offset:6144
    v_mfma_f32_16x16x32_bf16 v[28:31], a[128:131], v[36:39], 0
    ds_read_b64_tr_b16 v[62:63], v7 offset:6400
    s_lshl_b32 s45, s30, 14
    s_add_u32 s46, s35, s45
    s_add_u32 m0, s45, 0
    s_add_u32 s46, s46, 0
    buffer_load_dwordx4 v1, s[4:7], s46 offen sc1 lds
    s_waitcnt lgkmcnt(8)
    v_mfma_f32_16x16x32_bf16 v[16:19], a[4:7], v[40:43], v[16:19]
    ds_read_b64_tr_b16 v[32:33], v6 offset:8192
    v_mfma_f32_16x16x32_bf16 v[24:27], a[132:135], v[40:43], v[24:27]
    ds_read_b64_tr_b16 v[34:35], v6 offset:8448
    v_mfma_f32_16x16x32_bf16 v[20:23], a[4:7], v[44:47], v[20:23]
    ds_read_b64_tr_b16 v[36:37], v7 offset:8192
    v_mfma_f32_16x16x32_bf16 v[28:31], a[132:135], v[44:47], v[28:31]
    ds_read_b64_tr_b16 v[38:39], v7 offset:8448
    s_waitcnt lgkmcnt(8)
    v_mfma_f32_16x16x32_bf16 v[16:19], a[8:11], v[48:51], v[16:19]
    ds_read_b64_tr_b16 v[40:41], v6 offset:10240
    v_mfma_f32_16x16x32_bf16 v[24:27], a[136:139], v[48:51], v[24:27]
    ds_read_b64_tr_b16 v[42:43], v6 offset:10496
    v_mfma_f32_16x16x32_bf16 v[20:23], a[8:11], v[52:55], v[20:23]
    ds_read_b64_tr_b16 v[44:45], v7 offset:10240
    v_mfma_f32_16x16x32_bf16 v[28:31], a[136:139], v[52:55], v[28:31]
    ds_read_b64_tr_b16 v[46:47], v7 offset:10496
    s_lshl_b32 s45, s30, 14
    s_add_u32 s46, s35, s45
    s_add_u32 m0, s45, 1024
    s_add_u32 s46, s46, 1024
    buffer_load_dwordx4 v1, s[4:7], s46 offen sc1 lds
    s_waitcnt lgkmcnt(8)
    v_mfma_f32_16x16x32_bf16 v[16:19], a[12:15], v[56:59], v[16:19]
    ds_read_b64_tr_b16 v[48:49], v6 offset:12288
    v_mfma_f32_16x16x32_bf16 v[24:27], a[140:143], v[56:59], v[24:27]
    ds_read_b64_tr_b16 v[50:51], v6 offset:12544
    v_mfma_f32_16x16x32_bf16 v[20:23], a[12:15], v[60:63], v[20:23]
    ds_read_b64_tr_b16 v[52:53], v7 offset:12288
    v_mfma_f32_16x16x32_bf16 v[28:31], a[140:143], v[60:63], v[28:31]
    ds_read_b64_tr_b16 v[54:55], v7 offset:12544
    s_waitcnt lgkmcnt(8)
    v_mfma_f32_16x16x32_bf16 v[16:19], a[16:19], v[32:35], v[16:19]
    ds_read_b64_tr_b16 v[56:57], v6 offset:14336
    v_mfma_f32_16x16x32_bf16 v[24:27], a[144:147], v[32:35], v[24:27]
    ds_read_b64_tr_b16 v[58:59], v6 offset:14592
    v_mfma_f32_16x16x32_bf16 v[20:23], a[16:19], v[36:39], v[20:23]
    ds_read_b64_tr_b16 v[60:61], v7 offset:14336
    v_mfma_f32_16x16x32_bf16 v[28:31], a[144:147], v[36:39], v[28:31]
    ds_read_b64_tr_b16 v[62:63], v7 offset:14592
    s_lshl_b32 s45, s30, 14
    s_add_u32 s46, s35, s45
    s_add_u32 m0, s45, 2048
    s_add_u32 s46, s46, 2048
    buffer_load_dwordx4 v1, s[4:7], s46 offen sc1 lds
    s_waitcnt lgkmcnt(8)
    v_mfma_f32_16x16x32_bf16 v[16:19], a[20:23], v[40:43], v[16:19]
    ds_read_b64_tr_b16 v[32:33], v6 offset:16384
    v_mfma_f32_16x16x32_bf16 v[24:27], a[148:151], v[40:43], v[24:27]
    ds_read_b64_tr_b16 v[34:35], v6 offset:16640
    v_mfma_f32_16x16x32_bf16 v[20:23], a[20:23], v[44:47], v[20:23]
    ds_read_b64_tr_b16 v[36:37], v7 offset:16384
    v_mfma_f32_16x16x32_bf16 v[28:31], a[148:151], v[44:47], v[28:31]
    ds_read_b64_tr_b16 v[38:39], v7 offset:16640
    s_waitcnt lgkmcnt(8)
    v_mfma_f32_16x16x32_bf16 v[16:19], a[24:27], v[48:51], v[16:19]
    ds_read_b64_tr_b16 v[40:41], v6 offset:18432
    v_mfma_f32_16x16x32_bf16 v[24:27], a[152:155], v[48:51], v[24:27]
    ds_read_b64_tr_b16 v[42:43], v6 offset:18688
    v_mfma_f32_16x16x32_bf16 v[20:23], a[24:27], v[52:55], v[20:23]
    ds_read_b64_tr_b16 v[44:45], v7 offset:18432
    v_mfma_f32_16x16x32_bf16 v[28:31], a[152:155], v[52:55], v[28:31]
    ds_read_b64_tr_b16 v[46:47], v7 offset:18688
    s_lshl_b32 s45, s30, 14
    s_add_u32 s46, s35, s45
    s_add_u32 m0, s45, 3072
    s_add_u32 s46, s46, 3072
    buffer_load_dwordx4 v1, s[4:7], s46 offen sc1 lds
    s_waitcnt lgkmcnt(8)
    v_mfma_f32_16x16x32_bf16 v[16:19], a[28:31], v[56:59], v[16:19]
    ds_read_b64_tr_b16 v[48:49], v6 offset:20480
    v_mfma_f32_16x16x32_bf16 v[24:27], a[156:159], v[56:59], v[24:27]
    ds_read_b64_tr_b16 v[50:51], v6 offset:20736
    v_mfma_f32_16x16x32_bf16 v[20:23], a[28:31], v[60:63], v[20:23]
    ds_read_b64_tr_b16 v[52:53], v7 offset:20480
    v_mfma_f32_16x16x32_bf16 v[28:31], a[156:159], v[60:63], v[28:31]
    ds_read_b64_tr_b16 v[54:55], v7 offset:20736
    s_waitcnt lgkmcnt(8)
    v_mfma_f32_16x16x32_bf16 v[16:19], a[32:35], v[32:35], v[16:19]
    ds_read_b64_tr_b16 v[56:57], v6 offset:22528
    v_mfma_f32_16x16x32_bf16 v[24:27], a[160:163], v[32:35], v[24:27]
    ds_read_b64_tr_b16 v[58:59], v6 offset:22784
    v_mfma_f32_16x16x32_bf16 v[20:23], a[32:35], v[36:39], v[20:23]
    ds_read_b64_tr_b16 v[60:61], v7 offset:22528
    v_mfma_f32_16x16x32_bf16 v[28:31], a[160:163], v[36:39], v[28:31]
    ds_read_b64_tr_b16 v[62:63], v7 offset:22784
    s_lshl_b32 s45, s30, 14
    s_add_u32 s46, s35, s45
    s_add_u32 m0, s45, 4096
    s_add_u32 s46, s46, 4096
    buffer_load_dwordx4 v1, s[4:7], s46 offen sc1 lds
    s_waitcnt lgkmcnt(8)
    v_mfma_f32_16x16x32_bf16 v[16:19], a[36:39], v[40:43], v[16:19]
    ds_read_b64_tr_b16 v[32:33], v6 offset:24576
    v_mfma_f32_16x16x32_bf16 v[24:27], a[164:167], v[40:43], v[24:27]
    ds_read_b64_tr_b16 v[34:35], v6 offset:24832
    v_mfma_f32_16x16x32_bf16 v[20:23], a[36:39], v[44:47], v[20:23]
    ds_read_b64_tr_b16 v[36:37], v7 offset:24576
    v_mfma_f32_16x16x32_bf16 v[28:31], a[164:167], v[44:47], v[28:31]
    ds_read_b64_tr_b16 v[38:39], v7 offset:24832
    s_waitcnt lgkmcnt(8)
    v_mfma_f32_16x16x32_bf16 v[16:19], a[40:43], v[48:51], v[16:19]
    ds_read_b64_tr_b16 v[40:41], v6 offset:26624
    v_mfma_f32_16x16x32_bf16 v[24:27], a[168:171], v[48:51], v[24:27]
    ds_read_b64_tr_b16 v[42:43], v6 offset:26880
    v_mfma_f32_16x16x32_bf16 v[20:23], a[40:43], v[52:55], v[20:23]
    ds_read_b64_tr_b16 v[44:45], v7 offset:26624
    v_mfma_f32_16x16x32_bf16 v[28:31], a[168:171], v[52:55], v[28:31]
    ds_read_b64_tr_b16 v[46:47], v7 offset:26880
    s_lshl_b32 s45, s30, 14
    s_add_u32 s46, s35, s45
    s_add_u32 m0, s45, 5120
    s_add_u32 s46, s46, 5120
    buffer_load_dwordx4 v1, s[4:7], s46 offen sc1 lds
    s_waitcnt lgkmcnt(8)
    v_mfma_f32_16x16x32_bf16 v[16:19], a[44:47], v[56:59], v[16:19]
    ds_read_b64_tr_b16 v[48:49], v6 offset:28672
    v_mfma_f32_16x16x32_bf16 v[24:27], a[172:175], v[56:59], v[24:27]
    ds_read_b64_tr_b16 v[50:51], v6 offset:28928
    v_mfma_f32_16x16x32_bf16 v[20:23], a[44:47], v[60:63], v[20:23]
    ds_read_b64_tr_b16 v[52:53], v7 offset:28672
    v_mfma_f32_16x16x32_bf16 v[28:31], a[172:175], v[60:63], v[28:31]
    ds_read_b64_tr_b16 v[54:55], v7 offset:28928
    s_waitcnt lgkmcnt(8)
    v_mfma_f32_16x16x32_bf16 v[16:19], a[48:51], v[32:35], v[16:19]
    ds_read_b64_tr_b16 v[56:57], v6 offset:30720
    v_mfma_f32_16x16x32_bf16 v[24:27], a[176:179], v[32:35], v[24:27]
    ds_read_b64_tr_b16 v[58:59], v6 offset:30976
    v_mfma_f32_16x16x32_bf16 v[20:23], a[48:51], v[36:39], v[20:23]
    ds_read_b64_tr_b16 v[60:61], v7 offset:30720
    v_mfma_f32_16x16x32_bf16 v[28:31], a[176:179], v[36:39], v[28:31]
    ds_read_b64_tr_b16 v[62:63], v7 offset:30976
    s_lshl_b32 s45, s30, 14
    s_add_u32 s46, s35, s45
    s_add_u32 m0, s45, 6144
    s_add_u32 s46, s46, 6144
    buffer_load_dwordx4 v1, s[4:7], s46 offen sc1 lds
    s_waitcnt lgkmcnt(8)
    v_mfma_f32_16x16x32_bf16 v[16:19], a[52:55], v[40:43], v[16:19]
    ds_read_b64_tr_b16 v[32:33], v6 offset:32768
    v_mfma_f32_16x16x32_bf16 v[24:27], a[180:183], v[40:43], v[24:27]
    ds_read_b64_tr_b16 v[34:35], v6 offset:33024
    v_mfma_f32_16x16x32_bf16 v[20:23], a[52:55], v[44:47], v[20:23]
    ds_read_b64_tr_b16 v[36:37], v7 offset:32768
    v_mfma_f32_16x16x32_bf16 v[28:31], a[180:183], v[44:47], v[28:31]
    ds_read_b64_tr_b16 v[38:39], v7 offset:33024
    s_waitcnt lgkmcnt(8)
    v_mfma_f32_16x16x32_bf16 v[16:19], a[56:59], v[48:51], v[16:19]
    ds_read_b64_tr_b16 v[40:41], v6 offset:34816
    v_mfma_f32_16x16x32_bf16 v[24:27], a[184:187], v[48:51], v[24:27]
    ds_read_b64_tr_b16 v[42:43], v6 offset:35072
    v_mfma_f32_16x16x32_bf16 v[20:23], a[56:59], v[52:55], v[20:23]
    ds_read_b64_tr_b16 v[44:45], v7 offset:34816
    v_mfma_f32_16x16x32_bf16 v[28:31], a[184:187], v[52:55], v[28:31]
    ds_read_b64_tr_b16 v[46:47], v7 offset:35072
    s_lshl_b32 s45, s30, 14
    s_add_u32 s46, s35, s45
    s_add_u32 m0, s45, 7168
    s_add_u32 s46, s46, 7168
    buffer_load_dwordx4 v1, s[4:7], s46 offen sc1 lds
    s_waitcnt lgkmcnt(8)
    v_mfma_f32_16x16x32_bf16 v[16:19], a[60:63], v[56:59], v[16:19]
    ds_read_b64_tr_b16 v[48:49], v6 offset:36864
    v_mfma_f32_16x16x32_bf16 v[24:27], a[188:191], v[56:59], v[24:27]
    ds_read_b64_tr_b16 v[50:51], v6 offset:37120
    v_mfma_f32_16x16x32_bf16 v[20:23], a[60:63], v[60:63], v[20:23]
    ds_read_b64_tr_b16 v[52:53], v7 offset:36864
    v_mfma_f32_16x16x32_bf16 v[28:31], a[188:191], v[60:63], v[28:31]
    ds_read_b64_tr_b16 v[54:55], v7 offset:37120
    s_waitcnt lgkmcnt(8)
    v_mfma_f32_16x16x32_bf16 v[16:19], a[64:67], v[32:35], v[16:19]
    ds_read_b64_tr_b16 v[56:57], v6 offset:38912
    v_mfma_f32_16x16x32_bf16 v[24:27], a[192:195], v[32:35], v[24:27]
    ds_read_b64_tr_b16 v[58:59], v6 offset:39168
    v_mfma_f32_16x16x32_bf16 v[20:23], a[64:67], v[36:39], v[20:23]
    ds_read_b64_tr_b16 v[60:61], v7 offset:38912
    v_mfma_f32_16x16x32_bf16 v[28:31], a[192:195], v[36:39], v[28:31]
    ds_read_b64_tr_b16 v[62:63], v7 offset:39168
    s_lshl_b32 s45, s30, 14
    s_add_u32 s46, s35, s45
    s_add_u32 m0, s45, 8192
    s_add_u32 s46, s46, 8192
    buffer_load_dwordx4 v1, s[4:7], s46 offen sc1 lds
    s_waitcnt lgkmcnt(8)
    v_mfma_f32_16x16x32_bf16 v[16:19], a[68:71], v[40:43], v[16:19]
    ds_read_b64_tr_b16 v[32:33], v6 offset:40960
    v_mfma_f32_16x16x32_bf16 v[24:27], a[196:199], v[40:43], v[24:27]
    ds_read_b64_tr_b16 v[34:35], v6 offset:41216
    v_mfma_f32_16x16x32_bf16 v[20:23], a[68:71], v[44:47], v[20:23]
    ds_read_b64_tr_b16 v[36:37], v7 offset:40960
    v_mfma_f32_16x16x32_bf16 v[28:31], a[196:199], v[44:47], v[28:31]
    ds_read_b64_tr_b16 v[38:39], v7 offset:41216
    s_waitcnt lgkmcnt(8)
    v_mfma_f32_16x16x32_bf16 v[16:19], a[72:75], v[48:51], v[16:19]
    ds_read_b64_tr_b16 v[40:41], v6 offset:43008
    v_mfma_f32_16x16x32_bf16 v[24:27], a[200:203], v[48:51], v[24:27]
    ds_read_b64_tr_b16 v[42:43], v6 offset:43264
    v_mfma_f32_16x16x32_bf16 v[20:23], a[72:75], v[52:55], v[20:23]
    ds_read_b64_tr_b16 v[44:45], v7 offset:43008
    v_mfma_f32_16x16x32_bf16 v[28:31], a[200:203], v[52:55], v[28:31]
    ds_read_b64_tr_b16 v[46:47], v7 offset:43264
    s_lshl_b32 s45, s30, 14
    s_add_u32 s46, s35, s45
    s_add_u32 m0, s45, 9216
    s_add_u32 s46, s46, 9216
    buffer_load_dwordx4 v1, s[4:7], s46 offen sc1 lds
    s_waitcnt lgkmcnt(8)
    v_mfma_f32_16x16x32_bf16 v[16:19], a[76:79], v[56:59], v[16:19]
    ds_read_b64_tr_b16 v[48:49], v6 offset:45056
    v_mfma_f32_16x16x32_bf16 v[24:27], a[204:207], v[56:59], v[24:27]
    ds_read_b64_tr_b16 v[50:51], v6 offset:45312
    v_mfma_f32_16x16x32_bf16 v[20:23], a[76:79], v[60:63], v[20:23]
    ds_read_b64_tr_b16 v[52:53], v7 offset:45056
    v_mfma_f32_16x16x32_bf16 v[28:31], a[204:207], v[60:63], v[28:31]
    ds_read_b64_tr_b16 v[54:55], v7 offset:45312
    s_waitcnt lgkmcnt(8)
    v_mfma_f32_16x16x32_bf16 v[16:19], a[80:83], v[32:35], v[16:19]
    ds_read_b64_tr_b16 v[56:57], v6 offset:47104
    v_mfma_f32_16x16x32_bf16 v[24:27], a[208:211], v[32:35], v[24:27]
    ds_read_b64_tr_b16 v[58:59], v6 offset:47360
    v_mfma_f32_16x16x32_bf16 v[20:23], a[80:83], v[36:39], v[20:23]
    ds_read_b64_tr_b16 v[60:61], v7 offset:47104
    v_mfma_f32_16x16x32_bf16 v[28:31], a[208:211], v[36:39], v[28:31]
    ds_read_b64_tr_b16 v[62:63], v7 offset:47360
    s_lshl_b32 s45, s30, 14
    s_add_u32 s46, s35, s45
    s_add_u32 m0, s45, 10240
    s_add_u32 s46, s46, 10240
    buffer_load_dwordx4 v1, s[4:7], s46 offen sc1 lds
    s_waitcnt lgkmcnt(8)
    v_mfma_f32_16x16x32_bf16 v[16:19], a[84:87], v[40:43], v[16:19]
    ds_read_b64_tr_b16 v[32:33], v6 offset:49152
    v_mfma_f32_16x16x32_bf16 v[24:27], a[212:215], v[40:43], v[24:27]
    ds_read_b64_tr_b16 v[34:35], v6 offset:49408
    v_mfma_f32_16x16x32_bf16 v[20:23], a[84:87], v[44:47], v[20:23]
    ds_read_b64_tr_b16 v[36:37], v7 offset:49152
    v_mfma_f32_16x16x32_bf16 v[28:31], a[212:215], v[44:47], v[28:31]
    ds_read_b64_tr_b16 v[38:39], v7 offset:49408
    s_waitcnt lgkmcnt(8)
    v_mfma_f32_16x16x32_bf16 v[16:19], a[88:91], v[48:51], v[16:19]
    ds_read_b64_tr_b16 v[40:41], v6 offset:51200
    v_mfma_f32_16x16x32_bf16 v[24:27], a[216:219], v[48:51], v[24:27]
    ds_read_b64_tr_b16 v[42:43], v6 offset:51456
    v_mfma_f32_16x16x32_bf16 v[20:23], a[88:91], v[52:55], v[20:23]
    ds_read_b64_tr_b16 v[44:45], v7 offset:51200
    v_mfma_f32_16x16x32_bf16 v[28:31], a[216:219], v[52:55], v[28:31]
    ds_read_b64_tr_b16 v[46:47], v7 offset:51456
    s_lshl_b32 s45, s30, 14
    s_add_u32 s46, s35, s45
    s_add_u32 m0, s45, 11264
    s_add_u32 s46, s46, 11264
    buffer_load_dwordx4 v1, s[4:7], s46 offen sc1 lds
    s_waitcnt lgkmcnt(8)
    v_mfma_f32_16x16x32_bf16 v[16:19], a[92:95], v[56:59], v[16:19]
    ds_read_b64_tr_b16 v[48:49], v6 offset:53248
    v_mfma_f32_16x16x32_bf16 v[24:27], a[220:223], v[56:59], v[24:27]
    ds_read_b64_tr_b16 v[50:51], v6 offset:53504
    v_mfma_f32_16x16x32_bf16 v[20:23], a[92:95], v[60:63], v[20:23]
    ds_read_b64_tr_b16 v[52:53], v7 offset:53248
    v_mfma_f32_16x16x32_bf16 v[28:31], a[220:223], v[60:63], v[28:31]
    ds_read_b64_tr_b16 v[54:55], v7 offset:53504
    s_waitcnt lgkmcnt(8)
    v_mfma_f32_16x16x32_bf16 v[16:19], a[96:99], v[32:35], v[16:19]
    ds_read_b64_tr_b16 v[56:57], v6 offset:55296
    v_mfma_f32_16x16x32_bf16 v[24:27], a[224:227], v[32:35], v[24:27]
    ds_read_b64_tr_b16 v[58:59], v6 offset:55552
    v_mfma_f32_16x16x32_bf16 v[20:23], a[96:99], v[36:39], v[20:23]
    ds_read_b64_tr_b16 v[60:61], v7 offset:55296
    v_mfma_f32_16x16x32_bf16 v[28:31], a[224:227], v[36:39], v[28:31]
    ds_read_b64_tr_b16 v[62:63], v7 offset:55552
    s_lshl_b32 s45, s30, 14
    s_add_u32 s46, s35, s45
    s_add_u32 m0, s45, 12288
    s_add_u32 s46, s46, 12288
    buffer_load_dwordx4 v1, s[4:7], s46 offen sc1 lds
    s_waitcnt lgkmcnt(8)
    v_mfma_f32_16x16x32_bf16 v[16:19], a[100:103], v[40:43], v[16:19]
    ds_read_b64_tr_b16 v[32:33], v6 offset:57344
    v_mfma_f32_16x16x32_bf16 v[24:27], a[228:231], v[40:43], v[24:27]
    ds_read_b64_tr_b16 v[34:35], v6 offset:57600
    v_mfma_f32_16x16x32_bf16 v[20:23], a[100:103], v[44:47], v[20:23]
    ds_read_b64_tr_b16 v[36:37], v7 offset:57344
    v_mfma_f32_16x16x32_bf16 v[28:31], a[228:231], v[44:47], v[28:31]
    ds_read_b64_tr_b16 v[38:39], v7 offset:57600
    s_waitcnt lgkmcnt(8)
    v_mfma_f32_16x16x32_bf16 v[16:19], a[104:107], v[48:51], v[16:19]
    ds_read_b64_tr_b16 v[40:41], v6 offset:59392
    v_mfma_f32_16x16x32_bf16 v[24:27], a[232:235], v[48:51], v[24:27]
    ds_read_b64_tr_b16 v[42:43], v6 offset:59648
    v_mfma_f32_16x16x32_bf16 v[20:23], a[104:107], v[52:55], v[20:23]
    ds_read_b64_tr_b16 v[44:45], v7 offset:59392
    v_mfma_f32_16x16x32_bf16 v[28:31], a[232:235], v[52:55], v[28:31]
    ds_read_b64_tr_b16 v[46:47], v7 offset:59648
    s_lshl_b32 s45, s30, 14
    s_add_u32 s46, s35, s45
    s_add_u32 m0, s45, 13312
    s_add_u32 s46, s46, 13312
    buffer_load_dwordx4 v1, s[4:7], s46 offen sc1 lds
    s_waitcnt lgkmcnt(8)
    v_mfma_f32_16x16x32_bf16 v[16:19], a[108:111], v[56:59], v[16:19]
    ds_read_b64_tr_b16 v[48:49], v6 offset:61440
    v_mfma_f32_16x16x32_bf16 v[24:27], a[236:239], v[56:59], v[24:27]
    ds_read_b64_tr_b16 v[50:51], v6 offset:61696
    v_mfma_f32_16x16x32_bf16 v[20:23], a[108:111], v[60:63], v[20:23]
    ds_read_b64_tr_b16 v[52:53], v7 offset:61440
    v_mfma_f32_16x16x32_bf16 v[28:31], a[236:239], v[60:63], v[28:31]
    ds_read_b64_tr_b16 v[54:55], v7 offset:61696
    s_waitcnt lgkmcnt(8)
    v_mfma_f32_16x16x32_bf16 v[16:19], a[112:115], v[32:35], v[16:19]
    ds_read_b64_tr_b16 v[56:57], v6 offset:63488
    v_mfma_f32_16x16x32_bf16 v[24:27], a[240:243], v[32:35], v[24:27]
    ds_read_b64_tr_b16 v[58:59], v6 offset:63744
    v_mfma_f32_16x16x32_bf16 v[20:23], a[112:115], v[36:39], v[20:23]
    ds_read_b64_tr_b16 v[60:61], v7 offset:63488
    v_mfma_f32_16x16x32_bf16 v[28:31], a[240:243], v[36:39], v[28:31]
    ds_read_b64_tr_b16 v[62:63], v7 offset:63744
    s_lshl_b32 s45, s30, 14
    s_add_u32 s46, s35, s45
    s_add_u32 m0, s45, 14336
    s_add_u32 s46, s46, 14336
    buffer_load_dwordx4 v1, s[4:7], s46 offen sc1 lds
    s_waitcnt lgkmcnt(8)
    v_mfma_f32_16x16x32_bf16 v[16:19], a[116:119], v[40:43], v[16:19]
    v_mfma_f32_16x16x32_bf16 v[24:27], a[244:247], v[40:43], v[24:27]
    v_mfma_f32_16x16x32_bf16 v[20:23], a[116:119], v[44:47], v[20:23]
    v_mfma_f32_16x16x32_bf16 v[28:31], a[244:247], v[44:47], v[28:31]
    s_waitcnt lgkmcnt(4)
    v_mfma_f32_16x16x32_bf16 v[16:19], a[120:123], v[48:51], v[16:19]
    v_mfma_f32_16x16x32_bf16 v[24:27], a[248:251], v[48:51], v[24:27]
    v_mfma_f32_16x16x32_bf16 v[20:23], a[120:123], v[52:55], v[20:23]
    v_mfma_f32_16x16x32_bf16 v[28:31], a[248:251], v[52:55], v[28:31]
    s_lshl_b32 s45, s30, 14
    s_add_u32 s46, s35, s45
    s_add_u32 m0, s45, 15360
    s_add_u32 s46, s46, 15360
    buffer_load_dwordx4 v1, s[4:7], s46 offen sc1 lds
    s_waitcnt lgkmcnt(0)
    v_mfma_f32_16x16x32_bf16 v[16:19], a[124:127], v[56:59], v[16:19]
    v_mfma_f32_16x16x32_bf16 v[24:27], a[252:255], v[56:59], v[24:27]
    v_mfma_f32_16x16x32_bf16 v[20:23], a[124:127], v[60:63], v[20:23]
    v_mfma_f32_16x16x32_bf16 v[28:31], a[252:255], v[60:63], v[28:31]
    s_waitcnt vmcnt(16)
    s_add_u32 s47, s36, 65536
    v_lshlrev_b32 v80, 16, v64
    v_and_b32 v81, 0xffff0000, v64
    v_lshlrev_b32 v82, 16, v65
    v_and_b32 v83, 0xffff0000, v65
    v_mul_f32 v80, v80, v8
    v_mul_f32 v81, v81, v9
    v_mul_f32 v82, v82, v10
    v_mul_f32 v83, v83, v11
    v_cvt_pk_bf16_f32 v84, v80, v81
    v_cvt_pk_bf16_f32 v85, v82, v83
    v_lshlrev_b32 v80, 16, v84
    v_and_b32 v81, 0xffff0000, v84
    v_lshlrev_b32 v82, 16, v85
    v_and_b32 v83, 0xffff0000, v85
    v_add_f32 v16, v16, v80
    v_add_f32 v17, v17, v81
    v_add_f32 v18, v18, v82
    v_add_f32 v19, v19, v83
    buffer_store_dwordx4 v[16:19], v3, s[20:23], s36 offen offset:0 nt
    v_lshlrev_b32 v80, 16, v68
    v_and_b32 v81, 0xffff0000, v68
    v_lshlrev_b32 v82, 16, v69
    v_and_b32 v83, 0xffff0000, v69
    v_mul_f32 v80, v80, v12
    v_mul_f32 v81, v81, v13
    v_mul_f32 v82, v82, v14
    v_mul_f32 v83, v83, v15
    v_cvt_pk_bf16_f32 v84, v80, v81
    v_cvt_pk_bf16_f32 v85, v82, v83
    v_lshlrev_b32 v80, 16, v84
    v_and_b32 v81, 0xffff0000, v84
    v_lshlrev_b32 v82, 16, v85
    v_and_b32 v83, 0xffff0000, v85
    v_add_f32 v24, v24, v80
    v_add_f32 v25, v25, v81
    v_add_f32 v26, v26, v82
    v_add_f32 v27, v27, v83
    buffer_store_dwordx4 v[24:27], v3, s[20:23], s36 offen offset:64 nt
    v_lshlrev_b32 v80, 16, v66
    v_and_b32 v81, 0xffff0000, v66
    v_lshlrev_b32 v82, 16, v67
    v_and_b32 v83, 0xffff0000, v67
    v_mul_f32 v80, v80, v8
    v_mul_f32 v81, v81, v9
    v_mul_f32 v82, v82, v10
    v_mul_f32 v83, v83, v11
    v_cvt_pk_bf16_f32 v84, v80, v81
    v_cvt_pk_bf16_f32 v85, v82, v83
    v_lshlrev_b32 v80, 16, v84
    v_and_b32 v81, 0xffff0000, v84
    v_lshlrev_b32 v82, 16, v85
    v_and_b32 v83, 0xffff0000, v85
    v_add_f32 v20, v20, v80
    v_add_f32 v21, v21, v81
    v_add_f32 v22, v22, v82
    v_add_f32 v23, v23, v83
    buffer_store_dwordx4 v[20:23], v3, s[20:23], s47 offen offset:0 nt
    v_lshlrev_b32 v80, 16, v70
    v_and_b32 v81, 0xffff0000, v70
    v_lshlrev_b32 v82, 16, v71
    v_and_b32 v83, 0xffff0000, v71
    v_mul_f32 v80, v80, v12
    v_mul_f32 v81, v81, v13
    v_mul_f32 v82, v82, v14
    v_mul_f32 v83, v83, v15
    v_cvt_pk_bf16_f32 v84, v80, v81
    v_cvt_pk_bf16_f32 v85, v82, v83
    v_lshlrev_b32 v80, 16, v84
    v_and_b32 v81, 0xffff0000, v84
    v_lshlrev_b32 v82, 16, v85
    v_and_b32 v83, 0xffff0000, v85
    v_add_f32 v28, v28, v80
    v_add_f32 v29, v29, v81
    v_add_f32 v30, v30, v82
    v_add_f32 v31, v31, v83
    buffer_store_dwordx4 v[28:31], v3, s[20:23], s47 offen offset:64 nt
    s_cmp_ge_u32 s33, 64
    s_cbranch_scc0 S3L_b0
S3L_fin:
    s_endpgm
L_s1:
    s_sub_u32 s32, s31, 160
    s_lshl_b32 s63, s32, 2
    s_add_u32 s63, s63, 1838976
    s_cmp_eq_u32 s30, 0
    s_cselect_b32 s63, s63, 268435456
    s_load_dwordx2 s[8:9], s[0:1], 0
    s_waitcnt lgkmcnt(0)
    s_mov_b32 s10, 2097152
    s_mov_b32 s11, 0x20000
    s_load_dwordx2 s[12:13], s[0:1], 24
    s_waitcnt lgkmcnt(0)
    s_mov_b32 s14, 524288
    s_mov_b32 s15, 0x20000
    s_load_dwordx2 s[16:17], s[0:1], 32
    s_waitcnt lgkmcnt(0)
    s_mov_b32 s18, 524288
    s_mov_b32 s19, 0x20000
    v_and_b32 v1, 15, v0
    v_lshrrev_b32 v2, 4, v0
    s_lshl_b32 s45, s32, 5
    s_lshl_b32 s46, s30, 3
    s_add_u32 s45, s45, s46
    v_and_b32 v3, 7, v0
    v_add_u32 v3, s45, v3
    v_lshlrev_b32 v4, 10, v3
    v_lshl_add_u32 v4, v2, 4, v4
    s_mov_b32 s58, 0x00ff00ff
    s_mov_b32 s59, 0x00ff00ff
    s_mov_b64 exec, s[58:59]
    buffer_load_dwordx4 a[0:3], v4, s[12:15], 0 offen offset:0
    buffer_load_dwordx4 a[4:7], v4, s[12:15], 0 offen offset:64
    buffer_load_dwordx4 a[8:11], v4, s[12:15], 0 offen offset:128
    buffer_load_dwordx4 a[12:15], v4, s[12:15], 0 offen offset:192
    buffer_load_dwordx4 a[16:19], v4, s[12:15], 0 offen offset:256
    buffer_load_dwordx4 a[20:23], v4, s[12:15], 0 offen offset:320
    buffer_load_dwordx4 a[24:27], v4, s[12:15], 0 offen offset:384
    buffer_load_dwordx4 a[28:31], v4, s[12:15], 0 offen offset:448
    buffer_load_dwordx4 a[32:35], v4, s[12:15], 0 offen offset:512
    buffer_load_dwordx4 a[36:39], v4, s[12:15], 0 offen offset:576
    buffer_load_dwordx4 a[40:43], v4, s[12:15], 0 offen offset:640
    buffer_load_dwordx4 a[44:47], v4, s[12:15], 0 offen offset:704
    buffer_load_dwordx4 a[48:51], v4, s[12:15], 0 offen offset:768
    buffer_load_dwordx4 a[52:55], v4, s[12:15], 0 offen offset:832
    buffer_load_dwordx4 a[56:59], v4, s[12:15], 0 offen offset:896
    buffer_load_dwordx4 a[60:63], v4, s[12:15], 0 offen offset:960
    s_not_b64 exec, exec
    buffer_load_dwordx4 a[0:3], v4, s[16:19], 0 offen offset:0
    buffer_load_dwordx4 a[4:7], v4, s[16:19], 0 offen offset:64
    buffer_load_dwordx4 a[8:11], v4, s[16:19], 0 offen offset:128
    buffer_load_dwordx4 a[12:15], v4, s[16:19], 0 offen offset:192
    buffer_load_dwordx4 a[16:19], v4, s[16:19], 0 offen offset:256
    buffer_load_dwordx4 a[20:23], v4, s[16:19], 0 offen offset:320
    buffer_load_dwordx4 a[24:27], v4, s[16:19], 0 offen offset:384
    buffer_load_dwordx4 a[28:31], v4, s[16:19], 0 offen offset:448
    buffer_load_dwordx4 a[32:35], v4, s[16:19], 0 offen offset:512
    buffer_load_dwordx4 a[36:39], v4, s[16:19], 0 offen offset:576
    buffer_load_dwordx4 a[40:43], v4, s[16:19], 0 offen offset:640
    buffer_load_dwordx4 a[44:47], v4, s[16:19], 0 offen offset:704
    buffer_load_dwordx4 a[48:51], v4, s[16:19], 0 offen offset:768
    buffer_load_dwordx4 a[52:55], v4, s[16:19], 0 offen offset:832
    buffer_load_dwordx4 a[56:59], v4, s[16:19], 0 offen offset:896
    buffer_load_dwordx4 a[60:63], v4, s[16:19], 0 offen offset:960
    s_mov_b64 exec, -1
    v_lshlrev_b32 v5, 1, v3
    s_load_dwordx2 s[20:21], s[0:1], 8
    s_waitcnt lgkmcnt(0)
    s_mov_b32 s22, 1024
    s_mov_b32 s23, 0x20000
    buffer_load_ushort v40, v5, s[20:23], 0 offen
    s_waitcnt vmcnt(0)
    s_load_dwordx2 s[20:21], s[0:1], 16
    s_waitcnt lgkmcnt(0)
    s_mov_b32 s22, 1024
    s_mov_b32 s23, 0x20000
    buffer_load_ushort v41, v5, s[20:23], 0 offen
    s_waitcnt vmcnt(0)
    s_load_dwordx2 s[20:21], s[0:1], 56
    s_waitcnt lgkmcnt(0)
    s_mov_b32 s22, 1024
    s_mov_b32 s23, 0x20000
    buffer_load_ushort v42, v5, s[20:23], 0 offen
    s_waitcnt vmcnt(0)
    v_lshlrev_b32 v40, 16, v40
    v_lshlrev_b32 v41, 16, v41
    v_lshlrev_b32 v42, 16, v42
    v_mul_f32 v42, 0x3fb8aa3b, v42
    v_exp_f32 v42, v42
    s_nop 0
    v_cvt_pk_bf16_f32 v42, v42, v42
    v_lshlrev_b32 v42, 16, v42
    v_mul_f32 v43, v42, v40
    v_mul_f32 v44, v42, v41
    v_mul_f32 v43, 0x3fb8aa3b, v43
    v_exp_f32 v43, v43
    v_mul_f32 v44, 0.15915494, v44
    v_fract_f32 v44, v44
    v_cos_f32 v45, v44
    v_sin_f32 v46, v44
    v_mul_f32 v29, v43, v45
    v_mul_f32 v30, v43, v46
    v_add_f32 v47, -1.0, v29
    v_mul_f32 v48, v40, v40
    v_fmac_f32 v48, v41, v41
    v_rcp_f32 v48, v48
    v_mul_f32 v49, v47, v40
    v_fmac_f32 v49, v30, v41
    v_mul_f32 v50, v30, v40
    v_fma_f32 v50, -v47, v41, v50
    v_add_f32 v48, v48, v48
    v_mul_f32 v33, v49, v48
    v_mul_f32 v34, -v50, v48
    v_mov_b32 v31, v29
    v_mov_b32 v32, v30
    v_mul_f32 v47, v32, v32
    v_mul_f32 v48, v31, v32
    v_fma_f32 v31, v31, v31, -v47
    v_add_f32 v32, v48, v48
    v_mul_f32 v47, v32, v32
    v_mul_f32 v48, v31, v32
    v_fma_f32 v31, v31, v31, -v47
    v_add_f32 v32, v48, v48
    v_mul_f32 v47, v32, v32
    v_mul_f32 v48, v31, v32
    v_fma_f32 v31, v31, v31, -v47
    v_add_f32 v32, v48, v48
    v_mul_f32 v47, v32, v32
    v_mul_f32 v48, v31, v32
    v_fma_f32 v31, v31, v31, -v47
    v_add_f32 v32, v48, v48
    s_mov_b64 exec, s[58:59]
    v_xor_b32 v30, 0x80000000, v30
    v_xor_b32 v32, 0x80000000, v32
    s_not_b64 exec, exec
    v_xor_b32 v33, 0x80000000, v33
    s_mov_b64 exec, -1
    v_mov_b32 v35, 0
    s_lshl_b32 s45, s30, 2
    s_add_u32 s45, s45, 0
    v_xor_b32 v47, s45, v0
    v_lshlrev_b32 v47, 4, v47
    s_lshl_b32 s45, s30, 14
    v_add_u32 v8, s45, v47
    s_lshl_b32 s45, s30, 2
    s_add_u32 s45, s45, 1
    v_xor_b32 v47, s45, v0
    v_lshlrev_b32 v47, 4, v47
    s_lshl_b32 s45, s30, 14
    v_add_u32 v9, s45, v47
    s_lshl_b32 s45, s30, 2
    s_add_u32 s45, s45, 2
    v_xor_b32 v47, s45, v0
    v_lshlrev_b32 v47, 4, v47
    s_lshl_b32 s45, s30, 14
    v_add_u32 v10, s45, v47
    s_lshl_b32 s45, s30, 2
    s_add_u32 s45, s45, 3
    v_xor_b32 v47, s45, v0
    v_lshlrev_b32 v47, 4, v47
    s_lshl_b32 s45, s30, 14
    v_add_u32 v11, s45, v47
    v_lshrrev_b32 v47, 2, v1
    v_lshlrev_b32 v47, 14, v47
    v_and_b32 v48, 3, v1
    v_lshl_add_u32 v47, v48, 10, v47
    v_add_u32 v48, 0, v2
    v_xor_b32 v48, v48, v1
    v_lshl_add_u32 v24, v48, 4, v47
    v_add_u32 v152, 65536, v24
    v_add_u32 v48, 4, v2
    v_xor_b32 v48, v48, v1
    v_lshl_add_u32 v25, v48, 4, v47
    v_add_u32 v153, 65536, v25
    v_add_u32 v48, 8, v2
    v_xor_b32 v48, v48, v1
    v_lshl_add_u32 v26, v48, 4, v47
    v_add_u32 v154, 65536, v26
    v_add_u32 v48, 12, v2
    v_xor_b32 v48, v48, v1
    v_lshl_add_u32 v27, v48, 4, v47
    v_add_u32 v155, 65536, v27
    v_bfe_u32 v48, v0, 3, 1
    v_lshl_add_u32 v49, v48, 9, v3
    v_lshrrev_b32 v47, 1, v2
    v_lshlrev_b32 v47, 4, v47
    v_lshl_add_u32 v47, v49, 6, v47
    v_bfe_u32 v48, v3, 3, 1
    v_xor_b32 v48, v48, v2
    v_and_b32 v48, 1, v48
    v_lshl_add_u32 v28, v48, 5, v47
    s_mov_b32 s34, 87031808
    s_mov_b32 s33, 0
    s_mov_b32 s35, 0
    v_cmp_eq_u32 s[52:53], 1, v2
    v_cmp_eq_u32 s[54:55], 2, v2
    v_cmp_eq_u32 s[56:57], 3, v2
    s_lshl_b32 s36, s30, 14
    s_barrier
    s_add_u32 m0, s36, 0
    s_add_u32 s46, s33, 0
    buffer_load_dwordx4 v8, s[8:11], s46 offen offset:0 lds
    buffer_load_dwordx4 v9, s[8:11], s46 offen offset:1024 lds
    buffer_load_dwordx4 v10, s[8:11], s46 offen offset:2048 lds
    buffer_load_dwordx4 v11, s[8:11], s46 offen offset:3072 lds
    s_add_u32 m0, s36, 4096
    s_add_u32 s46, s33, 4096
    buffer_load_dwordx4 v8, s[8:11], s46 offen offset:0 lds
    buffer_load_dwordx4 v9, s[8:11], s46 offen offset:1024 lds
    buffer_load_dwordx4 v10, s[8:11], s46 offen offset:2048 lds
    buffer_load_dwordx4 v11, s[8:11], s46 offen offset:3072 lds
    s_add_u32 m0, s36, 8192
    s_add_u32 s46, s33, 8192
    buffer_load_dwordx4 v8, s[8:11], s46 offen offset:0 lds
    buffer_load_dwordx4 v9, s[8:11], s46 offen offset:1024 lds
    buffer_load_dwordx4 v10, s[8:11], s46 offen offset:2048 lds
    buffer_load_dwordx4 v11, s[8:11], s46 offen offset:3072 lds
    s_add_u32 m0, s36, 12288
    s_add_u32 s46, s33, 12288
    buffer_load_dwordx4 v8, s[8:11], s46 offen offset:0 lds
    buffer_load_dwordx4 v9, s[8:11], s46 offen offset:1024 lds
    buffer_load_dwordx4 v10, s[8:11], s46 offen offset:2048 lds
    buffer_load_dwordx4 v11, s[8:11], s46 offen offset:3072 lds
    s_waitcnt vmcnt(0)
    s_barrier
    s_add_u32 s33, s33, 65536
    ds_read_b128 v[96:99], v24 offset:0
    ds_read_b128 v[100:103], v24 offset:4096
    ds_read_b128 v[104:107], v24 offset:8192
    ds_read_b128 v[108:111], v24 offset:12288
    ds_read_b128 v[112:115], v25 offset:0
    ds_read_b128 v[116:119], v25 offset:4096
    ds_read_b128 v[120:123], v25 offset:8192
    ds_read_b128 v[124:127], v25 offset:12288
    s_waitcnt lgkmcnt(4)
    v_mfma_f32_16x16x32_bf16 v[64:67], v[96:99], a[0:3], 0
    ds_read_b128 v[128:131], v26 offset:0
    s_add_u32 m0, s36, 65536
    s_add_u32 s46, s33, 0
    buffer_load_dwordx4 v8, s[8:11], s46 offen offset:0 lds
    v_mfma_f32_16x16x32_bf16 v[68:71], v[100:103], a[0:3], 0
    ds_read_b128 v[132:135], v26 offset:4096
    v_mfma_f32_16x16x32_bf16 v[72:75], v[104:107], a[0:3], 0
    ds_read_b128 v[136:139], v26 offset:8192
    buffer_load_dwordx4 v9, s[8:11], s46 offen offset:1024 lds
    v_mfma_f32_16x16x32_bf16 v[76:79], v[108:111], a[0:3], 0
    ds_read_b128 v[140:143], v26 offset:12288
    s_waitcnt lgkmcnt(4)
    v_mfma_f32_16x16x32_bf16 v[64:67], v[112:115], a[4:7], v[64:67]
    ds_read_b128 v[96:99], v27 offset:0
    buffer_load_dwordx4 v10, s[8:11], s46 offen offset:2048 lds
    v_mfma_f32_16x16x32_bf16 v[68:71], v[116:119], a[4:7], v[68:71]
    ds_read_b128 v[100:103], v27 offset:4096
    v_mfma_f32_16x16x32_bf16 v[72:75], v[120:123], a[4:7], v[72:75]
    ds_read_b128 v[104:107], v27 offset:8192
    buffer_load_dwordx4 v11, s[8:11], s46 offen offset:3072 lds
    v_mfma_f32_16x16x32_bf16 v[76:79], v[124:127], a[4:7], v[76:79]
    ds_read_b128 v[108:111], v27 offset:12288
    s_waitcnt lgkmcnt(4)
    v_mfma_f32_16x16x32_bf16 v[64:67], v[128:131], a[8:11], v[64:67]
    ds_read_b128 v[112:115], v24 offset:256
    s_add_u32 m0, s36, 69632
    s_add_u32 s46, s33, 4096
    buffer_load_dwordx4 v8, s[8:11], s46 offen offset:0 lds
    v_mfma_f32_16x16x32_bf16 v[68:71], v[132:135], a[8:11], v[68:71]
    ds_read_b128 v[116:119], v24 offset:4352
    v_mfma_f32_16x16x32_bf16 v[72:75], v[136:139], a[8:11], v[72:75]
    ds_read_b128 v[120:123], v24 offset:8448
    buffer_load_dwordx4 v9, s[8:11], s46 offen offset:1024 lds
    v_mfma_f32_16x16x32_bf16 v[76:79], v[140:143], a[8:11], v[76:79]
    ds_read_b128 v[124:127], v24 offset:12544
    s_waitcnt lgkmcnt(4)
    v_mfma_f32_16x16x32_bf16 v[64:67], v[96:99], a[12:15], v[64:67]
    ds_read_b128 v[128:131], v25 offset:256
    buffer_load_dwordx4 v10, s[8:11], s46 offen offset:2048 lds
    v_mfma_f32_16x16x32_bf16 v[68:71], v[100:103], a[12:15], v[68:71]
    ds_read_b128 v[132:135], v25 offset:4352
    v_mfma_f32_16x16x32_bf16 v[72:75], v[104:107], a[12:15], v[72:75]
    ds_read_b128 v[136:139], v25 offset:8448
    buffer_load_dwordx4 v11, s[8:11], s46 offen offset:3072 lds
    v_mfma_f32_16x16x32_bf16 v[76:79], v[108:111], a[12:15], v[76:79]
    ds_read_b128 v[140:143], v25 offset:12544
    s_waitcnt lgkmcnt(4)
    v_mfma_f32_16x16x32_bf16 v[64:67], v[112:115], a[16:19], v[64:67]
    ds_read_b128 v[96:99], v26 offset:256
    s_add_u32 m0, s36, 73728
    s_add_u32 s46, s33, 8192
    buffer_load_dwordx4 v8, s[8:11], s46 offen offset:0 lds
    v_mfma_f32_16x16x32_bf16 v[68:71], v[116:119], a[16:19], v[68:71]
    ds_read_b128 v[100:103], v26 offset:4352
    v_mfma_f32_16x16x32_bf16 v[72:75], v[120:123], a[16:19], v[72:75]
    ds_read_b128 v[104:107], v26 offset:8448
    buffer_load_dwordx4 v9, s[8:11], s46 offen offset:1024 lds
    v_mfma_f32_16x16x32_bf16 v[76:79], v[124:127], a[16:19], v[76:79]
    ds_read_b128 v[108:111], v26 offset:12544
    s_waitcnt lgkmcnt(4)
    v_mfma_f32_16x16x32_bf16 v[64:67], v[128:131], a[20:23], v[64:67]
    ds_read_b128 v[112:115], v27 offset:256
    buffer_load_dwordx4 v10, s[8:11], s46 offen offset:2048 lds
    v_mfma_f32_16x16x32_bf16 v[68:71], v[132:135], a[20:23], v[68:71]
    ds_read_b128 v[116:119], v27 offset:4352
    v_mfma_f32_16x16x32_bf16 v[72:75], v[136:139], a[20:23], v[72:75]
    ds_read_b128 v[120:123], v27 offset:8448
    buffer_load_dwordx4 v11, s[8:11], s46 offen offset:3072 lds
    v_mfma_f32_16x16x32_bf16 v[76:79], v[140:143], a[20:23], v[76:79]
    ds_read_b128 v[124:127], v27 offset:12544
    s_waitcnt lgkmcnt(4)
    v_mfma_f32_16x16x32_bf16 v[64:67], v[96:99], a[24:27], v[64:67]
    ds_read_b128 v[128:131], v24 offset:512
    s_add_u32 m0, s36, 77824
    s_add_u32 s46, s33, 12288
    buffer_load_dwordx4 v8, s[8:11], s46 offen offset:0 lds
    v_mfma_f32_16x16x32_bf16 v[68:71], v[100:103], a[24:27], v[68:71]
    ds_read_b128 v[132:135], v24 offset:4608
    v_mfma_f32_16x16x32_bf16 v[72:75], v[104:107], a[24:27], v[72:75]
    ds_read_b128 v[136:139], v24 offset:8704
    buffer_load_dwordx4 v9, s[8:11], s46 offen offset:1024 lds
    v_mfma_f32_16x16x32_bf16 v[76:79], v[108:111], a[24:27], v[76:79]
    ds_read_b128 v[140:143], v24 offset:12800
    s_waitcnt lgkmcnt(4)
    v_mfma_f32_16x16x32_bf16 v[64:67], v[112:115], a[28:31], v[64:67]
    ds_read_b128 v[96:99], v25 offset:512
    buffer_load_dwordx4 v10, s[8:11], s46 offen offset:2048 lds
    v_mfma_f32_16x16x32_bf16 v[68:71], v[116:119], a[28:31], v[68:71]
    ds_read_b128 v[100:103], v25 offset:4608
    v_mfma_f32_16x16x32_bf16 v[72:75], v[120:123], a[28:31], v[72:75]
    ds_read_b128 v[104:107], v25 offset:8704
    buffer_load_dwordx4 v11, s[8:11], s46 offen offset:3072 lds
    v_mfma_f32_16x16x32_bf16 v[76:79], v[124:127], a[28:31], v[76:79]
    ds_read_b128 v[108:111], v25 offset:12800
    s_waitcnt lgkmcnt(4)
    v_mfma_f32_16x16x32_bf16 v[64:67], v[128:131], a[32:35], v[64:67]
    ds_read_b128 v[112:115], v26 offset:512
    v_mfma_f32_16x16x32_bf16 v[68:71], v[132:135], a[32:35], v[68:71]
    ds_read_b128 v[116:119], v26 offset:4608
    v_mfma_f32_16x16x32_bf16 v[72:75], v[136:139], a[32:35], v[72:75]
    ds_read_b128 v[120:123], v26 offset:8704
    v_mfma_f32_16x16x32_bf16 v[76:79], v[140:143], a[32:35], v[76:79]
    ds_read_b128 v[124:127], v26 offset:12800
    s_waitcnt lgkmcnt(4)
    v_mfma_f32_16x16x32_bf16 v[64:67], v[96:99], a[36:39], v[64:67]
    ds_read_b128 v[128:131], v27 offset:512
    v_mfma_f32_16x16x32_bf16 v[68:71], v[100:103], a[36:39], v[68:71]
    ds_read_b128 v[132:135], v27 offset:4608
    v_mfma_f32_16x16x32_bf16 v[72:75], v[104:107], a[36:39], v[72:75]
    ds_read_b128 v[136:139], v27 offset:8704
    v_mfma_f32_16x16x32_bf16 v[76:79], v[108:111], a[36:39], v[76:79]
    ds_read_b128 v[140:143], v27 offset:12800
    s_waitcnt lgkmcnt(4)
    v_mfma_f32_16x16x32_bf16 v[64:67], v[112:115], a[40:43], v[64:67]
    ds_read_b128 v[96:99], v24 offset:768
    v_mfma_f32_16x16x32_bf16 v[68:71], v[116:119], a[40:43], v[68:71]
    ds_read_b128 v[100:103], v24 offset:4864
    v_mfma_f32_16x16x32_bf16 v[72:75], v[120:123], a[40:43], v[72:75]
    ds_read_b128 v[104:107], v24 offset:8960
    v_mfma_f32_16x16x32_bf16 v[76:79], v[124:127], a[40:43], v[76:79]
    ds_read_b128 v[108:111], v24 offset:13056
    s_waitcnt lgkmcnt(4)
    v_mfma_f32_16x16x32_bf16 v[64:67], v[128:131], a[44:47], v[64:67]
    ds_read_b128 v[112:115], v25 offset:768
    v_mfma_f32_16x16x32_bf16 v[68:71], v[132:135], a[44:47], v[68:71]
    ds_read_b128 v[116:119], v25 offset:4864
    v_mfma_f32_16x16x32_bf16 v[72:75], v[136:139], a[44:47], v[72:75]
    ds_read_b128 v[120:123], v25 offset:8960
    v_mfma_f32_16x16x32_bf16 v[76:79], v[140:143], a[44:47], v[76:79]
    ds_read_b128 v[124:127], v25 offset:13056
    s_waitcnt lgkmcnt(4)
    v_mfma_f32_16x16x32_bf16 v[64:67], v[96:99], a[48:51], v[64:67]
    ds_read_b128 v[128:131], v26 offset:768
    v_mfma_f32_16x16x32_bf16 v[68:71], v[100:103], a[48:51], v[68:71]
    ds_read_b128 v[132:135], v26 offset:4864
    v_mfma_f32_16x16x32_bf16 v[72:75], v[104:107], a[48:51], v[72:75]
    ds_read_b128 v[136:139], v26 offset:8960
    v_mfma_f32_16x16x32_bf16 v[76:79], v[108:111], a[48:51], v[76:79]
    ds_read_b128 v[140:143], v26 offset:13056
    s_waitcnt lgkmcnt(4)
    v_mfma_f32_16x16x32_bf16 v[64:67], v[112:115], a[52:55], v[64:67]
    ds_read_b128 v[96:99], v27 offset:768
    v_mfma_f32_16x16x32_bf16 v[68:71], v[116:119], a[52:55], v[68:71]
    ds_read_b128 v[100:103], v27 offset:4864
    v_mfma_f32_16x16x32_bf16 v[72:75], v[120:123], a[52:55], v[72:75]
    ds_read_b128 v[104:107], v27 offset:8960
    v_mfma_f32_16x16x32_bf16 v[76:79], v[124:127], a[52:55], v[76:79]
    ds_read_b128 v[108:111], v27 offset:13056
    s_waitcnt lgkmcnt(4)
    v_mfma_f32_16x16x32_bf16 v[64:67], v[128:131], a[56:59], v[64:67]
    v_mfma_f32_16x16x32_bf16 v[68:71], v[132:135], a[56:59], v[68:71]
    v_mfma_f32_16x16x32_bf16 v[72:75], v[136:139], a[56:59], v[72:75]
    v_mfma_f32_16x16x32_bf16 v[76:79], v[140:143], a[56:59], v[76:79]
    s_waitcnt lgkmcnt(0)
    v_mfma_f32_16x16x32_bf16 v[64:67], v[96:99], a[60:63], v[64:67]
    v_mfma_f32_16x16x32_bf16 v[68:71], v[100:103], a[60:63], v[68:71]
    v_mfma_f32_16x16x32_bf16 v[72:75], v[104:107], a[60:63], v[72:75]
    v_mfma_f32_16x16x32_bf16 v[76:79], v[108:111], a[60:63], v[76:79]
    s_waitcnt vmcnt(0)
    s_nop 6
S1L_b1:
    s_waitcnt vmcnt(2)
    s_barrier
    s_sub_u32 s48, s35, 1
    s_max_i32 s48, s48, 0
    v_mov_b32 v255, s48
    buffer_store_dword v255, off, s[4:7], s63 sc0 sc1
    s_add_u32 s33, s33, 65536
    ds_read_b128 v[96:99], v152 offset:0
    ds_read_b128 v[100:103], v152 offset:4096
    ds_read_b128 v[104:107], v152 offset:8192
    ds_read_b128 v[108:111], v152 offset:12288
    ds_read_b128 v[112:115], v153 offset:0
    ds_read_b128 v[116:119], v153 offset:4096
    ds_read_b128 v[120:123], v153 offset:8192
    ds_read_b128 v[124:127], v153 offset:12288
    s_waitcnt lgkmcnt(4)
    v_mfma_f32_16x16x32_bf16 v[80:83], v[96:99], a[0:3], 0
    ds_read_b128 v[128:131], v154 offset:0
    v_mov_b32 v40, v64
    v_fma_f32 v41, v40, v29, v65
    s_add_u32 m0, s36, 0
    s_add_u32 s46, s33, 0
    buffer_load_dwordx4 v8, s[8:11], s46 offen offset:0 lds
    v_mfma_f32_16x16x32_bf16 v[84:87], v[100:103], a[0:3], 0
    ds_read_b128 v[132:135], v154 offset:4096
    v_fmac_f32_dpp v41, v40, v30 row_ror:8 row_mask:0xf bank_mask:0xf
    v_fma_f32 v40, v41, v29, v66
    v_mfma_f32_16x16x32_bf16 v[88:91], v[104:107], a[0:3], 0
    ds_read_b128 v[136:139], v154 offset:8192
    v_fmac_f32_dpp v40, v41, v30 row_ror:8 row_mask:0xf bank_mask:0xf
    v_fma_f32 v41, v40, v29, v67
    buffer_load_dwordx4 v9, s[8:11], s46 offen offset:1024 lds
    v_mfma_f32_16x16x32_bf16 v[92:95], v[108:111], a[0:3], 0
    ds_read_b128 v[140:143], v154 offset:12288
    v_fmac_f32_dpp v41, v40, v30 row_ror:8 row_mask:0xf bank_mask:0xf
    v_fma_f32 v40, v41, v29, v68
    s_waitcnt lgkmcnt(4)
    v_mfma_f32_16x16x32_bf16 v[80:83], v[112:115], a[4:7], v[80:83]
    ds_read_b128 v[96:99], v155 offset:0
    v_fmac_f32_dpp v40, v41, v30 row_ror:8 row_mask:0xf bank_mask:0xf
    v_fma_f32 v41, v40, v29, v69
    buffer_load_dwordx4 v10, s[8:11], s46 offen offset:2048 lds
    v_mfma_f32_16x16x32_bf16 v[84:87], v[116:119], a[4:7], v[84:87]
    ds_read_b128 v[100:103], v155 offset:4096
    v_fmac_f32_dpp v41, v40, v30 row_ror:8 row_mask:0xf bank_mask:0xf
    v_fma_f32 v40, v41, v29, v70
    v_mfma_f32_16x16x32_bf16 v[88:91], v[120:123], a[4:7], v[88:91]
    ds_read_b128 v[104:107], v155 offset:8192
    v_fmac_f32_dpp v40, v41, v30 row_ror:8 row_mask:0xf bank_mask:0xf
    v_fma_f32 v41, v40, v29, v71
    buffer_load_dwordx4 v11, s[8:11], s46 offen offset:3072 lds
    v_mfma_f32_16x16x32_bf16 v[92:95], v[124:127], a[4:7], v[92:95]
    ds_read_b128 v[108:111], v155 offset:12288
    v_fmac_f32_dpp v41, v40, v30 row_ror:8 row_mask:0xf bank_mask:0xf
    v_fma_f32 v40, v41, v29, v72
    s_waitcnt lgkmcnt(4)
    v_mfma_f32_16x16x32_bf16 v[80:83], v[128:131], a[8:11], v[80:83]
    ds_read_b128 v[112:115], v152 offset:256
    v_fmac_f32_dpp v40, v41, v30 row_ror:8 row_mask:0xf bank_mask:0xf
    v_fma_f32 v41, v40, v29, v73
    s_add_u32 m0, s36, 4096
    s_add_u32 s46, s33, 4096
    buffer_load_dwordx4 v8, s[8:11], s46 offen offset:0 lds
    v_mfma_f32_16x16x32_bf16 v[84:87], v[132:135], a[8:11], v[84:87]
    ds_read_b128 v[116:119], v152 offset:4352
    v_fmac_f32_dpp v41, v40, v30 row_ror:8 row_mask:0xf bank_mask:0xf
    v_fma_f32 v40, v41, v29, v74
    v_mfma_f32_16x16x32_bf16 v[88:91], v[136:139], a[8:11], v[88:91]
    ds_read_b128 v[120:123], v152 offset:8448
    v_fmac_f32_dpp v40, v41, v30 row_ror:8 row_mask:0xf bank_mask:0xf
    v_fma_f32 v41, v40, v29, v75
    buffer_load_dwordx4 v9, s[8:11], s46 offen offset:1024 lds
    v_mfma_f32_16x16x32_bf16 v[92:95], v[140:143], a[8:11], v[92:95]
    ds_read_b128 v[124:127], v152 offset:12544
    v_fmac_f32_dpp v41, v40, v30 row_ror:8 row_mask:0xf bank_mask:0xf
    v_fma_f32 v40, v41, v29, v76
    s_waitcnt lgkmcnt(4)
    v_mfma_f32_16x16x32_bf16 v[80:83], v[96:99], a[12:15], v[80:83]
    ds_read_b128 v[128:131], v153 offset:256
    v_fmac_f32_dpp v40, v41, v30 row_ror:8 row_mask:0xf bank_mask:0xf
    v_fma_f32 v41, v40, v29, v77
    buffer_load_dwordx4 v10, s[8:11], s46 offen offset:2048 lds
    v_mfma_f32_16x16x32_bf16 v[84:87], v[100:103], a[12:15], v[84:87]
    ds_read_b128 v[132:135], v153 offset:4352
    v_fmac_f32_dpp v41, v40, v30 row_ror:8 row_mask:0xf bank_mask:0xf
    v_fma_f32 v40, v41, v29, v78
    v_mfma_f32_16x16x32_bf16 v[88:91], v[104:107], a[12:15], v[88:91]
    ds_read_b128 v[136:139], v153 offset:8448
    v_fmac_f32_dpp v40, v41, v30 row_ror:8 row_mask:0xf bank_mask:0xf
    v_fma_f32 v41, v40, v29, v79
    buffer_load_dwordx4 v11, s[8:11], s46 offen offset:3072 lds
    v_mfma_f32_16x16x32_bf16 v[92:95], v[108:111], a[12:15], v[92:95]
    ds_read_b128 v[140:143], v153 offset:12544
    v_fmac_f32_dpp v41, v40, v30 row_ror:8 row_mask:0xf bank_mask:0xf
    v_mov_b32 v44, v41
    s_waitcnt lgkmcnt(4)
    v_mfma_f32_16x16x32_bf16 v[80:83], v[112:115], a[16:19], v[80:83]
    ds_read_b128 v[96:99], v154 offset:256
    v_mov_b32 v46, v41
    s_nop 1
    v_permlane32_swap_b32 v44, v46
    s_add_u32 m0, s36, 8192
    s_add_u32 s46, s33, 8192
    buffer_load_dwordx4 v8, s[8:11], s46 offen offset:0 lds
    v_mfma_f32_16x16x32_bf16 v[84:87], v[116:119], a[16:19], v[84:87]
    ds_read_b128 v[100:103], v154 offset:4352
    v_mov_b32 v45, v44
    v_mov_b32 v47, v46
    v_mfma_f32_16x16x32_bf16 v[88:91], v[120:123], a[16:19], v[88:91]
    ds_read_b128 v[104:107], v154 offset:8448
    v_permlane16_swap_b32 v44, v45
    v_permlane16_swap_b32 v46, v47
    buffer_load_dwordx4 v9, s[8:11], s46 offen offset:1024 lds
    v_mfma_f32_16x16x32_bf16 v[92:95], v[124:127], a[16:19], v[92:95]
    ds_read_b128 v[108:111], v154 offset:12544
    v_mov_b32 v41, v35
    v_fmac_f32 v44, v35, v31
    s_waitcnt lgkmcnt(4)
    v_mfma_f32_16x16x32_bf16 v[80:83], v[128:131], a[20:23], v[80:83]
    ds_read_b128 v[112:115], v155 offset:256
    v_fmac_f32_dpp v44, v35, v32 row_ror:8 row_mask:0xf bank_mask:0xf
    v_cndmask_b32 v41, v41, v44, s[52:53]
    buffer_load_dwordx4 v10, s[8:11], s46 offen offset:2048 lds
    v_mfma_f32_16x16x32_bf16 v[84:87], v[132:135], a[20:23], v[84:87]
    ds_read_b128 v[116:119], v155 offset:4352
    v_fmac_f32 v45, v44, v31
    s_nop 1
    v_fmac_f32_dpp v45, v44, v32 row_ror:8 row_mask:0xf bank_mask:0xf
    v_mfma_f32_16x16x32_bf16 v[88:91], v[136:139], a[20:23], v[88:91]
    ds_read_b128 v[120:123], v155 offset:8448
    v_cndmask_b32 v41, v41, v45, s[54:55]
    v_fmac_f32 v46, v45, v31
    buffer_load_dwordx4 v11, s[8:11], s46 offen offset:3072 lds
    v_mfma_f32_16x16x32_bf16 v[92:95], v[140:143], a[20:23], v[92:95]
    ds_read_b128 v[124:127], v155 offset:12544
    v_fmac_f32_dpp v46, v45, v32 row_ror:8 row_mask:0xf bank_mask:0xf
    v_cndmask_b32 v41, v41, v46, s[56:57]
    s_waitcnt lgkmcnt(4)
    v_mfma_f32_16x16x32_bf16 v[80:83], v[96:99], a[24:27], v[80:83]
    ds_read_b128 v[128:131], v152 offset:512
    v_fmac_f32 v47, v46, v31
    s_nop 1
    v_fmac_f32_dpp v47, v46, v32 row_ror:8 row_mask:0xf bank_mask:0xf
    s_add_u32 m0, s36, 12288
    s_add_u32 s46, s33, 12288
    buffer_load_dwordx4 v8, s[8:11], s46 offen offset:0 lds
    v_mfma_f32_16x16x32_bf16 v[84:87], v[100:103], a[24:27], v[84:87]
    ds_read_b128 v[132:135], v152 offset:4608
    v_mov_b32 v35, v47
    v_fma_f32 v40, v41, v29, v64
    v_mfma_f32_16x16x32_bf16 v[88:91], v[104:107], a[24:27], v[88:91]
    ds_read_b128 v[136:139], v152 offset:8704
    v_fmac_f32_dpp v40, v41, v30 row_ror:8 row_mask:0xf bank_mask:0xf
    v_mul_f32 v64, v40, v33
    buffer_load_dwordx4 v9, s[8:11], s46 offen offset:1024 lds
    v_mfma_f32_16x16x32_bf16 v[92:95], v[108:111], a[24:27], v[92:95]
    ds_read_b128 v[140:143], v152 offset:12800
    v_fma_f32 v41, v40, v29, v65
    s_nop 1
    v_fmac_f32_dpp v41, v40, v30 row_ror:8 row_mask:0xf bank_mask:0xf
    s_waitcnt lgkmcnt(4)
    v_mfma_f32_16x16x32_bf16 v[80:83], v[112:115], a[28:31], v[80:83]
    ds_read_b128 v[96:99], v153 offset:512
    v_fmac_f32_dpp v64, v40, v34 row_ror:8 row_mask:0xf bank_mask:0xf
    v_mul_f32 v65, v41, v33
    buffer_load_dwordx4 v10, s[8:11], s46 offen offset:2048 lds
    v_mfma_f32_16x16x32_bf16 v[84:87], v[116:119], a[28:31], v[84:87]
    ds_read_b128 v[100:103], v153 offset:4608
    v_fma_f32 v40, v41, v29, v66
    s_nop 1
    v_fmac_f32_dpp v40, v41, v30 row_ror:8 row_mask:0xf bank_mask:0xf
    v_mfma_f32_16x16x32_bf16 v[88:91], v[120:123], a[28:31], v[88:91]
    ds_read_b128 v[104:107], v153 offset:8704
    v_fmac_f32_dpp v65, v41, v34 row_ror:8 row_mask:0xf bank_mask:0xf
    v_cvt_pk_bf16_f32 v144, v64, v65
    buffer_load_dwordx4 v11, s[8:11], s46 offen offset:3072 lds
    v_mfma_f32_16x16x32_bf16 v[92:95], v[124:127], a[28:31], v[92:95]
    ds_read_b128 v[108:111], v153 offset:12800
    v_mul_f32 v66, v40, v33
    v_fma_f32 v41, v40, v29, v67
    s_waitcnt lgkmcnt(4)
    v_mfma_f32_16x16x32_bf16 v[80:83], v[128:131], a[32:35], v[80:83]
    ds_read_b128 v[112:115], v154 offset:512
    v_fmac_f32_dpp v41, v40, v30 row_ror:8 row_mask:0xf bank_mask:0xf
    v_fmac_f32_dpp v66, v40, v34 row_ror:8 row_mask:0xf bank_mask:0xf
    v_mfma_f32_16x16x32_bf16 v[84:87], v[132:135], a[32:35], v[84:87]
    ds_read_b128 v[116:119], v154 offset:4608
    v_mul_f32 v67, v41, v33
    v_fma_f32 v40, v41, v29, v68
    v_mfma_f32_16x16x32_bf16 v[88:91], v[136:139], a[32:35], v[88:91]
    ds_read_b128 v[120:123], v154 offset:8704
    v_fmac_f32_dpp v40, v41, v30 row_ror:8 row_mask:0xf bank_mask:0xf
    v_fmac_f32_dpp v67, v41, v34 row_ror:8 row_mask:0xf bank_mask:0xf
    v_mfma_f32_16x16x32_bf16 v[92:95], v[140:143], a[32:35], v[92:95]
    ds_read_b128 v[124:127], v154 offset:12800
    v_cvt_pk_bf16_f32 v145, v66, v67
    v_mul_f32 v68, v40, v33
    s_waitcnt lgkmcnt(4)
    v_mfma_f32_16x16x32_bf16 v[80:83], v[96:99], a[36:39], v[80:83]
    ds_read_b128 v[128:131], v155 offset:512
    v_fma_f32 v41, v40, v29, v69
    s_nop 1
    v_fmac_f32_dpp v41, v40, v30 row_ror:8 row_mask:0xf bank_mask:0xf
    v_mfma_f32_16x16x32_bf16 v[84:87], v[100:103], a[36:39], v[84:87]
    ds_read_b128 v[132:135], v155 offset:4608
    v_fmac_f32_dpp v68, v40, v34 row_ror:8 row_mask:0xf bank_mask:0xf
    v_mul_f32 v69, v41, v33
    v_mfma_f32_16x16x32_bf16 v[88:91], v[104:107], a[36:39], v[88:91]
    ds_read_b128 v[136:139], v155 offset:8704
    v_fma_f32 v40, v41, v29, v70
    s_nop 1
    v_fmac_f32_dpp v40, v41, v30 row_ror:8 row_mask:0xf bank_mask:0xf
    v_mfma_f32_16x16x32_bf16 v[92:95], v[108:111], a[36:39], v[92:95]
    ds_read_b128 v[140:143], v155 offset:12800
    v_fmac_f32_dpp v69, v41, v34 row_ror:8 row_mask:0xf bank_mask:0xf
    v_cvt_pk_bf16_f32 v146, v68, v69
    s_waitcnt lgkmcnt(4)
    v_mfma_f32_16x16x32_bf16 v[80:83], v[112:115], a[40:43], v[80:83]
    ds_read_b128 v[96:99], v152 offset:768
    v_mul_f32 v70, v40, v33
    v_fma_f32 v41, v40, v29, v71
    v_mfma_f32_16x16x32_bf16 v[84:87], v[116:119], a[40:43], v[84:87]
    ds_read_b128 v[100:103], v152 offset:4864
    v_fmac_f32_dpp v41, v40, v30 row_ror:8 row_mask:0xf bank_mask:0xf
    v_fmac_f32_dpp v70, v40, v34 row_ror:8 row_mask:0xf bank_mask:0xf
    v_mfma_f32_16x16x32_bf16 v[88:91], v[120:123], a[40:43], v[88:91]
    ds_read_b128 v[104:107], v152 offset:8960
    v_mul_f32 v71, v41, v33
    v_fma_f32 v40, v41, v29, v72
    v_mfma_f32_16x16x32_bf16 v[92:95], v[124:127], a[40:43], v[92:95]
    ds_read_b128 v[108:111], v152 offset:13056
    v_fmac_f32_dpp v40, v41, v30 row_ror:8 row_mask:0xf bank_mask:0xf
    v_fmac_f32_dpp v71, v41, v34 row_ror:8 row_mask:0xf bank_mask:0xf
    s_waitcnt lgkmcnt(4)
    v_mfma_f32_16x16x32_bf16 v[80:83], v[128:131], a[44:47], v[80:83]
    ds_read_b128 v[112:115], v153 offset:768
    v_cvt_pk_bf16_f32 v147, v70, v71
    v_mul_f32 v72, v40, v33
    v_mfma_f32_16x16x32_bf16 v[84:87], v[132:135], a[44:47], v[84:87]
    ds_read_b128 v[116:119], v153 offset:4864
    v_fma_f32 v41, v40, v29, v73
    s_nop 1
    v_fmac_f32_dpp v41, v40, v30 row_ror:8 row_mask:0xf bank_mask:0xf
    v_mfma_f32_16x16x32_bf16 v[88:91], v[136:139], a[44:47], v[88:91]
    ds_read_b128 v[120:123], v153 offset:8960
    v_fmac_f32_dpp v72, v40, v34 row_ror:8 row_mask:0xf bank_mask:0xf
    v_mul_f32 v73, v41, v33
    v_mfma_f32_16x16x32_bf16 v[92:95], v[140:143], a[44:47], v[92:95]
    ds_read_b128 v[124:127], v153 offset:13056
    v_fma_f32 v40, v41, v29, v74
    s_nop 1
    v_fmac_f32_dpp v40, v41, v30 row_ror:8 row_mask:0xf bank_mask:0xf
    s_waitcnt lgkmcnt(4)
    v_mfma_f32_16x16x32_bf16 v[80:83], v[96:99], a[48:51], v[80:83]
    ds_read_b128 v[128:131], v154 offset:768
    v_fmac_f32_dpp v73, v41, v34 row_ror:8 row_mask:0xf bank_mask:0xf
    v_cvt_pk_bf16_f32 v148, v72, v73
    v_mfma_f32_16x16x32_bf16 v[84:87], v[100:103], a[48:51], v[84:87]
    ds_read_b128 v[132:135], v154 offset:4864
    v_mul_f32 v74, v40, v33
    v_fma_f32 v41, v40, v29, v75
    v_mfma_f32_16x16x32_bf16 v[88:91], v[104:107], a[48:51], v[88:91]
    ds_read_b128 v[136:139], v154 offset:8960
    v_fmac_f32_dpp v41, v40, v30 row_ror:8 row_mask:0xf bank_mask:0xf
    v_fmac_f32_dpp v74, v40, v34 row_ror:8 row_mask:0xf bank_mask:0xf
    v_mfma_f32_16x16x32_bf16 v[92:95], v[108:111], a[48:51], v[92:95]
    ds_read_b128 v[140:143], v154 offset:13056
    v_mul_f32 v75, v41, v33
    v_fma_f32 v40, v41, v29, v76
    s_waitcnt lgkmcnt(4)
    v_mfma_f32_16x16x32_bf16 v[80:83], v[112:115], a[52:55], v[80:83]
    ds_read_b128 v[96:99], v155 offset:768
    v_fmac_f32_dpp v40, v41, v30 row_ror:8 row_mask:0xf bank_mask:0xf
    v_fmac_f32_dpp v75, v41, v34 row_ror:8 row_mask:0xf bank_mask:0xf
    v_mfma_f32_16x16x32_bf16 v[84:87], v[116:119], a[52:55], v[84:87]
    ds_read_b128 v[100:103], v155 offset:4864
    v_cvt_pk_bf16_f32 v149, v74, v75
    v_mul_f32 v76, v40, v33
    v_mfma_f32_16x16x32_bf16 v[88:91], v[120:123], a[52:55], v[88:91]
    ds_read_b128 v[104:107], v155 offset:8960
    v_fma_f32 v41, v40, v29, v77
    s_nop 1
    v_fmac_f32_dpp v41, v40, v30 row_ror:8 row_mask:0xf bank_mask:0xf
    v_mfma_f32_16x16x32_bf16 v[92:95], v[124:127], a[52:55], v[92:95]
    ds_read_b128 v[108:111], v155 offset:13056
    v_fmac_f32_dpp v76, v40, v34 row_ror:8 row_mask:0xf bank_mask:0xf
    v_mul_f32 v77, v41, v33
    s_waitcnt lgkmcnt(4)
    v_mfma_f32_16x16x32_bf16 v[80:83], v[128:131], a[56:59], v[80:83]
    v_fma_f32 v40, v41, v29, v78
    s_nop 1
    v_fmac_f32_dpp v40, v41, v30 row_ror:8 row_mask:0xf bank_mask:0xf
    v_mfma_f32_16x16x32_bf16 v[84:87], v[132:135], a[56:59], v[84:87]
    v_fmac_f32_dpp v77, v41, v34 row_ror:8 row_mask:0xf bank_mask:0xf
    v_cvt_pk_bf16_f32 v150, v76, v77
    v_mfma_f32_16x16x32_bf16 v[88:91], v[136:139], a[56:59], v[88:91]
    v_mul_f32 v78, v40, v33
    v_fma_f32 v41, v40, v29, v79
    v_mfma_f32_16x16x32_bf16 v[92:95], v[140:143], a[56:59], v[92:95]
    s_nop 0
    v_fmac_f32_dpp v41, v40, v30 row_ror:8 row_mask:0xf bank_mask:0xf
    v_fmac_f32_dpp v78, v40, v34 row_ror:8 row_mask:0xf bank_mask:0xf
    s_waitcnt lgkmcnt(0)
    v_mfma_f32_16x16x32_bf16 v[80:83], v[96:99], a[60:63], v[80:83]
    v_mul_f32 v79, v41, v33
    s_nop 1
    v_fmac_f32_dpp v79, v41, v34 row_ror:8 row_mask:0xf bank_mask:0xf
    v_mfma_f32_16x16x32_bf16 v[84:87], v[100:103], a[60:63], v[84:87]
    v_cvt_pk_bf16_f32 v151, v78, v79
    v_permlane32_swap_b32 v144, v148
    v_mfma_f32_16x16x32_bf16 v[88:91], v[104:107], a[60:63], v[88:91]
    v_permlane32_swap_b32 v145, v149
    v_permlane32_swap_b32 v146, v150
    v_mfma_f32_16x16x32_bf16 v[92:95], v[108:111], a[60:63], v[92:95]
    v_permlane32_swap_b32 v147, v151
    buffer_store_dwordx4 v[144:147], v28, s[4:7], s34 offen sc0 sc1
    s_add_u32 s34, s34, 65536
    buffer_store_dwordx4 v[148:151], v28, s[4:7], s34 offen sc0 sc1
    s_add_u32 s34, s34, 65536
    s_add_u32 s35, s35, 1
    s_cmp_eq_u32 s35, 31
    s_cbranch_scc1 S1L_last
S1L_b0:
    s_waitcnt vmcnt(2)
    s_barrier
    s_sub_u32 s48, s35, 1
    s_max_i32 s48, s48, 0
    v_mov_b32 v255, s48
    buffer_store_dword v255, off, s[4:7], s63 sc0 sc1
    s_add_u32 s33, s33, 65536
    ds_read_b128 v[96:99], v24 offset:0
    ds_read_b128 v[100:103], v24 offset:4096
    ds_read_b128 v[104:107], v24 offset:8192
    ds_read_b128 v[108:111], v24 offset:12288
    ds_read_b128 v[112:115], v25 offset:0
    ds_read_b128 v[116:119], v25 offset:4096
    ds_read_b128 v[120:123], v25 offset:8192
    ds_read_b128 v[124:127], v25 offset:12288
    s_waitcnt lgkmcnt(4)
    v_mfma_f32_16x16x32_bf16 v[64:67], v[96:99], a[0:3], 0
    ds_read_b128 v[128:131], v26 offset:0
    v_mov_b32 v40, v80
    v_fma_f32 v41, v40, v29, v81
    s_add_u32 m0, s36, 65536
    s_add_u32 s46, s33, 0
    buffer_load_dwordx4 v8, s[8:11], s46 offen offset:0 lds
    v_mfma_f32_16x16x32_bf16 v[68:71], v[100:103], a[0:3], 0
    ds_read_b128 v[132:135], v26 offset:4096
    v_fmac_f32_dpp v41, v40, v30 row_ror:8 row_mask:0xf bank_mask:0xf
    v_fma_f32 v40, v41, v29, v82
    v_mfma_f32_16x16x32_bf16 v[72:75], v[104:107], a[0:3], 0
    ds_read_b128 v[136:139], v26 offset:8192
    v_fmac_f32_dpp v40, v41, v30 row_ror:8 row_mask:0xf bank_mask:0xf
    v_fma_f32 v41, v40, v29, v83
    buffer_load_dwordx4 v9, s[8:11], s46 offen offset:1024 lds
    v_mfma_f32_16x16x32_bf16 v[76:79], v[108:111], a[0:3], 0
    ds_read_b128 v[140:143], v26 offset:12288
    v_fmac_f32_dpp v41, v40, v30 row_ror:8 row_mask:0xf bank_mask:0xf
    v_fma_f32 v40, v41, v29, v84
    s_waitcnt lgkmcnt(4)
    v_mfma_f32_16x16x32_bf16 v[64:67], v[112:115], a[4:7], v[64:67]
    ds_read_b128 v[96:99], v27 offset:0
    v_fmac_f32_dpp v40, v41, v30 row_ror:8 row_mask:0xf bank_mask:0xf
    v_fma_f32 v41, v40, v29, v85
    buffer_load_dwordx4 v10, s[8:11], s46 offen offset:2048 lds
    v_mfma_f32_16x16x32_bf16 v[68:71], v[116:119], a[4:7], v[68:71]
    ds_read_b128 v[100:103], v27 offset:4096
    v_fmac_f32_dpp v41, v40, v30 row_ror:8 row_mask:0xf bank_mask:0xf
    v_fma_f32 v40, v41, v29, v86
    v_mfma_f32_16x16x32_bf16 v[72:75], v[120:123], a[4:7], v[72:75]
    ds_read_b128 v[104:107], v27 offset:8192
    v_fmac_f32_dpp v40, v41, v30 row_ror:8 row_mask:0xf bank_mask:0xf
    v_fma_f32 v41, v40, v29, v87
    buffer_load_dwordx4 v11, s[8:11], s46 offen offset:3072 lds
    v_mfma_f32_16x16x32_bf16 v[76:79], v[124:127], a[4:7], v[76:79]
    ds_read_b128 v[108:111], v27 offset:12288
    v_fmac_f32_dpp v41, v40, v30 row_ror:8 row_mask:0xf bank_mask:0xf
    v_fma_f32 v40, v41, v29, v88
    s_waitcnt lgkmcnt(4)
    v_mfma_f32_16x16x32_bf16 v[64:67], v[128:131], a[8:11], v[64:67]
    ds_read_b128 v[112:115], v24 offset:256
    v_fmac_f32_dpp v40, v41, v30 row_ror:8 row_mask:0xf bank_mask:0xf
    v_fma_f32 v41, v40, v29, v89
    s_add_u32 m0, s36, 69632
    s_add_u32 s46, s33, 4096
    buffer_load_dwordx4 v8, s[8:11], s46 offen offset:0 lds
    v_mfma_f32_16x16x32_bf16 v[68:71], v[132:135], a[8:11], v[68:71]
    ds_read_b128 v[116:119], v24 offset:4352
    v_fmac_f32_dpp v41, v40, v30 row_ror:8 row_mask:0xf bank_mask:0xf
    v_fma_f32 v40, v41, v29, v90
    v_mfma_f32_16x16x32_bf16 v[72:75], v[136:139], a[8:11], v[72:75]
    ds_read_b128 v[120:123], v24 offset:8448
    v_fmac_f32_dpp v40, v41, v30 row_ror:8 row_mask:0xf bank_mask:0xf
    v_fma_f32 v41, v40, v29, v91
    buffer_load_dwordx4 v9, s[8:11], s46 offen offset:1024 lds
    v_mfma_f32_16x16x32_bf16 v[76:79], v[140:143], a[8:11], v[76:79]
    ds_read_b128 v[124:127], v24 offset:12544
    v_fmac_f32_dpp v41, v40, v30 row_ror:8 row_mask:0xf bank_mask:0xf
    v_fma_f32 v40, v41, v29, v92
    s_waitcnt lgkmcnt(4)
    v_mfma_f32_16x16x32_bf16 v[64:67], v[96:99], a[12:15], v[64:67]
    ds_read_b128 v[128:131], v25 offset:256
    v_fmac_f32_dpp v40, v41, v30 row_ror:8 row_mask:0xf bank_mask:0xf
    v_fma_f32 v41, v40, v29, v93
    buffer_load_dwordx4 v10, s[8:11], s46 offen offset:2048 lds
    v_mfma_f32_16x16x32_bf16 v[68:71], v[100:103], a[12:15], v[68:71]
    ds_read_b128 v[132:135], v25 offset:4352
    v_fmac_f32_dpp v41, v40, v30 row_ror:8 row_mask:0xf bank_mask:0xf
    v_fma_f32 v40, v41, v29, v94
    v_mfma_f32_16x16x32_bf16 v[72:75], v[104:107], a[12:15], v[72:75]
    ds_read_b128 v[136:139], v25 offset:8448
    v_fmac_f32_dpp v40, v41, v30 row_ror:8 row_mask:0xf bank_mask:0xf
    v_fma_f32 v41, v40, v29, v95
    buffer_load_dwordx4 v11, s[8:11], s46 offen offset:3072 lds
    v_mfma_f32_16x16x32_bf16 v[76:79], v[108:111], a[12:15], v[76:79]
    ds_read_b128 v[140:143], v25 offset:12544
    v_fmac_f32_dpp v41, v40, v30 row_ror:8 row_mask:0xf bank_mask:0xf
    v_mov_b32 v44, v41
    s_waitcnt lgkmcnt(4)
    v_mfma_f32_16x16x32_bf16 v[64:67], v[112:115], a[16:19], v[64:67]
    ds_read_b128 v[96:99], v26 offset:256
    v_mov_b32 v46, v41
    s_nop 1
    v_permlane32_swap_b32 v44, v46
    s_add_u32 m0, s36, 73728
    s_add_u32 s46, s33, 8192
    buffer_load_dwordx4 v8, s[8:11], s46 offen offset:0 lds
    v_mfma_f32_16x16x32_bf16 v[68:71], v[116:119], a[16:19], v[68:71]
    ds_read_b128 v[100:103], v26 offset:4352
    v_mov_b32 v45, v44
    v_mov_b32 v47, v46
    v_mfma_f32_16x16x32_bf16 v[72:75], v[120:123], a[16:19], v[72:75]
    ds_read_b128 v[104:107], v26 offset:8448
    v_permlane16_swap_b32 v44, v45
    v_permlane16_swap_b32 v46, v47
    buffer_load_dwordx4 v9, s[8:11], s46 offen offset:1024 lds
    v_mfma_f32_16x16x32_bf16 v[76:79], v[124:127], a[16:19], v[76:79]
    ds_read_b128 v[108:111], v26 offset:12544
    v_mov_b32 v41, v35
    v_fmac_f32 v44, v35, v31
    s_waitcnt lgkmcnt(4)
    v_mfma_f32_16x16x32_bf16 v[64:67], v[128:131], a[20:23], v[64:67]
    ds_read_b128 v[112:115], v27 offset:256
    v_fmac_f32_dpp v44, v35, v32 row_ror:8 row_mask:0xf bank_mask:0xf
    v_cndmask_b32 v41, v41, v44, s[52:53]
    buffer_load_dwordx4 v10, s[8:11], s46 offen offset:2048 lds
    v_mfma_f32_16x16x32_bf16 v[68:71], v[132:135], a[20:23], v[68:71]
    ds_read_b128 v[116:119], v27 offset:4352
    v_fmac_f32 v45, v44, v31
    s_nop 1
    v_fmac_f32_dpp v45, v44, v32 row_ror:8 row_mask:0xf bank_mask:0xf
    v_mfma_f32_16x16x32_bf16 v[72:75], v[136:139], a[20:23], v[72:75]
    ds_read_b128 v[120:123], v27 offset:8448
    v_cndmask_b32 v41, v41, v45, s[54:55]
    v_fmac_f32 v46, v45, v31
    buffer_load_dwordx4 v11, s[8:11], s46 offen offset:3072 lds
    v_mfma_f32_16x16x32_bf16 v[76:79], v[140:143], a[20:23], v[76:79]
    ds_read_b128 v[124:127], v27 offset:12544
    v_fmac_f32_dpp v46, v45, v32 row_ror:8 row_mask:0xf bank_mask:0xf
    v_cndmask_b32 v41, v41, v46, s[56:57]
    s_waitcnt lgkmcnt(4)
    v_mfma_f32_16x16x32_bf16 v[64:67], v[96:99], a[24:27], v[64:67]
    ds_read_b128 v[128:131], v24 offset:512
    v_fmac_f32 v47, v46, v31
    s_nop 1
    v_fmac_f32_dpp v47, v46, v32 row_ror:8 row_mask:0xf bank_mask:0xf
    s_add_u32 m0, s36, 77824
    s_add_u32 s46, s33, 12288
    buffer_load_dwordx4 v8, s[8:11], s46 offen offset:0 lds
    v_mfma_f32_16x16x32_bf16 v[68:71], v[100:103], a[24:27], v[68:71]
    ds_read_b128 v[132:135], v24 offset:4608
    v_mov_b32 v35, v47
    v_fma_f32 v40, v41, v29, v80
    v_mfma_f32_16x16x32_bf16 v[72:75], v[104:107], a[24:27], v[72:75]
    ds_read_b128 v[136:139], v24 offset:8704
    v_fmac_f32_dpp v40, v41, v30 row_ror:8 row_mask:0xf bank_mask:0xf
    v_mul_f32 v80, v40, v33
    buffer_load_dwordx4 v9, s[8:11], s46 offen offset:1024 lds
    v_mfma_f32_16x16x32_bf16 v[76:79], v[108:111], a[24:27], v[76:79]
    ds_read_b128 v[140:143], v24 offset:12800
    v_fma_f32 v41, v40, v29, v81
    s_nop 1
    v_fmac_f32_dpp v41, v40, v30 row_ror:8 row_mask:0xf bank_mask:0xf
    s_waitcnt lgkmcnt(4)
    v_mfma_f32_16x16x32_bf16 v[64:67], v[112:115], a[28:31], v[64:67]
    ds_read_b128 v[96:99], v25 offset:512
    v_fmac_f32_dpp v80, v40, v34 row_ror:8 row_mask:0xf bank_mask:0xf
    v_mul_f32 v81, v41, v33
    buffer_load_dwordx4 v10, s[8:11], s46 offen offset:2048 lds
    v_mfma_f32_16x16x32_bf16 v[68:71], v[116:119], a[28:31], v[68:71]
    ds_read_b128 v[100:103], v25 offset:4608
    v_fma_f32 v40, v41, v29, v82
    s_nop 1
    v_fmac_f32_dpp v40, v41, v30 row_ror:8 row_mask:0xf bank_mask:0xf
    v_mfma_f32_16x16x32_bf16 v[72:75], v[120:123], a[28:31], v[72:75]
    ds_read_b128 v[104:107], v25 offset:8704
    v_fmac_f32_dpp v81, v41, v34 row_ror:8 row_mask:0xf bank_mask:0xf
    v_cvt_pk_bf16_f32 v144, v80, v81
    buffer_load_dwordx4 v11, s[8:11], s46 offen offset:3072 lds
    v_mfma_f32_16x16x32_bf16 v[76:79], v[124:127], a[28:31], v[76:79]
    ds_read_b128 v[108:111], v25 offset:12800
    v_mul_f32 v82, v40, v33
    v_fma_f32 v41, v40, v29, v83
    s_waitcnt lgkmcnt(4)
    v_mfma_f32_16x16x32_bf16 v[64:67], v[128:131], a[32:35], v[64:67]
    ds_read_b128 v[112:115], v26 offset:512
    v_fmac_f32_dpp v41, v40, v30 row_ror:8 row_mask:0xf bank_mask:0xf
    v_fmac_f32_dpp v82, v40, v34 row_ror:8 row_mask:0xf bank_mask:0xf
    v_mfma_f32_16x16x32_bf16 v[68:71], v[132:135], a[32:35], v[68:71]
    ds_read_b128 v[116:119], v26 offset:4608
    v_mul_f32 v83, v41, v33
    v_fma_f32 v40, v41, v29, v84
    v_mfma_f32_16x16x32_bf16 v[72:75], v[136:139], a[32:35], v[72:75]
    ds_read_b128 v[120:123], v26 offset:8704
    v_fmac_f32_dpp v40, v41, v30 row_ror:8 row_mask:0xf bank_mask:0xf
    v_fmac_f32_dpp v83, v41, v34 row_ror:8 row_mask:0xf bank_mask:0xf
    v_mfma_f32_16x16x32_bf16 v[76:79], v[140:143], a[32:35], v[76:79]
    ds_read_b128 v[124:127], v26 offset:12800
    v_cvt_pk_bf16_f32 v145, v82, v83
    v_mul_f32 v84, v40, v33
    s_waitcnt lgkmcnt(4)
    v_mfma_f32_16x16x32_bf16 v[64:67], v[96:99], a[36:39], v[64:67]
    ds_read_b128 v[128:131], v27 offset:512
    v_fma_f32 v41, v40, v29, v85
    s_nop 1
    v_fmac_f32_dpp v41, v40, v30 row_ror:8 row_mask:0xf bank_mask:0xf
    v_mfma_f32_16x16x32_bf16 v[68:71], v[100:103], a[36:39], v[68:71]
    ds_read_b128 v[132:135], v27 offset:4608
    v_fmac_f32_dpp v84, v40, v34 row_ror:8 row_mask:0xf bank_mask:0xf
    v_mul_f32 v85, v41, v33
    v_mfma_f32_16x16x32_bf16 v[72:75], v[104:107], a[36:39], v[72:75]
    ds_read_b128 v[136:139], v27 offset:8704
    v_fma_f32 v40, v41, v29, v86
    s_nop 1
    v_fmac_f32_dpp v40, v41, v30 row_ror:8 row_mask:0xf bank_mask:0xf
    v_mfma_f32_16x16x32_bf16 v[76:79], v[108:111], a[36:39], v[76:79]
    ds_read_b128 v[140:143], v27 offset:12800
    v_fmac_f32_dpp v85, v41, v34 row_ror:8 row_mask:0xf bank_mask:0xf
    v_cvt_pk_bf16_f32 v146, v84, v85
    s_waitcnt lgkmcnt(4)
    v_mfma_f32_16x16x32_bf16 v[64:67], v[112:115], a[40:43], v[64:67]
    ds_read_b128 v[96:99], v24 offset:768
    v_mul_f32 v86, v40, v33
    v_fma_f32 v41, v40, v29, v87
    v_mfma_f32_16x16x32_bf16 v[68:71], v[116:119], a[40:43], v[68:71]
    ds_read_b128 v[100:103], v24 offset:4864
    v_fmac_f32_dpp v41, v40, v30 row_ror:8 row_mask:0xf bank_mask:0xf
    v_fmac_f32_dpp v86, v40, v34 row_ror:8 row_mask:0xf bank_mask:0xf
    v_mfma_f32_16x16x32_bf16 v[72:75], v[120:123], a[40:43], v[72:75]
    ds_read_b128 v[104:107], v24 offset:8960
    v_mul_f32 v87, v41, v33
    v_fma_f32 v40, v41, v29, v88
    v_mfma_f32_16x16x32_bf16 v[76:79], v[124:127], a[40:43], v[76:79]
    ds_read_b128 v[108:111], v24 offset:13056
    v_fmac_f32_dpp v40, v41, v30 row_ror:8 row_mask:0xf bank_mask:0xf
    v_fmac_f32_dpp v87, v41, v34 row_ror:8 row_mask:0xf bank_mask:0xf
    s_waitcnt lgkmcnt(4)
    v_mfma_f32_16x16x32_bf16 v[64:67], v[128:131], a[44:47], v[64:67]
    ds_read_b128 v[112:115], v25 offset:768
    v_cvt_pk_bf16_f32 v147, v86, v87
    v_mul_f32 v88, v40, v33
    v_mfma_f32_16x16x32_bf16 v[68:71], v[132:135], a[44:47], v[68:71]
    ds_read_b128 v[116:119], v25 offset:4864
    v_fma_f32 v41, v40, v29, v89
    s_nop 1
    v_fmac_f32_dpp v41, v40, v30 row_ror:8 row_mask:0xf bank_mask:0xf
    v_mfma_f32_16x16x32_bf16 v[72:75], v[136:139], a[44:47], v[72:75]
    ds_read_b128 v[120:123], v25 offset:8960
    v_fmac_f32_dpp v88, v40, v34 row_ror:8 row_mask:0xf bank_mask:0xf
    v_mul_f32 v89, v41, v33
    v_mfma_f32_16x16x32_bf16 v[76:79], v[140:143], a[44:47], v[76:79]
    ds_read_b128 v[124:127], v25 offset:13056
    v_fma_f32 v40, v41, v29, v90
    s_nop 1
    v_fmac_f32_dpp v40, v41, v30 row_ror:8 row_mask:0xf bank_mask:0xf
    s_waitcnt lgkmcnt(4)
    v_mfma_f32_16x16x32_bf16 v[64:67], v[96:99], a[48:51], v[64:67]
    ds_read_b128 v[128:131], v26 offset:768
    v_fmac_f32_dpp v89, v41, v34 row_ror:8 row_mask:0xf bank_mask:0xf
    v_cvt_pk_bf16_f32 v148, v88, v89
    v_mfma_f32_16x16x32_bf16 v[68:71], v[100:103], a[48:51], v[68:71]
    ds_read_b128 v[132:135], v26 offset:4864
    v_mul_f32 v90, v40, v33
    v_fma_f32 v41, v40, v29, v91
    v_mfma_f32_16x16x32_bf16 v[72:75], v[104:107], a[48:51], v[72:75]
    ds_read_b128 v[136:139], v26 offset:8960
    v_fmac_f32_dpp v41, v40, v30 row_ror:8 row_mask:0xf bank_mask:0xf
    v_fmac_f32_dpp v90, v40, v34 row_ror:8 row_mask:0xf bank_mask:0xf
    v_mfma_f32_16x16x32_bf16 v[76:79], v[108:111], a[48:51], v[76:79]
    ds_read_b128 v[140:143], v26 offset:13056
    v_mul_f32 v91, v41, v33
    v_fma_f32 v40, v41, v29, v92
    s_waitcnt lgkmcnt(4)
    v_mfma_f32_16x16x32_bf16 v[64:67], v[112:115], a[52:55], v[64:67]
    ds_read_b128 v[96:99], v27 offset:768
    v_fmac_f32_dpp v40, v41, v30 row_ror:8 row_mask:0xf bank_mask:0xf
    v_fmac_f32_dpp v91, v41, v34 row_ror:8 row_mask:0xf bank_mask:0xf
    v_mfma_f32_16x16x32_bf16 v[68:71], v[116:119], a[52:55], v[68:71]
    ds_read_b128 v[100:103], v27 offset:4864
    v_cvt_pk_bf16_f32 v149, v90, v91
    v_mul_f32 v92, v40, v33
    v_mfma_f32_16x16x32_bf16 v[72:75], v[120:123], a[52:55], v[72:75]
    ds_read_b128 v[104:107], v27 offset:8960
    v_fma_f32 v41, v40, v29, v93
    s_nop 1
    v_fmac_f32_dpp v41, v40, v30 row_ror:8 row_mask:0xf bank_mask:0xf
    v_mfma_f32_16x16x32_bf16 v[76:79], v[124:127], a[52:55], v[76:79]
    ds_read_b128 v[108:111], v27 offset:13056
    v_fmac_f32_dpp v92, v40, v34 row_ror:8 row_mask:0xf bank_mask:0xf
    v_mul_f32 v93, v41, v33
    s_waitcnt lgkmcnt(4)
    v_mfma_f32_16x16x32_bf16 v[64:67], v[128:131], a[56:59], v[64:67]
    v_fma_f32 v40, v41, v29, v94
    s_nop 1
    v_fmac_f32_dpp v40, v41, v30 row_ror:8 row_mask:0xf bank_mask:0xf
    v_mfma_f32_16x16x32_bf16 v[68:71], v[132:135], a[56:59], v[68:71]
    v_fmac_f32_dpp v93, v41, v34 row_ror:8 row_mask:0xf bank_mask:0xf
    v_cvt_pk_bf16_f32 v150, v92, v93
    v_mfma_f32_16x16x32_bf16 v[72:75], v[136:139], a[56:59], v[72:75]
    v_mul_f32 v94, v40, v33
    v_fma_f32 v41, v40, v29, v95
    v_mfma_f32_16x16x32_bf16 v[76:79], v[140:143], a[56:59], v[76:79]
    s_nop 0
    v_fmac_f32_dpp v41, v40, v30 row_ror:8 row_mask:0xf bank_mask:0xf
    v_fmac_f32_dpp v94, v40, v34 row_ror:8 row_mask:0xf bank_mask:0xf
    s_waitcnt lgkmcnt(0)
    v_mfma_f32_16x16x32_bf16 v[64:67], v[96:99], a[60:63], v[64:67]
    v_mul_f32 v95, v41, v33
    s_nop 1
    v_fmac_f32_dpp v95, v41, v34 row_ror:8 row_mask:0xf bank_mask:0xf
    v_mfma_f32_16x16x32_bf16 v[68:71], v[100:103], a[60:63], v[68:71]
    v_cvt_pk_bf16_f32 v151, v94, v95
    v_permlane32_swap_b32 v144, v148
    v_mfma_f32_16x16x32_bf16 v[72:75], v[104:107], a[60:63], v[72:75]
    v_permlane32_swap_b32 v145, v149
    v_permlane32_swap_b32 v146, v150
    v_mfma_f32_16x16x32_bf16 v[76:79], v[108:111], a[60:63], v[76:79]
    v_permlane32_swap_b32 v147, v151
    buffer_store_dwordx4 v[144:147], v28, s[4:7], s34 offen sc0 sc1
    s_add_u32 s34, s34, 65536
    buffer_store_dwordx4 v[148:151], v28, s[4:7], s34 offen sc0 sc1
    s_add_u32 s34, s34, 65536
    s_add_u32 s35, s35, 1
    s_nop 0
    s_branch S1L_b1
S1L_last:
    v_mov_b32 v40, v80
    v_fma_f32 v41, v40, v29, v81
    s_nop 1
    v_fmac_f32_dpp v41, v40, v30 row_ror:8 row_mask:0xf bank_mask:0xf
    v_fma_f32 v40, v41, v29, v82
    s_nop 1
    v_fmac_f32_dpp v40, v41, v30 row_ror:8 row_mask:0xf bank_mask:0xf
    v_fma_f32 v41, v40, v29, v83
    s_nop 1
    v_fmac_f32_dpp v41, v40, v30 row_ror:8 row_mask:0xf bank_mask:0xf
    v_fma_f32 v40, v41, v29, v84
    s_nop 1
    v_fmac_f32_dpp v40, v41, v30 row_ror:8 row_mask:0xf bank_mask:0xf
    v_fma_f32 v41, v40, v29, v85
    s_nop 1
    v_fmac_f32_dpp v41, v40, v30 row_ror:8 row_mask:0xf bank_mask:0xf
    v_fma_f32 v40, v41, v29, v86
    s_nop 1
    v_fmac_f32_dpp v40, v41, v30 row_ror:8 row_mask:0xf bank_mask:0xf
    v_fma_f32 v41, v40, v29, v87
    s_nop 1
    v_fmac_f32_dpp v41, v40, v30 row_ror:8 row_mask:0xf bank_mask:0xf
    v_fma_f32 v40, v41, v29, v88
    s_nop 1
    v_fmac_f32_dpp v40, v41, v30 row_ror:8 row_mask:0xf bank_mask:0xf
    v_fma_f32 v41, v40, v29, v89
    s_nop 1
    v_fmac_f32_dpp v41, v40, v30 row_ror:8 row_mask:0xf bank_mask:0xf
    v_fma_f32 v40, v41, v29, v90
    s_nop 1
    v_fmac_f32_dpp v40, v41, v30 row_ror:8 row_mask:0xf bank_mask:0xf
    v_fma_f32 v41, v40, v29, v91
    s_nop 1
    v_fmac_f32_dpp v41, v40, v30 row_ror:8 row_mask:0xf bank_mask:0xf
    v_fma_f32 v40, v41, v29, v92
    s_nop 1
    v_fmac_f32_dpp v40, v41, v30 row_ror:8 row_mask:0xf bank_mask:0xf
    v_fma_f32 v41, v40, v29, v93
    s_nop 1
    v_fmac_f32_dpp v41, v40, v30 row_ror:8 row_mask:0xf bank_mask:0xf
    v_fma_f32 v40, v41, v29, v94
    s_nop 1
    v_fmac_f32_dpp v40, v41, v30 row_ror:8 row_mask:0xf bank_mask:0xf
    v_fma_f32 v41, v40, v29, v95
    s_nop 1
    v_fmac_f32_dpp v41, v40, v30 row_ror:8 row_mask:0xf bank_mask:0xf
    v_mov_b32 v44, v41
    v_mov_b32 v46, v41
    s_nop 1
    v_permlane32_swap_b32 v44, v46
    v_mov_b32 v45, v44
    v_mov_b32 v47, v46
    s_nop 0
    v_permlane16_swap_b32 v44, v45
    v_permlane16_swap_b32 v46, v47
    v_mov_b32 v41, v35
    v_fmac_f32 v44, v35, v31
    s_nop 1
    v_fmac_f32_dpp v44, v35, v32 row_ror:8 row_mask:0xf bank_mask:0xf
    v_cndmask_b32 v41, v41, v44, s[52:53]
    v_fmac_f32 v45, v44, v31
    s_nop 1
    v_fmac_f32_dpp v45, v44, v32 row_ror:8 row_mask:0xf bank_mask:0xf
    v_cndmask_b32 v41, v41, v45, s[54:55]
    v_fmac_f32 v46, v45, v31
    s_nop 1
    v_fmac_f32_dpp v46, v45, v32 row_ror:8 row_mask:0xf bank_mask:0xf
    v_cndmask_b32 v41, v41, v46, s[56:57]
    v_fmac_f32 v47, v46, v31
    s_nop 1
    v_fmac_f32_dpp v47, v46, v32 row_ror:8 row_mask:0xf bank_mask:0xf
    v_mov_b32 v35, v47
    v_fma_f32 v40, v41, v29, v80
    s_nop 1
    v_fmac_f32_dpp v40, v41, v30 row_ror:8 row_mask:0xf bank_mask:0xf
    v_mul_f32 v80, v40, v33
    v_fma_f32 v41, v40, v29, v81
    s_nop 1
    v_fmac_f32_dpp v41, v40, v30 row_ror:8 row_mask:0xf bank_mask:0xf
    v_fmac_f32_dpp v80, v40, v34 row_ror:8 row_mask:0xf bank_mask:0xf
    v_mul_f32 v81, v41, v33
    v_fma_f32 v40, v41, v29, v82
    s_nop 1
    v_fmac_f32_dpp v40, v41, v30 row_ror:8 row_mask:0xf bank_mask:0xf
    v_fmac_f32_dpp v81, v41, v34 row_ror:8 row_mask:0xf bank_mask:0xf
    v_cvt_pk_bf16_f32 v144, v80, v81
    v_mul_f32 v82, v40, v33
    v_fma_f32 v41, v40, v29, v83
    s_nop 1
    v_fmac_f32_dpp v41, v40, v30 row_ror:8 row_mask:0xf bank_mask:0xf
    v_fmac_f32_dpp v82, v40, v34 row_ror:8 row_mask:0xf bank_mask:0xf
    v_mul_f32 v83, v41, v33
    v_fma_f32 v40, v41, v29, v84
    s_nop 1
    v_fmac_f32_dpp v40, v41, v30 row_ror:8 row_mask:0xf bank_mask:0xf
    v_fmac_f32_dpp v83, v41, v34 row_ror:8 row_mask:0xf bank_mask:0xf
    v_cvt_pk_bf16_f32 v145, v82, v83
    v_mul_f32 v84, v40, v33
    v_fma_f32 v41, v40, v29, v85
    s_nop 1
    v_fmac_f32_dpp v41, v40, v30 row_ror:8 row_mask:0xf bank_mask:0xf
    v_fmac_f32_dpp v84, v40, v34 row_ror:8 row_mask:0xf bank_mask:0xf
    v_mul_f32 v85, v41, v33
    v_fma_f32 v40, v41, v29, v86
    s_nop 1
    v_fmac_f32_dpp v40, v41, v30 row_ror:8 row_mask:0xf bank_mask:0xf
    v_fmac_f32_dpp v85, v41, v34 row_ror:8 row_mask:0xf bank_mask:0xf
    v_cvt_pk_bf16_f32 v146, v84, v85
    v_mul_f32 v86, v40, v33
    v_fma_f32 v41, v40, v29, v87
    s_nop 1
    v_fmac_f32_dpp v41, v40, v30 row_ror:8 row_mask:0xf bank_mask:0xf
    v_fmac_f32_dpp v86, v40, v34 row_ror:8 row_mask:0xf bank_mask:0xf
    v_mul_f32 v87, v41, v33
    v_fma_f32 v40, v41, v29, v88
    s_nop 1
    v_fmac_f32_dpp v40, v41, v30 row_ror:8 row_mask:0xf bank_mask:0xf
    v_fmac_f32_dpp v87, v41, v34 row_ror:8 row_mask:0xf bank_mask:0xf
    v_cvt_pk_bf16_f32 v147, v86, v87
    v_mul_f32 v88, v40, v33
    v_fma_f32 v41, v40, v29, v89
    s_nop 1
    v_fmac_f32_dpp v41, v40, v30 row_ror:8 row_mask:0xf bank_mask:0xf
    v_fmac_f32_dpp v88, v40, v34 row_ror:8 row_mask:0xf bank_mask:0xf
    v_mul_f32 v89, v41, v33
    v_fma_f32 v40, v41, v29, v90
    s_nop 1
    v_fmac_f32_dpp v40, v41, v30 row_ror:8 row_mask:0xf bank_mask:0xf
    v_fmac_f32_dpp v89, v41, v34 row_ror:8 row_mask:0xf bank_mask:0xf
    v_cvt_pk_bf16_f32 v148, v88, v89
    v_mul_f32 v90, v40, v33
    v_fma_f32 v41, v40, v29, v91
    s_nop 1
    v_fmac_f32_dpp v41, v40, v30 row_ror:8 row_mask:0xf bank_mask:0xf
    v_fmac_f32_dpp v90, v40, v34 row_ror:8 row_mask:0xf bank_mask:0xf
    v_mul_f32 v91, v41, v33
    v_fma_f32 v40, v41, v29, v92
    s_nop 1
    v_fmac_f32_dpp v40, v41, v30 row_ror:8 row_mask:0xf bank_mask:0xf
    v_fmac_f32_dpp v91, v41, v34 row_ror:8 row_mask:0xf bank_mask:0xf
    v_cvt_pk_bf16_f32 v149, v90, v91
    v_mul_f32 v92, v40, v33
    v_fma_f32 v41, v40, v29, v93
    s_nop 1
    v_fmac_f32_dpp v41, v40, v30 row_ror:8 row_mask:0xf bank_mask:0xf
    v_fmac_f32_dpp v92, v40, v34 row_ror:8 row_mask:0xf bank_mask:0xf
    v_mul_f32 v93, v41, v33
    v_fma_f32 v40, v41, v29, v94
    s_nop 1
    v_fmac_f32_dpp v40, v41, v30 row_ror:8 row_mask:0xf bank_mask:0xf
    v_fmac_f32_dpp v93, v41, v34 row_ror:8 row_mask:0xf bank_mask:0xf
    v_cvt_pk_bf16_f32 v150, v92, v93
    v_mul_f32 v94, v40, v33
    v_fma_f32 v41, v40, v29, v95
    s_nop 1
    v_fmac_f32_dpp v41, v40, v30 row_ror:8 row_mask:0xf bank_mask:0xf
    v_fmac_f32_dpp v94, v40, v34 row_ror:8 row_mask:0xf bank_mask:0xf
    v_mul_f32 v95, v41, v33
    s_nop 1
    v_fmac_f32_dpp v95, v41, v34 row_ror:8 row_mask:0xf bank_mask:0xf
    v_cvt_pk_bf16_f32 v151, v94, v95
    v_permlane32_swap_b32 v144, v148
    v_permlane32_swap_b32 v145, v149
    v_permlane32_swap_b32 v146, v150
    v_permlane32_swap_b32 v147, v151
    buffer_store_dwordx4 v[144:147], v28, s[4:7], s34 offen sc0 sc1
    s_add_u32 s34, s34, 65536
    buffer_store_dwordx4 v[148:151], v28, s[4:7], s34 offen sc0 sc1
    s_add_u32 s34, s34, 65536
    s_mov_b32 s35, 32
    s_waitcnt vmcnt(0)
    s_barrier
    v_mov_b32 v255, s35
    buffer_store_dword v255, off, s[4:7], s63 sc0 sc1
    s_endpgm
    s_nop 0
L_attn_tail:
    v_mov_b32 v254, 192
    s_mov_b32 s62, 0
    s_nop 0
L_w4:
    global_load_dword v255, v254, s[28:29] sc1
    s_add_u32 s62, s62, 1
    s_cmp_gt_u32 s62, 2000000
    s_cbranch_scc1 L_end
    s_waitcnt vmcnt(0)
    v_cmp_eq_u32 vcc, 0, v255
    s_nop 0
    s_cbranch_vccnz L_w4
    s_sub_u32 s31, s31, 176
    s_lshr_b32 s33, s31, 3
    s_add_u32 s33, s33, 58
    s_mov_b32 s64, 15
    s_mov_b32 s65, 64
    s_mov_b32 s45, 87031744
    buffer_load_dword v250, off, s[4:7], s45 sc1
    s_branch L_attn2
L_attn:
    s_lshr_b32 s33, s31, 3
    s_mov_b32 s64, 0
    s_mov_b32 s65, 62
L_attn2:
    s_and_b32 s32, s31, 7
    s_lshl_b32 s32, s32, 2
    s_add_u32 s32, s32, s30
    s_mov_b32 s34, 4
    s_lshr_b32 s63, s31, 3
    s_lshl_b32 s63, s63, 7
    s_and_b32 s45, s31, 7
    s_lshl_b32 s45, s45, 2
    s_add_u32 s63, s63, s45
    s_add_u32 s63, s63, 1838080
    s_cmp_eq_u32 s30, 0
    s_cselect_b32 s63, s63, 268435456
    v_lshlrev_b32 v1, 4, v0
    v_and_b32 v20, 15, v0
    v_lshrrev_b32 v21, 4, v0
    v_bfe_u32 v22, v0, 2, 2
    v_and_b32 v23, 3, v0
    s_lshl_b32 s45, s30, 12
    v_lshlrev_b32 v24, 5, v20
    v_lshl_add_u32 v24, v21, 3, v24
    v_add_u32 v2, s45, v24
    v_lshl_add_u32 v24, v21, 2, v22
    v_lshlrev_b32 v24, 5, v24
    v_lshl_add_u32 v24, v23, 3, v24
    v_add_u32 v3, s45, v24
    v_mov_b32 v6, 0xf149f2ca
    v_lshlrev_b32 v24, 2, v21
    v_add_u32 v25, 0, v24
    v_cmp_le_u32 s[52:53], v25, v20
    v_add_u32 v25, 1, v24
    v_cmp_le_u32 s[54:55], v25, v20
    v_add_u32 v25, 2, v24
    v_cmp_le_u32 s[56:57], v25, v20
    v_add_u32 v25, 3, v24
    v_cmp_le_u32 s[58:59], v25, v20
    v_mov_b32 v200, 0x3f803f80
    v_mov_b32 v201, 0x3f803f80
    v_mov_b32 v202, 0x3f803f80
    v_mov_b32 v203, 0x3f803f80
    v_mov_b32 v144, 0
    v_mov_b32 v145, 0
    v_mov_b32 v186, 0
    v_mov_b32 v187, 0
    v_mov_b32 v193, 0
    v_mov_b32 v194, 0
    v_mov_b32 v195, 0
    v_mov_b32 v197, 0
    v_mov_b32 v198, 0
    v_mov_b32 v199, 0
    s_nop 1
AL_task:
    s_lshl_b32 s45, s33, 5
    s_add_u32 s45, s45, s32
    s_lshl_b32 s35, s45, 13
    s_add_u32 s37, s35, 52690944
    s_add_u32 s35, s35, 35651584
    s_lshl_b32 s36, s45, 14
    s_add_u32 s36, s36, 2097152
    s_lshl_b32 s38, s33, 18
    s_lshl_b32 s45, s32, 12
    s_add_u32 s38, s38, s45
    s_add_u32 s38, s38, 70254592
    s_lshr_b32 s61, s33, 2
    s_add_u32 s61, s61, 1
    s_and_b32 s46, s33, 3
    s_lshl_b32 s46, s46, 2
    s_lshl_b32 s60, s32, 6
    s_add_u32 s60, s60, s46
    s_add_u32 s60, s60, 1835008
    v_lshlrev_b32 v254, 2, v0
    s_mov_b64 exec, 1
    s_mov_b32 s62, 0
L_w5:
    buffer_load_dword v255, v254, s[4:7], s60 offen sc1
    s_add_u32 s62, s62, 1
    s_cmp_gt_u32 s62, 2000000
    s_cbranch_scc1 L_end
    s_waitcnt vmcnt(0)
    v_cmp_gt_u32 vcc, s61, v255
    s_nop 0
    s_cbranch_vccz L_wd5
    s_sleep 32
    s_branch L_w5
    s_nop 0
L_wd5:
    s_mov_b64 exec, -1
    s_lshr_b32 s60, s32, 1
    s_lshl_b32 s60, s60, 6
    s_add_u32 s60, s60, s46
    s_add_u32 s60, s60, 1837056
    v_lshlrev_b32 v254, 2, v0
    s_mov_b64 exec, 1
    s_mov_b32 s62, 0
L_w6:
    buffer_load_dword v255, v254, s[4:7], s60 offen sc1
    s_add_u32 s62, s62, 1
    s_cmp_gt_u32 s62, 2000000
    s_cbranch_scc1 L_end
    s_waitcnt vmcnt(0)
    v_cmp_gt_u32 vcc, s61, v255
    s_nop 0
    s_cbranch_vccz L_wd6
    s_sleep 32
    s_branch L_w6
    s_nop 0
L_wd6:
    s_mov_b64 exec, -1
    buffer_load_dwordx4 v[32:35], v1, s[4:7], s35 offen offset:0 sc1
    buffer_load_dwordx4 v[36:39], v1, s[4:7], s35 offen offset:1024 sc1
    buffer_load_dwordx4 v[40:43], v1, s[4:7], s35 offen offset:2048 sc1
    buffer_load_dwordx4 v[44:47], v1, s[4:7], s35 offen offset:3072 sc1
    s_add_u32 s35, s35, 4096
    buffer_load_dwordx4 v[48:51], v1, s[4:7], s35 offen offset:0 sc1
    buffer_load_dwordx4 v[52:55], v1, s[4:7], s35 offen offset:1024 sc1
    buffer_load_dwordx4 v[56:59], v1, s[4:7], s35 offen offset:2048 sc1
    buffer_load_dwordx4 v[60:63], v1, s[4:7], s35 offen offset:3072 sc1
    s_add_u32 s35, s35, 4096
    buffer_load_dwordx4 v[64:67], v1, s[4:7], s36 offen offset:0 sc1
    buffer_load_dwordx4 v[68:71], v1, s[4:7], s36 offen offset:1024 sc1
    buffer_load_dwordx4 v[72:75], v1, s[4:7], s36 offen offset:2048 sc1
    buffer_load_dwordx4 v[76:79], v1, s[4:7], s36 offen offset:3072 sc1
    s_add_u32 s36, s36, 4096
    buffer_load_dwordx4 v[80:83], v1, s[4:7], s36 offen offset:0 sc1
    buffer_load_dwordx4 v[84:87], v1, s[4:7], s36 offen offset:1024 sc1
    buffer_load_dwordx4 v[88:91], v1, s[4:7], s36 offen offset:2048 sc1
    buffer_load_dwordx4 v[92:95], v1, s[4:7], s36 offen offset:3072 sc1
    s_add_u32 s36, s36, 4096
    buffer_load_dwordx4 v[96:99], v1, s[4:7], s36 offen offset:0 sc1
    buffer_load_dwordx4 v[100:103], v1, s[4:7], s36 offen offset:1024 sc1
    buffer_load_dwordx4 v[104:107], v1, s[4:7], s36 offen offset:2048 sc1
    buffer_load_dwordx4 v[108:111], v1, s[4:7], s36 offen offset:3072 sc1
    s_add_u32 s36, s36, 4096
    buffer_load_dwordx4 v[112:115], v1, s[4:7], s36 offen offset:0 sc1
    buffer_load_dwordx4 v[116:119], v1, s[4:7], s36 offen offset:1024 sc1
    buffer_load_dwordx4 v[120:123], v1, s[4:7], s36 offen offset:2048 sc1
    buffer_load_dwordx4 v[124:127], v1, s[4:7], s36 offen offset:3072 sc1
    s_add_u32 s36, s36, 4096
    s_waitcnt vmcnt(8)
    v_mfma_f32_16x16x32_bf16 v[168:171], v[64:67], v[32:35], 0
    v_mfma_f32_16x16x32_bf16 v[176:179], v[64:67], v[48:51], 0
    v_mfma_f32_16x16x32_bf16 v[180:183], v[80:83], v[48:51], 0
    v_mfma_f32_16x16x32_bf16 v[168:171], v[68:71], v[36:39], v[168:171]
    v_mfma_f32_16x16x32_bf16 v[176:179], v[68:71], v[52:55], v[176:179]
    v_mfma_f32_16x16x32_bf16 v[180:183], v[84:87], v[52:55], v[180:183]
    v_mfma_f32_16x16x32_bf16 v[168:171], v[72:75], v[40:43], v[168:171]
    v_mfma_f32_16x16x32_bf16 v[176:179], v[72:75], v[56:59], v[176:179]
    v_mfma_f32_16x16x32_bf16 v[180:183], v[88:91], v[56:59], v[180:183]
    v_mfma_f32_16x16x32_bf16 v[168:171], v[76:79], v[44:47], v[168:171]
    v_mfma_f32_16x16x32_bf16 v[176:179], v[76:79], v[60:63], v[176:179]
    v_mfma_f32_16x16x32_bf16 v[180:183], v[92:95], v[60:63], v[180:183]
    s_nop 1
    v_cndmask_b32 v168, v6, v168, s[52:53]
    s_nop 4
    v_cndmask_b32 v180, v6, v180, s[52:53]
    v_cndmask_b32 v169, v6, v169, s[54:55]
    v_cndmask_b32 v181, v6, v181, s[54:55]
    v_cndmask_b32 v170, v6, v170, s[56:57]
    v_cndmask_b32 v182, v6, v182, s[56:57]
    v_cndmask_b32 v171, v6, v171, s[58:59]
    v_cndmask_b32 v183, v6, v183, s[58:59]
    s_add_u32 s61, s33, 1
    s_cmp_ge_u32 s33, 60
    s_cselect_b32 s46, 2, 0
    s_sub_u32 s61, s61, s46
    s_cmp_eq_u32 s33, 63
    s_cselect_b32 s61, 61, s61
    s_lshr_b32 s60, s32, 2
    s_lshl_b32 s60, s60, 7
    s_add_u32 s60, s60, 1839104
    s_cmp_lg_u32 s30, 0
    s_cbranch_scc1 L_wb7
    v_lshlrev_b32 v254, 2, v0
    s_mov_b64 exec, 15
    s_mov_b32 s62, 0
L_w7:
    buffer_load_dword v255, v254, s[4:7], s60 offen sc1
    s_add_u32 s62, s62, 1
    s_cmp_gt_u32 s62, 2000000
    s_cbranch_scc1 L_end
    s_waitcnt vmcnt(0)
    v_cmp_gt_u32 vcc, s61, v255
    s_nop 0
    s_cbranch_vccz L_wd7
    s_sleep 1
    v_add_u32 v255, 3, v255
    v_cmp_gt_u32 vcc, s61, v255
    s_nop 0
    s_cbranch_vccz L_w7
    s_sleep 40
    s_branch L_w7
    s_nop 0
L_wd7:
    s_mov_b64 exec, -1
L_wb7:
    s_barrier
    v_mov_b32 v255, s64
    buffer_store_dword v255, off, s[4:7], s63 sc0 sc1
    s_add_u32 s48, s37, 4096
    s_mov_b32 s39, 0
AL_kvm:
    buffer_load_dwordx4 v[128:131], v1, s[4:7], s37 offen offset:0 sc1
    buffer_load_dwordx4 v[132:135], v1, s[4:7], s37 offen offset:2048 sc1
    buffer_load_dwordx4 v[136:139], v1, s[4:7], s48 offen offset:0 sc1
    buffer_load_dwordx4 v[140:143], v1, s[4:7], s48 offen offset:2048 sc1
    s_waitcnt vmcnt(0)
    s_cmp_lt_u32 s33, 60
    s_cbranch_scc1 AL_kvok
    v_max3_u32 v24, v128, v132, v136
    v_max_u32 v24, v24, v140
    s_add_u32 s39, s39, 1
    s_cmp_gt_u32 s39, 2000000
    s_cbranch_scc1 L_end
    v_cmp_eq_u32 vcc, -1, v24
    s_nop 0
    s_cbranch_vccnz AL_kvm
    s_nop 2
AL_kvok:
    ds_write2_b32 v2, v129, v131 offset0:0 offset1:128
    v_add_u32 v24, 1024, v2
    ds_write2_b32 v24, v133, v135 offset1:128
    v_add_u32 v24, 2048, v2
    ds_write2_b32 v24, v137, v139 offset1:128
    v_add_u32 v24, 3072, v2
    ds_write2_b32 v24, v141, v143 offset1:128
    s_waitcnt lgkmcnt(0)
    ds_read_b64_tr_b16 v[148:149], v3 offset:0
    ds_read_b64_tr_b16 v[150:151], v3 offset:512
    ds_read_b64_tr_b16 v[152:153], v3 offset:1024
    ds_read_b64_tr_b16 v[154:155], v3 offset:1536
    ds_read_b64_tr_b16 v[156:157], v3 offset:2048
    ds_read_b64_tr_b16 v[158:159], v3 offset:2560
    ds_read_b64_tr_b16 v[160:161], v3 offset:3072
    ds_read_b64_tr_b16 v[162:163], v3 offset:3584
    s_waitcnt lgkmcnt(0)
    v_mfma_f32_16x16x32_bf16 v[164:167], v[148:151], v[32:35], 0
    v_mfma_f32_16x16x32_bf16 v[172:175], v[148:151], v[48:51], 0
    v_mfma_f32_16x16x32_bf16 v[164:167], v[152:155], v[36:39], v[164:167]
    v_mfma_f32_16x16x32_bf16 v[172:175], v[152:155], v[52:55], v[172:175]
    v_mfma_f32_16x16x32_bf16 v[164:167], v[156:159], v[40:43], v[164:167]
    v_mfma_f32_16x16x32_bf16 v[172:175], v[156:159], v[56:59], v[172:175]
    v_mfma_f32_16x16x32_bf16 v[164:167], v[160:163], v[44:47], v[164:167]
    v_mfma_f32_16x16x32_bf16 v[172:175], v[160:163], v[60:63], v[172:175]
    s_nop 4
    v_max3_f32 v4, v164, v165, v168
    v_max3_f32 v4, v4, v169, v170
    v_max_f32 v4, v4, v171
    v_mov_b32 v5, v4
    s_nop 1
    v_permlane32_swap_b32 v4, v5
    v_max_f32 v4, v4, v5
    v_mov_b32 v5, v4
    s_nop 1
    v_permlane16_swap_b32 v4, v5
    v_max_f32 v4, v4, v5
    v_sub_f32 v164, v164, v4
    v_sub_f32 v165, v165, v4
    v_sub_f32 v168, v168, v4
    v_sub_f32 v169, v169, v4
    v_sub_f32 v170, v170, v4
    v_sub_f32 v171, v171, v4
    v_exp_f32 v164, v164
    v_exp_f32 v165, v165
    v_exp_f32 v168, v168
    v_exp_f32 v169, v169
    v_exp_f32 v170, v170
    v_exp_f32 v171, v171
    v_cvt_pk_bf16_f32 v192, v164, v165
    v_cvt_pk_bf16_f32 v184, v168, v169
    v_cvt_pk_bf16_f32 v185, v170, v171
    v_max3_f32 v4, v172, v173, v176
    v_max3_f32 v4, v4, v177, v178
    v_max3_f32 v4, v4, v179, v180
    v_max3_f32 v4, v4, v181, v182
    v_max_f32 v4, v4, v183
    v_mov_b32 v5, v4
    s_nop 1
    v_permlane32_swap_b32 v4, v5
    v_max_f32 v4, v4, v5
    v_mov_b32 v5, v4
    s_nop 1
    v_permlane16_swap_b32 v4, v5
    v_max_f32 v4, v4, v5
    v_sub_f32 v172, v172, v4
    v_sub_f32 v173, v173, v4
    v_sub_f32 v176, v176, v4
    v_sub_f32 v177, v177, v4
    v_sub_f32 v178, v178, v4
    v_sub_f32 v179, v179, v4
    v_sub_f32 v180, v180, v4
    v_sub_f32 v181, v181, v4
    v_sub_f32 v182, v182, v4
    v_sub_f32 v183, v183, v4
    v_exp_f32 v172, v172
    v_exp_f32 v173, v173
    v_exp_f32 v176, v176
    v_exp_f32 v177, v177
    v_exp_f32 v178, v178
    v_exp_f32 v179, v179
    v_exp_f32 v180, v180
    v_exp_f32 v181, v181
    v_exp_f32 v182, v182
    v_exp_f32 v183, v183
    v_cvt_pk_bf16_f32 v196, v172, v173
    v_cvt_pk_bf16_f32 v188, v176, v177
    v_cvt_pk_bf16_f32 v189, v178, v179
    v_cvt_pk_bf16_f32 v190, v180, v181
    v_cvt_pk_bf16_f32 v191, v182, v183
    v_mfma_f32_16x16x32_bf16 v[204:207], v[200:203], v[184:187], 0
    v_mfma_f32_16x16x32_bf16 v[204:207], v[200:203], v[192:195], v[204:207]
    v_mfma_f32_16x16x32_bf16 v[32:35], v[96:99], v[184:187], 0
    v_mfma_f32_16x16x32_bf16 v[36:39], v[100:103], v[184:187], 0
    v_mfma_f32_16x16x32_bf16 v[40:43], v[104:107], v[184:187], 0
    v_mfma_f32_16x16x32_bf16 v[44:47], v[108:111], v[184:187], 0
    v_mfma_f32_16x16x32_bf16 v[48:51], v[112:115], v[184:187], 0
    v_mfma_f32_16x16x32_bf16 v[52:55], v[116:119], v[184:187], 0
    v_mfma_f32_16x16x32_bf16 v[56:59], v[120:123], v[184:187], 0
    v_mfma_f32_16x16x32_bf16 v[60:63], v[124:127], v[184:187], 0
    v_mfma_f32_16x16x32_bf16 v[32:35], v[128:131], v[192:195], v[32:35]
    v_mfma_f32_16x16x32_bf16 v[36:39], v[130:133], v[192:195], v[36:39]
    v_mfma_f32_16x16x32_bf16 v[40:43], v[132:135], v[192:195], v[40:43]
    v_mfma_f32_16x16x32_bf16 v[44:47], v[134:137], v[192:195], v[44:47]
    v_mfma_f32_16x16x32_bf16 v[48:51], v[136:139], v[192:195], v[48:51]
    v_mfma_f32_16x16x32_bf16 v[52:55], v[138:141], v[192:195], v[52:55]
    v_mfma_f32_16x16x32_bf16 v[56:59], v[140:143], v[192:195], v[56:59]
    v_mfma_f32_16x16x32_bf16 v[60:63], v[142:145], v[192:195], v[60:63]
    v_mfma_f32_16x16x32_bf16 v[208:211], v[200:203], v[188:191], 0
    v_mfma_f32_16x16x32_bf16 v[208:211], v[200:203], v[196:199], v[208:211]
    v_mfma_f32_16x16x32_bf16 v[64:67], v[96:99], v[188:191], 0
    v_mfma_f32_16x16x32_bf16 v[68:71], v[100:103], v[188:191], 0
    v_mfma_f32_16x16x32_bf16 v[72:75], v[104:107], v[188:191], 0
    v_mfma_f32_16x16x32_bf16 v[76:79], v[108:111], v[188:191], 0
    v_mfma_f32_16x16x32_bf16 v[80:83], v[112:115], v[188:191], 0
    v_mfma_f32_16x16x32_bf16 v[84:87], v[116:119], v[188:191], 0
    v_mfma_f32_16x16x32_bf16 v[88:91], v[120:123], v[188:191], 0
    v_mfma_f32_16x16x32_bf16 v[92:95], v[124:127], v[188:191], 0
    v_mfma_f32_16x16x32_bf16 v[64:67], v[128:131], v[196:199], v[64:67]
    v_mfma_f32_16x16x32_bf16 v[68:71], v[130:133], v[196:199], v[68:71]
    v_mfma_f32_16x16x32_bf16 v[72:75], v[132:135], v[196:199], v[72:75]
    v_mfma_f32_16x16x32_bf16 v[76:79], v[134:137], v[196:199], v[76:79]
    v_mfma_f32_16x16x32_bf16 v[80:83], v[136:139], v[196:199], v[80:83]
    v_mfma_f32_16x16x32_bf16 v[84:87], v[138:141], v[196:199], v[84:87]
    v_mfma_f32_16x16x32_bf16 v[88:91], v[140:143], v[196:199], v[88:91]
    v_mfma_f32_16x16x32_bf16 v[92:95], v[142:145], v[196:199], v[92:95]
    v_rcp_f32 v4, v204
    s_nop 0
    v_pk_mul_f32 v[32:33], v[32:33], v[4:5] op_sel_hi:[1,0]
    v_pk_mul_f32 v[34:35], v[34:35], v[4:5] op_sel_hi:[1,0]
    v_pk_mul_f32 v[36:37], v[36:37], v[4:5] op_sel_hi:[1,0]
    v_pk_mul_f32 v[38:39], v[38:39], v[4:5] op_sel_hi:[1,0]
    v_pk_mul_f32 v[40:41], v[40:41], v[4:5] op_sel_hi:[1,0]
    v_pk_mul_f32 v[42:43], v[42:43], v[4:5] op_sel_hi:[1,0]
    v_pk_mul_f32 v[44:45], v[44:45], v[4:5] op_sel_hi:[1,0]
    v_pk_mul_f32 v[46:47], v[46:47], v[4:5] op_sel_hi:[1,0]
    v_pk_mul_f32 v[48:49], v[48:49], v[4:5] op_sel_hi:[1,0]
    v_pk_mul_f32 v[50:51], v[50:51], v[4:5] op_sel_hi:[1,0]
    v_pk_mul_f32 v[52:53], v[52:53], v[4:5] op_sel_hi:[1,0]
    v_pk_mul_f32 v[54:55], v[54:55], v[4:5] op_sel_hi:[1,0]
    v_pk_mul_f32 v[56:57], v[56:57], v[4:5] op_sel_hi:[1,0]
    v_pk_mul_f32 v[58:59], v[58:59], v[4:5] op_sel_hi:[1,0]
    v_pk_mul_f32 v[60:61], v[60:61], v[4:5] op_sel_hi:[1,0]
    v_pk_mul_f32 v[62:63], v[62:63], v[4:5] op_sel_hi:[1,0]
    v_cvt_pk_bf16_f32 v32, v32, v33
    v_cvt_pk_bf16_f32 v33, v34, v35
    v_cvt_pk_bf16_f32 v34, v36, v37
    v_cvt_pk_bf16_f32 v35, v38, v39
    buffer_store_dwordx4 v[32:35], v1, s[4:7], s38 offen offset:0 sc0 sc1
    v_cvt_pk_bf16_f32 v40, v40, v41
    v_cvt_pk_bf16_f32 v41, v42, v43
    v_cvt_pk_bf16_f32 v42, v44, v45
    v_cvt_pk_bf16_f32 v43, v46, v47
    buffer_store_dwordx4 v[40:43], v1, s[4:7], s38 offen offset:1024 sc0 sc1
    v_cvt_pk_bf16_f32 v48, v48, v49
    v_cvt_pk_bf16_f32 v49, v50, v51
    v_cvt_pk_bf16_f32 v50, v52, v53
    v_cvt_pk_bf16_f32 v51, v54, v55
    buffer_store_dwordx4 v[48:51], v1, s[4:7], s38 offen offset:2048 sc0 sc1
    v_cvt_pk_bf16_f32 v56, v56, v57
    v_cvt_pk_bf16_f32 v57, v58, v59
    v_cvt_pk_bf16_f32 v58, v60, v61
    v_cvt_pk_bf16_f32 v59, v62, v63
    buffer_store_dwordx4 v[56:59], v1, s[4:7], s38 offen offset:3072 sc0 sc1
    s_add_u32 s38, s38, 0x20000
    v_rcp_f32 v4, v208
    s_nop 0
    v_pk_mul_f32 v[64:65], v[64:65], v[4:5] op_sel_hi:[1,0]
    v_pk_mul_f32 v[66:67], v[66:67], v[4:5] op_sel_hi:[1,0]
    v_pk_mul_f32 v[68:69], v[68:69], v[4:5] op_sel_hi:[1,0]
    v_pk_mul_f32 v[70:71], v[70:71], v[4:5] op_sel_hi:[1,0]
    v_pk_mul_f32 v[72:73], v[72:73], v[4:5] op_sel_hi:[1,0]
    v_pk_mul_f32 v[74:75], v[74:75], v[4:5] op_sel_hi:[1,0]
    v_pk_mul_f32 v[76:77], v[76:77], v[4:5] op_sel_hi:[1,0]
    v_pk_mul_f32 v[78:79], v[78:79], v[4:5] op_sel_hi:[1,0]
    v_pk_mul_f32 v[80:81], v[80:81], v[4:5] op_sel_hi:[1,0]
    v_pk_mul_f32 v[82:83], v[82:83], v[4:5] op_sel_hi:[1,0]
    v_pk_mul_f32 v[84:85], v[84:85], v[4:5] op_sel_hi:[1,0]
    v_pk_mul_f32 v[86:87], v[86:87], v[4:5] op_sel_hi:[1,0]
    v_pk_mul_f32 v[88:89], v[88:89], v[4:5] op_sel_hi:[1,0]
    v_pk_mul_f32 v[90:91], v[90:91], v[4:5] op_sel_hi:[1,0]
    v_pk_mul_f32 v[92:93], v[92:93], v[4:5] op_sel_hi:[1,0]
    v_pk_mul_f32 v[94:95], v[94:95], v[4:5] op_sel_hi:[1,0]
    v_cvt_pk_bf16_f32 v64, v64, v65
    v_cvt_pk_bf16_f32 v65, v66, v67
    v_cvt_pk_bf16_f32 v66, v68, v69
    v_cvt_pk_bf16_f32 v67, v70, v71
    buffer_store_dwordx4 v[64:67], v1, s[4:7], s38 offen offset:0 sc0 sc1
    v_cvt_pk_bf16_f32 v72, v72, v73
    v_cvt_pk_bf16_f32 v73, v74, v75
    v_cvt_pk_bf16_f32 v74, v76, v77
    v_cvt_pk_bf16_f32 v75, v78, v79
    buffer_store_dwordx4 v[72:75], v1, s[4:7], s38 offen offset:1024 sc0 sc1
    v_cvt_pk_bf16_f32 v80, v80, v81
    v_cvt_pk_bf16_f32 v81, v82, v83
    v_cvt_pk_bf16_f32 v82, v84, v85
    v_cvt_pk_bf16_f32 v83, v86, v87
    buffer_store_dwordx4 v[80:83], v1, s[4:7], s38 offen offset:2048 sc0 sc1
    v_cvt_pk_bf16_f32 v88, v88, v89
    v_cvt_pk_bf16_f32 v89, v90, v91
    v_cvt_pk_bf16_f32 v90, v92, v93
    v_cvt_pk_bf16_f32 v91, v94, v95
    buffer_store_dwordx4 v[88:91], v1, s[4:7], s38 offen offset:3072 sc0 sc1
    s_add_u32 s64, s64, 1
    s_waitcnt vmcnt(0)
    s_barrier
    v_mov_b32 v255, s64
    buffer_store_dword v255, off, s[4:7], s63 sc0 sc1
    s_add_u32 s33, s33, s34
    s_cmp_lt_u32 s33, s65
    s_cbranch_scc1 AL_task
    s_endpgm
L_wo:
    s_sub_u32 s33, s31, 32
    s_and_b32 s32, s33, 15
    s_lshr_b32 s33, s33, 4
    s_mov_b32 s34, 8
    s_load_dwordx2 s[8:9], s[0:1], 112
    s_waitcnt lgkmcnt(0)
    s_mov_b32 s10, 4194304
    s_mov_b32 s11, 0x20000
    s_load_dwordx2 s[12:13], s[0:1], 128
    s_waitcnt lgkmcnt(0)
    s_mov_b32 s14, 8388608
    s_mov_b32 s15, 0x20000
    v_lshlrev_b32 v1, 4, v0
    v_and_b32 v20, 15, v0
    v_lshrrev_b32 v21, 4, v0
    v_bfe_u32 v22, v0, 2, 2
    v_and_b32 v23, 3, v0
    v_bfe_u32 v24, v0, 4, 1
    v_lshlrev_b32 v24, 1, v24
    v_xor_b32 v24, v24, v23
    v_lshlrev_b32 v24, 4, v24
    v_lshrrev_b32 v25, 2, v0
    v_lshl_add_u32 v24, v25, 10, v24
    s_lshl_b32 s45, s30, 20
    s_lshl_b32 s46, s32, 6
    s_add_u32 s45, s45, s46
    v_add_u32 v2, s45, v24
    v_lshl_add_u32 v24, v21, 2, v22
    v_lshlrev_b32 v24, 6, v24
    v_bfe_u32 v25, v0, 4, 1
    v_lshlrev_b32 v25, 1, v25
    v_lshrrev_b32 v26, 1, v23
    v_xor_b32 v25, v25, v26
    v_lshl_add_u32 v24, v25, 4, v24
    v_and_b32 v25, 1, v23
    v_lshl_add_u32 v24, v25, 3, v24
    s_lshl_b32 s45, s30, 15
    v_add_u32 v3, s45, v24
    v_xor_b32 v7, 32, v3
    s_lshl_b32 s45, s30, 11
    s_add_u32 s45, s45, 131072
    v_add_u32 v4, s45, v1
    s_and_b32 s45, s30, 1
    s_lshl_b32 s45, s45, 10
    s_add_u32 s45, s45, 131072
    v_add_u32 v5, s45, v1
    v_lshlrev_b32 v24, 12, v20
    v_lshl_add_u32 v24, v21, 4, v24
    s_lshl_b32 s45, s32, 7
    s_and_b32 s46, s30, 1
    s_lshl_b32 s46, s46, 6
    s_add_u32 s45, s45, s46
    s_add_u32 s45, s45, 2048
    v_add_u32 v6, s45, v24
    s_lshl_b32 s45, s30, 15
    s_add_u32 m0, s45, 0
    s_mov_b32 s47, 0
    buffer_load_dwordx4 v2, s[8:11], s47 offen lds
    s_lshl_b32 s45, s30, 15
    s_add_u32 m0, s45, 1024
    s_mov_b32 s47, 16384
    buffer_load_dwordx4 v2, s[8:11], s47 offen lds
    s_lshl_b32 s45, s30, 15
    s_add_u32 m0, s45, 2048
    s_mov_b32 s47, 32768
    buffer_load_dwordx4 v2, s[8:11], s47 offen lds
    s_lshl_b32 s45, s30, 15
    s_add_u32 m0, s45, 3072
    s_mov_b32 s47, 49152
    buffer_load_dwordx4 v2, s[8:11], s47 offen lds
    s_lshl_b32 s45, s30, 15
    s_add_u32 m0, s45, 4096
    s_mov_b32 s47, 65536
    buffer_load_dwordx4 v2, s[8:11], s47 offen lds
    s_lshl_b32 s45, s30, 15
    s_add_u32 m0, s45, 5120
    s_mov_b32 s47, 81920
    buffer_load_dwordx4 v2, s[8:11], s47 offen lds
    s_lshl_b32 s45, s30, 15
    s_add_u32 m0, s45, 6144
    s_mov_b32 s47, 98304
    buffer_load_dwordx4 v2, s[8:11], s47 offen lds
    s_lshl_b32 s45, s30, 15
    s_add_u32 m0, s45, 7168
    s_mov_b32 s47, 114688
    buffer_load_dwordx4 v2, s[8:11], s47 offen lds
    s_lshl_b32 s45, s30, 15
    s_add_u32 m0, s45, 8192
    s_mov_b32 s47, 131072
    buffer_load_dwordx4 v2, s[8:11], s47 offen lds
    s_lshl_b32 s45, s30, 15
    s_add_u32 m0, s45, 9216
    s_mov_b32 s47, 147456
    buffer_load_dwordx4 v2, s[8:11], s47 offen lds
    s_lshl_b32 s45, s30, 15
    s_add_u32 m0, s45, 10240
    s_mov_b32 s47, 163840
    buffer_load_dwordx4 v2, s[8:11], s47 offen lds
    s_lshl_b32 s45, s30, 15
    s_add_u32 m0, s45, 11264
    s_mov_b32 s47, 180224
    buffer_load_dwordx4 v2, s[8:11], s47 offen lds
    s_lshl_b32 s45, s30, 15
    s_add_u32 m0, s45, 12288
    s_mov_b32 s47, 196608
    buffer_load_dwordx4 v2, s[8:11], s47 offen lds
    s_lshl_b32 s45, s30, 15
    s_add_u32 m0, s45, 13312
    s_mov_b32 s47, 212992
    buffer_load_dwordx4 v2, s[8:11], s47 offen lds
    s_lshl_b32 s45, s30, 15
    s_add_u32 m0, s45, 14336
    s_mov_b32 s47, 229376
    buffer_load_dwordx4 v2, s[8:11], s47 offen lds
    s_lshl_b32 s45, s30, 15
    s_add_u32 m0, s45, 15360
    s_mov_b32 s47, 245760
    buffer_load_dwordx4 v2, s[8:11], s47 offen lds
    s_lshl_b32 s45, s30, 15
    s_add_u32 m0, s45, 16384
    s_mov_b32 s47, 262144
    buffer_load_dwordx4 v2, s[8:11], s47 offen lds
    s_lshl_b32 s45, s30, 15
    s_add_u32 m0, s45, 17408
    s_mov_b32 s47, 278528
    buffer_load_dwordx4 v2, s[8:11], s47 offen lds
    s_lshl_b32 s45, s30, 15
    s_add_u32 m0, s45, 18432
    s_mov_b32 s47, 294912
    buffer_load_dwordx4 v2, s[8:11], s47 offen lds
    s_lshl_b32 s45, s30, 15
    s_add_u32 m0, s45, 19456
    s_mov_b32 s47, 311296
    buffer_load_dwordx4 v2, s[8:11], s47 offen lds
    s_lshl_b32 s45, s30, 15
    s_add_u32 m0, s45, 20480
    s_mov_b32 s47, 327680
    buffer_load_dwordx4 v2, s[8:11], s47 offen lds
    s_lshl_b32 s45, s30, 15
    s_add_u32 m0, s45, 21504
    s_mov_b32 s47, 344064
    buffer_load_dwordx4 v2, s[8:11], s47 offen lds
    s_lshl_b32 s45, s30, 15
    s_add_u32 m0, s45, 22528
    s_mov_b32 s47, 360448
    buffer_load_dwordx4 v2, s[8:11], s47 offen lds
    s_lshl_b32 s45, s30, 15
    s_add_u32 m0, s45, 23552
    s_mov_b32 s47, 376832
    buffer_load_dwordx4 v2, s[8:11], s47 offen lds
    s_lshl_b32 s45, s30, 15
    s_add_u32 m0, s45, 24576
    s_mov_b32 s47, 393216
    buffer_load_dwordx4 v2, s[8:11], s47 offen lds
    s_lshl_b32 s45, s30, 15
    s_add_u32 m0, s45, 25600
    s_mov_b32 s47, 409600
    buffer_load_dwordx4 v2, s[8:11], s47 offen lds
    s_lshl_b32 s45, s30, 15
    s_add_u32 m0, s45, 26624
    s_mov_b32 s47, 425984
    buffer_load_dwordx4 v2, s[8:11], s47 offen lds
    s_lshl_b32 s45, s30, 15
    s_add_u32 m0, s45, 27648
    s_mov_b32 s47, 442368
    buffer_load_dwordx4 v2, s[8:11], s47 offen lds
    s_lshl_b32 s45, s30, 15
    s_add_u32 m0, s45, 28672
    s_mov_b32 s47, 458752
    buffer_load_dwordx4 v2, s[8:11], s47 offen lds
    s_lshl_b32 s45, s30, 15
    s_add_u32 m0, s45, 29696
    s_mov_b32 s47, 475136
    buffer_load_dwordx4 v2, s[8:11], s47 offen lds
    s_lshl_b32 s45, s30, 15
    s_add_u32 m0, s45, 30720
    s_mov_b32 s47, 491520
    buffer_load_dwordx4 v2, s[8:11], s47 offen lds
    s_lshl_b32 s45, s30, 15
    s_add_u32 m0, s45, 31744
    s_mov_b32 s47, 507904
    buffer_load_dwordx4 v2, s[8:11], s47 offen lds
    s_waitcnt vmcnt(0)
    ds_read_b64_tr_b16 a[0:1], v3 offset:0
    ds_read_b64_tr_b16 a[2:3], v3 offset:1024
    ds_read_b64_tr_b16 a[128:129], v7 offset:0
    ds_read_b64_tr_b16 a[130:131], v7 offset:1024
    s_waitcnt lgkmcnt(8)
    ds_read_b64_tr_b16 a[4:5], v3 offset:2048
    ds_read_b64_tr_b16 a[6:7], v3 offset:3072
    ds_read_b64_tr_b16 a[132:133], v7 offset:2048
    ds_read_b64_tr_b16 a[134:135], v7 offset:3072
    s_waitcnt lgkmcnt(8)
    ds_read_b64_tr_b16 a[8:9], v3 offset:4096
    ds_read_b64_tr_b16 a[10:11], v3 offset:5120
    ds_read_b64_tr_b16 a[136:137], v7 offset:4096
    ds_read_b64_tr_b16 a[138:139], v7 offset:5120
    s_waitcnt lgkmcnt(8)
    ds_read_b64_tr_b16 a[12:13], v3 offset:6144
    ds_read_b64_tr_b16 a[14:15], v3 offset:7168
    ds_read_b64_tr_b16 a[140:141], v7 offset:6144
    ds_read_b64_tr_b16 a[142:143], v7 offset:7168
    s_waitcnt lgkmcnt(8)
    ds_read_b64_tr_b16 a[16:17], v3 offset:8192
    ds_read_b64_tr_b16 a[18:19], v3 offset:9216
    ds_read_b64_tr_b16 a[144:145], v7 offset:8192
    ds_read_b64_tr_b16 a[146:147], v7 offset:9216
    s_waitcnt lgkmcnt(8)
    ds_read_b64_tr_b16 a[20:21], v3 offset:10240
    ds_read_b64_tr_b16 a[22:23], v3 offset:11264
    ds_read_b64_tr_b16 a[148:149], v7 offset:10240
    ds_read_b64_tr_b16 a[150:151], v7 offset:11264
    s_waitcnt lgkmcnt(8)
    ds_read_b64_tr_b16 a[24:25], v3 offset:12288
    ds_read_b64_tr_b16 a[26:27], v3 offset:13312
    ds_read_b64_tr_b16 a[152:153], v7 offset:12288
    ds_read_b64_tr_b16 a[154:155], v7 offset:13312
    s_waitcnt lgkmcnt(8)
    ds_read_b64_tr_b16 a[28:29], v3 offset:14336
    ds_read_b64_tr_b16 a[30:31], v3 offset:15360
    ds_read_b64_tr_b16 a[156:157], v7 offset:14336
    ds_read_b64_tr_b16 a[158:159], v7 offset:15360
    s_waitcnt lgkmcnt(8)
    ds_read_b64_tr_b16 a[32:33], v3 offset:16384
    ds_read_b64_tr_b16 a[34:35], v3 offset:17408
    ds_read_b64_tr_b16 a[160:161], v7 offset:16384
    ds_read_b64_tr_b16 a[162:163], v7 offset:17408
    s_waitcnt lgkmcnt(8)
    ds_read_b64_tr_b16 a[36:37], v3 offset:18432
    ds_read_b64_tr_b16 a[38:39], v3 offset:19456
    ds_read_b64_tr_b16 a[164:165], v7 offset:18432
    ds_read_b64_tr_b16 a[166:167], v7 offset:19456
    s_waitcnt lgkmcnt(8)
    ds_read_b64_tr_b16 a[40:41], v3 offset:20480
    ds_read_b64_tr_b16 a[42:43], v3 offset:21504
    ds_read_b64_tr_b16 a[168:169], v7 offset:20480
    ds_read_b64_tr_b16 a[170:171], v7 offset:21504
    s_waitcnt lgkmcnt(8)
    ds_read_b64_tr_b16 a[44:45], v3 offset:22528
    ds_read_b64_tr_b16 a[46:47], v3 offset:23552
    ds_read_b64_tr_b16 a[172:173], v7 offset:22528
    ds_read_b64_tr_b16 a[174:175], v7 offset:23552
    s_waitcnt lgkmcnt(8)
    ds_read_b64_tr_b16 a[48:49], v3 offset:24576
    ds_read_b64_tr_b16 a[50:51], v3 offset:25600
    ds_read_b64_tr_b16 a[176:177], v7 offset:24576
    ds_read_b64_tr_b16 a[178:179], v7 offset:25600
    s_waitcnt lgkmcnt(8)
    ds_read_b64_tr_b16 a[52:53], v3 offset:26624
    ds_read_b64_tr_b16 a[54:55], v3 offset:27648
    ds_read_b64_tr_b16 a[180:181], v7 offset:26624
    ds_read_b64_tr_b16 a[182:183], v7 offset:27648
    s_waitcnt lgkmcnt(8)
    ds_read_b64_tr_b16 a[56:57], v3 offset:28672
    ds_read_b64_tr_b16 a[58:59], v3 offset:29696
    ds_read_b64_tr_b16 a[184:185], v7 offset:28672
    ds_read_b64_tr_b16 a[186:187], v7 offset:29696
    s_waitcnt lgkmcnt(8)
    ds_read_b64_tr_b16 a[60:61], v3 offset:30720
    ds_read_b64_tr_b16 a[62:63], v3 offset:31744
    ds_read_b64_tr_b16 a[188:189], v7 offset:30720
    ds_read_b64_tr_b16 a[190:191], v7 offset:31744
    s_waitcnt lgkmcnt(8)
    s_waitcnt lgkmcnt(0)
    s_lshl_b32 s45, s30, 15
    s_add_u32 m0, s45, 0
    s_mov_b32 s47, 524288
    buffer_load_dwordx4 v2, s[8:11], s47 offen lds
    s_lshl_b32 s45, s30, 15
    s_add_u32 m0, s45, 1024
    s_mov_b32 s47, 540672
    buffer_load_dwordx4 v2, s[8:11], s47 offen lds
    s_lshl_b32 s45, s30, 15
    s_add_u32 m0, s45, 2048
    s_mov_b32 s47, 557056
    buffer_load_dwordx4 v2, s[8:11], s47 offen lds
    s_lshl_b32 s45, s30, 15
    s_add_u32 m0, s45, 3072
    s_mov_b32 s47, 573440
    buffer_load_dwordx4 v2, s[8:11], s47 offen lds
    s_lshl_b32 s45, s30, 15
    s_add_u32 m0, s45, 4096
    s_mov_b32 s47, 589824
    buffer_load_dwordx4 v2, s[8:11], s47 offen lds
    s_lshl_b32 s45, s30, 15
    s_add_u32 m0, s45, 5120
    s_mov_b32 s47, 606208
    buffer_load_dwordx4 v2, s[8:11], s47 offen lds
    s_lshl_b32 s45, s30, 15
    s_add_u32 m0, s45, 6144
    s_mov_b32 s47, 622592
    buffer_load_dwordx4 v2, s[8:11], s47 offen lds
    s_lshl_b32 s45, s30, 15
    s_add_u32 m0, s45, 7168
    s_mov_b32 s47, 638976
    buffer_load_dwordx4 v2, s[8:11], s47 offen lds
    s_lshl_b32 s45, s30, 15
    s_add_u32 m0, s45, 8192
    s_mov_b32 s47, 655360
    buffer_load_dwordx4 v2, s[8:11], s47 offen lds
    s_lshl_b32 s45, s30, 15
    s_add_u32 m0, s45, 9216
    s_mov_b32 s47, 671744
    buffer_load_dwordx4 v2, s[8:11], s47 offen lds
    s_lshl_b32 s45, s30, 15
    s_add_u32 m0, s45, 10240
    s_mov_b32 s47, 688128
    buffer_load_dwordx4 v2, s[8:11], s47 offen lds
    s_lshl_b32 s45, s30, 15
    s_add_u32 m0, s45, 11264
    s_mov_b32 s47, 704512
    buffer_load_dwordx4 v2, s[8:11], s47 offen lds
    s_lshl_b32 s45, s30, 15
    s_add_u32 m0, s45, 12288
    s_mov_b32 s47, 720896
    buffer_load_dwordx4 v2, s[8:11], s47 offen lds
    s_lshl_b32 s45, s30, 15
    s_add_u32 m0, s45, 13312
    s_mov_b32 s47, 737280
    buffer_load_dwordx4 v2, s[8:11], s47 offen lds
    s_lshl_b32 s45, s30, 15
    s_add_u32 m0, s45, 14336
    s_mov_b32 s47, 753664
    buffer_load_dwordx4 v2, s[8:11], s47 offen lds
    s_lshl_b32 s45, s30, 15
    s_add_u32 m0, s45, 15360
    s_mov_b32 s47, 770048
    buffer_load_dwordx4 v2, s[8:11], s47 offen lds
    s_lshl_b32 s45, s30, 15
    s_add_u32 m0, s45, 16384
    s_mov_b32 s47, 786432
    buffer_load_dwordx4 v2, s[8:11], s47 offen lds
    s_lshl_b32 s45, s30, 15
    s_add_u32 m0, s45, 17408
    s_mov_b32 s47, 802816
    buffer_load_dwordx4 v2, s[8:11], s47 offen lds
    s_lshl_b32 s45, s30, 15
    s_add_u32 m0, s45, 18432
    s_mov_b32 s47, 819200
    buffer_load_dwordx4 v2, s[8:11], s47 offen lds
    s_lshl_b32 s45, s30, 15
    s_add_u32 m0, s45, 19456
    s_mov_b32 s47, 835584
    buffer_load_dwordx4 v2, s[8:11], s47 offen lds
    s_lshl_b32 s45, s30, 15
    s_add_u32 m0, s45, 20480
    s_mov_b32 s47, 851968
    buffer_load_dwordx4 v2, s[8:11], s47 offen lds
    s_lshl_b32 s45, s30, 15
    s_add_u32 m0, s45, 21504
    s_mov_b32 s47, 868352
    buffer_load_dwordx4 v2, s[8:11], s47 offen lds
    s_lshl_b32 s45, s30, 15
    s_add_u32 m0, s45, 22528
    s_mov_b32 s47, 884736
    buffer_load_dwordx4 v2, s[8:11], s47 offen lds
    s_lshl_b32 s45, s30, 15
    s_add_u32 m0, s45, 23552
    s_mov_b32 s47, 901120
    buffer_load_dwordx4 v2, s[8:11], s47 offen lds
    s_lshl_b32 s45, s30, 15
    s_add_u32 m0, s45, 24576
    s_mov_b32 s47, 917504
    buffer_load_dwordx4 v2, s[8:11], s47 offen lds
    s_lshl_b32 s45, s30, 15
    s_add_u32 m0, s45, 25600
    s_mov_b32 s47, 933888
    buffer_load_dwordx4 v2, s[8:11], s47 offen lds
    s_lshl_b32 s45, s30, 15
    s_add_u32 m0, s45, 26624
    s_mov_b32 s47, 950272
    buffer_load_dwordx4 v2, s[8:11], s47 offen lds
    s_lshl_b32 s45, s30, 15
    s_add_u32 m0, s45, 27648
    s_mov_b32 s47, 966656
    buffer_load_dwordx4 v2, s[8:11], s47 offen lds
    s_lshl_b32 s45, s30, 15
    s_add_u32 m0, s45, 28672
    s_mov_b32 s47, 983040
    buffer_load_dwordx4 v2, s[8:11], s47 offen lds
    s_lshl_b32 s45, s30, 15
    s_add_u32 m0, s45, 29696
    s_mov_b32 s47, 999424
    buffer_load_dwordx4 v2, s[8:11], s47 offen lds
    s_lshl_b32 s45, s30, 15
    s_add_u32 m0, s45, 30720
    s_mov_b32 s47, 1015808
    buffer_load_dwordx4 v2, s[8:11], s47 offen lds
    s_lshl_b32 s45, s30, 15
    s_add_u32 m0, s45, 31744
    s_mov_b32 s47, 1032192
    buffer_load_dwordx4 v2, s[8:11], s47 offen lds
    s_waitcnt vmcnt(0)
    ds_read_b64_tr_b16 a[64:65], v3 offset:0
    ds_read_b64_tr_b16 a[66:67], v3 offset:1024
    ds_read_b64_tr_b16 a[192:193], v7 offset:0
    ds_read_b64_tr_b16 a[194:195], v7 offset:1024
    s_waitcnt lgkmcnt(8)
    ds_read_b64_tr_b16 a[68:69], v3 offset:2048
    ds_read_b64_tr_b16 a[70:71], v3 offset:3072
    ds_read_b64_tr_b16 a[196:197], v7 offset:2048
    ds_read_b64_tr_b16 a[198:199], v7 offset:3072
    s_waitcnt lgkmcnt(8)
    ds_read_b64_tr_b16 a[72:73], v3 offset:4096
    ds_read_b64_tr_b16 a[74:75], v3 offset:5120
    ds_read_b64_tr_b16 a[200:201], v7 offset:4096
    ds_read_b64_tr_b16 a[202:203], v7 offset:5120
    s_waitcnt lgkmcnt(8)
    ds_read_b64_tr_b16 a[76:77], v3 offset:6144
    ds_read_b64_tr_b16 a[78:79], v3 offset:7168
    ds_read_b64_tr_b16 a[204:205], v7 offset:6144
    ds_read_b64_tr_b16 a[206:207], v7 offset:7168
    s_waitcnt lgkmcnt(8)
    ds_read_b64_tr_b16 a[80:81], v3 offset:8192
    ds_read_b64_tr_b16 a[82:83], v3 offset:9216
    ds_read_b64_tr_b16 a[208:209], v7 offset:8192
    ds_read_b64_tr_b16 a[210:211], v7 offset:9216
    s_waitcnt lgkmcnt(8)
    ds_read_b64_tr_b16 a[84:85], v3 offset:10240
    ds_read_b64_tr_b16 a[86:87], v3 offset:11264
    ds_read_b64_tr_b16 a[212:213], v7 offset:10240
    ds_read_b64_tr_b16 a[214:215], v7 offset:11264
    s_waitcnt lgkmcnt(8)
    ds_read_b64_tr_b16 a[88:89], v3 offset:12288
    ds_read_b64_tr_b16 a[90:91], v3 offset:13312
    ds_read_b64_tr_b16 a[216:217], v7 offset:12288
    ds_read_b64_tr_b16 a[218:219], v7 offset:13312
    s_waitcnt lgkmcnt(8)
    ds_read_b64_tr_b16 a[92:93], v3 offset:14336
    ds_read_b64_tr_b16 a[94:95], v3 offset:15360
    ds_read_b64_tr_b16 a[220:221], v7 offset:14336
    ds_read_b64_tr_b16 a[222:223], v7 offset:15360
    s_waitcnt lgkmcnt(8)
    ds_read_b64_tr_b16 a[96:97], v3 offset:16384
    ds_read_b64_tr_b16 a[98:99], v3 offset:17408
    ds_read_b64_tr_b16 a[224:225], v7 offset:16384
    ds_read_b64_tr_b16 a[226:227], v7 offset:17408
    s_waitcnt lgkmcnt(8)
    ds_read_b64_tr_b16 a[100:101], v3 offset:18432
    ds_read_b64_tr_b16 a[102:103], v3 offset:19456
    ds_read_b64_tr_b16 a[228:229], v7 offset:18432
    ds_read_b64_tr_b16 a[230:231], v7 offset:19456
    s_waitcnt lgkmcnt(8)
    ds_read_b64_tr_b16 a[104:105], v3 offset:20480
    ds_read_b64_tr_b16 a[106:107], v3 offset:21504
    ds_read_b64_tr_b16 a[232:233], v7 offset:20480
    ds_read_b64_tr_b16 a[234:235], v7 offset:21504
    s_waitcnt lgkmcnt(8)
    ds_read_b64_tr_b16 a[108:109], v3 offset:22528
    ds_read_b64_tr_b16 a[110:111], v3 offset:23552
    ds_read_b64_tr_b16 a[236:237], v7 offset:22528
    ds_read_b64_tr_b16 a[238:239], v7 offset:23552
    s_waitcnt lgkmcnt(8)
    ds_read_b64_tr_b16 a[112:113], v3 offset:24576
    ds_read_b64_tr_b16 a[114:115], v3 offset:25600
    ds_read_b64_tr_b16 a[240:241], v7 offset:24576
    ds_read_b64_tr_b16 a[242:243], v7 offset:25600
    s_waitcnt lgkmcnt(8)
    ds_read_b64_tr_b16 a[116:117], v3 offset:26624
    ds_read_b64_tr_b16 a[118:119], v3 offset:27648
    ds_read_b64_tr_b16 a[244:245], v7 offset:26624
    ds_read_b64_tr_b16 a[246:247], v7 offset:27648
    s_waitcnt lgkmcnt(8)
    ds_read_b64_tr_b16 a[120:121], v3 offset:28672
    ds_read_b64_tr_b16 a[122:123], v3 offset:29696
    ds_read_b64_tr_b16 a[248:249], v7 offset:28672
    ds_read_b64_tr_b16 a[250:251], v7 offset:29696
    s_waitcnt lgkmcnt(8)
    ds_read_b64_tr_b16 a[124:125], v3 offset:30720
    ds_read_b64_tr_b16 a[126:127], v3 offset:31744
    ds_read_b64_tr_b16 a[252:253], v7 offset:30720
    ds_read_b64_tr_b16 a[254:255], v7 offset:31744
    s_waitcnt lgkmcnt(8)
    s_waitcnt lgkmcnt(0)
    s_mov_b32 s40, 0
    v_mov_b64 v[128:129], 0
    v_mov_b64 v[130:131], 0
    v_mov_b64 v[132:133], 0
    v_mov_b64 v[134:135], 0
    v_mov_b64 v[136:137], 0
    v_mov_b64 v[138:139], 0
    v_mov_b64 v[140:141], 0
    v_mov_b64 v[142:143], 0
    v_mov_b64 v[144:145], 0
    v_mov_b64 v[146:147], 0
    v_mov_b64 v[148:149], 0
    v_mov_b64 v[150:151], 0
    v_mov_b64 v[152:153], 0
    v_mov_b64 v[154:155], 0
    v_mov_b64 v[156:157], 0
    v_mov_b64 v[158:159], 0
    v_mov_b64 v[160:161], 0
    v_mov_b64 v[162:163], 0
    v_mov_b64 v[164:165], 0
    v_mov_b64 v[166:167], 0
    v_mov_b64 v[168:169], 0
    v_mov_b64 v[170:171], 0
    v_mov_b64 v[172:173], 0
    v_mov_b64 v[174:175], 0
    v_mov_b64 v[176:177], 0
    v_mov_b64 v[178:179], 0
    v_mov_b64 v[180:181], 0
    v_mov_b64 v[182:183], 0
    v_mov_b64 v[184:185], 0
    v_mov_b64 v[186:187], 0
    v_mov_b64 v[188:189], 0
    v_mov_b64 v[190:191], 0
    v_mov_b64 v[192:193], 0
    v_mov_b64 v[194:195], 0
    v_mov_b64 v[196:197], 0
    v_mov_b64 v[198:199], 0
    v_mov_b64 v[200:201], 0
    v_mov_b64 v[202:203], 0
    v_mov_b64 v[204:205], 0
    v_mov_b64 v[206:207], 0
    v_mov_b64 v[208:209], 0
    v_mov_b64 v[210:211], 0
    v_mov_b64 v[212:213], 0
    v_mov_b64 v[214:215], 0
    v_mov_b64 v[216:217], 0
    v_mov_b64 v[218:219], 0
    v_mov_b64 v[220:221], 0
    v_mov_b64 v[222:223], 0
    v_mov_b64 v[224:225], 0
    v_mov_b64 v[226:227], 0
    v_mov_b64 v[228:229], 0
    v_mov_b64 v[230:231], 0
    v_mov_b64 v[232:233], 0
    v_mov_b64 v[234:235], 0
    v_mov_b64 v[236:237], 0
    v_mov_b64 v[238:239], 0
    v_mov_b64 v[240:241], 0
    v_mov_b64 v[242:243], 0
    v_mov_b64 v[244:245], 0
    v_mov_b64 v[246:247], 0
    v_mov_b64 v[248:249], 0
    v_mov_b64 v[250:251], 0
    v_mov_b64 v[252:253], 0
    v_mov_b64 v[254:255], 0
    s_nop 1
OL_task:
    s_lshl_b32 s35, s33, 17
    s_lshl_b32 s45, s30, 15
    s_add_u32 s35, s35, s45
    s_add_u32 s35, s35, 70254592
    s_lshl_b32 s36, s33, 16
    s_lshr_b32 s61, s33, 3
    s_add_u32 s61, s61, 1
    s_lshr_b32 s60, s33, 1
    s_sub_u32 s45, s60, 58
    s_cmp_ge_u32 s60, 62
    s_cselect_b32 s45, s45, 0
    s_cselect_b32 s60, 0, s60
    s_and_b32 s60, s60, 3
    s_add_u32 s60, s60, s45
    s_lshl_b32 s60, s60, 7
    s_add_u32 s60, s60, 1838080
    s_cmp_lg_u32 s30, 0
    s_cbranch_scc1 L_wb8
    v_lshlrev_b32 v254, 2, v0
    s_mov_b64 exec, 255
    s_mov_b32 s62, 0
L_w8:
    buffer_load_dword v255, v254, s[4:7], s60 offen sc1
    s_add_u32 s62, s62, 1
    s_cmp_gt_u32 s62, 2000000
    s_cbranch_scc1 L_end
    s_waitcnt vmcnt(0)
    v_cmp_gt_u32 vcc, s61, v255
    s_nop 0
    s_cbranch_vccz L_wd8
    s_sleep 4
    v_add_u32 v255, 1, v255
    v_cmp_gt_u32 vcc, s61, v255
    s_nop 0
    s_cbranch_vccz L_w8
    s_sleep 36
    s_branch L_w8
    s_nop 0
L_wd8:
    s_mov_b64 exec, -1
L_wb8:
    s_barrier
    s_mov_b64 s[38:39], -1
    s_cmp_lt_u32 s33, 126
    s_cbranch_scc1 OL_full
    s_mov_b32 s38, 0x00ff00ff
    s_mov_b32 s39, 0x00ff00ff
    s_cmp_eq_u32 s40, 0
    s_cbranch_scc1 OL_full
    s_not_b64 s[38:39], s[38:39]
OL_full:
    s_mov_b64 exec, s[38:39]
    buffer_load_dwordx4 v[128:131], v1, s[4:7], s35 offen offset:0 sc1
    buffer_load_dwordx4 v[132:135], v1, s[4:7], s35 offen offset:1024 sc1
    buffer_load_dwordx4 v[136:139], v1, s[4:7], s35 offen offset:2048 sc1
    buffer_load_dwordx4 v[140:143], v1, s[4:7], s35 offen offset:3072 sc1
    s_add_u32 s35, s35, 4096
    buffer_load_dwordx4 v[144:147], v1, s[4:7], s35 offen offset:0 sc1
    buffer_load_dwordx4 v[148:151], v1, s[4:7], s35 offen offset:1024 sc1
    buffer_load_dwordx4 v[152:155], v1, s[4:7], s35 offen offset:2048 sc1
    buffer_load_dwordx4 v[156:159], v1, s[4:7], s35 offen offset:3072 sc1
    s_add_u32 s35, s35, 4096
    buffer_load_dwordx4 v[160:163], v1, s[4:7], s35 offen offset:0 sc1
    buffer_load_dwordx4 v[164:167], v1, s[4:7], s35 offen offset:1024 sc1
    buffer_load_dwordx4 v[168:171], v1, s[4:7], s35 offen offset:2048 sc1
    buffer_load_dwordx4 v[172:175], v1, s[4:7], s35 offen offset:3072 sc1
    s_add_u32 s35, s35, 4096
    buffer_load_dwordx4 v[176:179], v1, s[4:7], s35 offen offset:0 sc1
    buffer_load_dwordx4 v[180:183], v1, s[4:7], s35 offen offset:1024 sc1
    buffer_load_dwordx4 v[184:187], v1, s[4:7], s35 offen offset:2048 sc1
    buffer_load_dwordx4 v[188:191], v1, s[4:7], s35 offen offset:3072 sc1
    s_add_u32 s35, s35, 4096
    buffer_load_dwordx4 v[192:195], v1, s[4:7], s35 offen offset:0 sc1
    buffer_load_dwordx4 v[196:199], v1, s[4:7], s35 offen offset:1024 sc1
    buffer_load_dwordx4 v[200:203], v1, s[4:7], s35 offen offset:2048 sc1
    buffer_load_dwordx4 v[204:207], v1, s[4:7], s35 offen offset:3072 sc1
    s_add_u32 s35, s35, 4096
    buffer_load_dwordx4 v[208:211], v1, s[4:7], s35 offen offset:0 sc1
    buffer_load_dwordx4 v[212:215], v1, s[4:7], s35 offen offset:1024 sc1
    buffer_load_dwordx4 v[216:219], v1, s[4:7], s35 offen offset:2048 sc1
    buffer_load_dwordx4 v[220:223], v1, s[4:7], s35 offen offset:3072 sc1
    s_add_u32 s35, s35, 4096
    buffer_load_dwordx4 v[224:227], v1, s[4:7], s35 offen offset:0 sc1
    buffer_load_dwordx4 v[228:231], v1, s[4:7], s35 offen offset:1024 sc1
    buffer_load_dwordx4 v[232:235], v1, s[4:7], s35 offen offset:2048 sc1
    buffer_load_dwordx4 v[236:239], v1, s[4:7], s35 offen offset:3072 sc1
    s_add_u32 s35, s35, 4096
    buffer_load_dwordx4 v[240:243], v1, s[4:7], s35 offen offset:0 sc1
    buffer_load_dwordx4 v[244:247], v1, s[4:7], s35 offen offset:1024 sc1
    buffer_load_dwordx4 v[248:251], v1, s[4:7], s35 offen offset:2048 sc1
    buffer_load_dwordx4 v[252:255], v1, s[4:7], s35 offen offset:3072 sc1
    s_mov_b64 exec, -1
    s_waitcnt vmcnt(31)
    v_mfma_f32_16x16x32_bf16 v[8:11], a[0:3], v[128:131], 0
    v_mfma_f32_16x16x32_bf16 v[12:15], a[128:131], v[128:131], 0
    s_waitcnt vmcnt(30)
    v_mfma_f32_16x16x32_bf16 v[8:11], a[4:7], v[132:135], v[8:11]
    v_mfma_f32_16x16x32_bf16 v[12:15], a[132:135], v[132:135], v[12:15]
    s_waitcnt vmcnt(29)
    v_mfma_f32_16x16x32_bf16 v[8:11], a[8:11], v[136:139], v[8:11]
    v_mfma_f32_16x16x32_bf16 v[12:15], a[136:139], v[136:139], v[12:15]
    s_waitcnt vmcnt(28)
    v_mfma_f32_16x16x32_bf16 v[8:11], a[12:15], v[140:143], v[8:11]
    v_mfma_f32_16x16x32_bf16 v[12:15], a[140:143], v[140:143], v[12:15]
    s_waitcnt vmcnt(27)
    v_mfma_f32_16x16x32_bf16 v[8:11], a[16:19], v[144:147], v[8:11]
    v_mfma_f32_16x16x32_bf16 v[12:15], a[144:147], v[144:147], v[12:15]
    s_waitcnt vmcnt(26)
    v_mfma_f32_16x16x32_bf16 v[8:11], a[20:23], v[148:151], v[8:11]
    v_mfma_f32_16x16x32_bf16 v[12:15], a[148:151], v[148:151], v[12:15]
    s_waitcnt vmcnt(25)
    v_mfma_f32_16x16x32_bf16 v[8:11], a[24:27], v[152:155], v[8:11]
    v_mfma_f32_16x16x32_bf16 v[12:15], a[152:155], v[152:155], v[12:15]
    s_waitcnt vmcnt(24)
    v_mfma_f32_16x16x32_bf16 v[8:11], a[28:31], v[156:159], v[8:11]
    v_mfma_f32_16x16x32_bf16 v[12:15], a[156:159], v[156:159], v[12:15]
    s_waitcnt vmcnt(23)
    v_mfma_f32_16x16x32_bf16 v[8:11], a[32:35], v[160:163], v[8:11]
    v_mfma_f32_16x16x32_bf16 v[12:15], a[160:163], v[160:163], v[12:15]
    s_waitcnt vmcnt(22)
    v_mfma_f32_16x16x32_bf16 v[8:11], a[36:39], v[164:167], v[8:11]
    v_mfma_f32_16x16x32_bf16 v[12:15], a[164:167], v[164:167], v[12:15]
    s_waitcnt vmcnt(21)
    v_mfma_f32_16x16x32_bf16 v[8:11], a[40:43], v[168:171], v[8:11]
    v_mfma_f32_16x16x32_bf16 v[12:15], a[168:171], v[168:171], v[12:15]
    s_waitcnt vmcnt(20)
    v_mfma_f32_16x16x32_bf16 v[8:11], a[44:47], v[172:175], v[8:11]
    v_mfma_f32_16x16x32_bf16 v[12:15], a[172:175], v[172:175], v[12:15]
    s_waitcnt vmcnt(19)
    v_mfma_f32_16x16x32_bf16 v[8:11], a[48:51], v[176:179], v[8:11]
    v_mfma_f32_16x16x32_bf16 v[12:15], a[176:179], v[176:179], v[12:15]
    s_waitcnt vmcnt(18)
    v_mfma_f32_16x16x32_bf16 v[8:11], a[52:55], v[180:183], v[8:11]
    v_mfma_f32_16x16x32_bf16 v[12:15], a[180:183], v[180:183], v[12:15]
    s_waitcnt vmcnt(17)
    v_mfma_f32_16x16x32_bf16 v[8:11], a[56:59], v[184:187], v[8:11]
    v_mfma_f32_16x16x32_bf16 v[12:15], a[184:187], v[184:187], v[12:15]
    s_waitcnt vmcnt(16)
    v_mfma_f32_16x16x32_bf16 v[8:11], a[60:63], v[188:191], v[8:11]
    v_mfma_f32_16x16x32_bf16 v[12:15], a[188:191], v[188:191], v[12:15]
    s_waitcnt vmcnt(15)
    v_mfma_f32_16x16x32_bf16 v[8:11], a[64:67], v[192:195], v[8:11]
    v_mfma_f32_16x16x32_bf16 v[12:15], a[192:195], v[192:195], v[12:15]
    s_waitcnt vmcnt(14)
    v_mfma_f32_16x16x32_bf16 v[8:11], a[68:71], v[196:199], v[8:11]
    v_mfma_f32_16x16x32_bf16 v[12:15], a[196:199], v[196:199], v[12:15]
    s_waitcnt vmcnt(13)
    v_mfma_f32_16x16x32_bf16 v[8:11], a[72:75], v[200:203], v[8:11]
    v_mfma_f32_16x16x32_bf16 v[12:15], a[200:203], v[200:203], v[12:15]
    s_waitcnt vmcnt(12)
    v_mfma_f32_16x16x32_bf16 v[8:11], a[76:79], v[204:207], v[8:11]
    v_mfma_f32_16x16x32_bf16 v[12:15], a[204:207], v[204:207], v[12:15]
    s_waitcnt vmcnt(11)
    v_mfma_f32_16x16x32_bf16 v[8:11], a[80:83], v[208:211], v[8:11]
    v_mfma_f32_16x16x32_bf16 v[12:15], a[208:211], v[208:211], v[12:15]
    s_waitcnt vmcnt(10)
    v_mfma_f32_16x16x32_bf16 v[8:11], a[84:87], v[212:215], v[8:11]
    v_mfma_f32_16x16x32_bf16 v[12:15], a[212:215], v[212:215], v[12:15]
    s_waitcnt vmcnt(9)
    v_mfma_f32_16x16x32_bf16 v[8:11], a[88:91], v[216:219], v[8:11]
    v_mfma_f32_16x16x32_bf16 v[12:15], a[216:219], v[216:219], v[12:15]
    s_waitcnt vmcnt(8)
    v_mfma_f32_16x16x32_bf16 v[8:11], a[92:95], v[220:223], v[8:11]
    v_mfma_f32_16x16x32_bf16 v[12:15], a[220:223], v[220:223], v[12:15]
    s_waitcnt vmcnt(7)
    v_mfma_f32_16x16x32_bf16 v[8:11], a[96:99], v[224:227], v[8:11]
    v_mfma_f32_16x16x32_bf16 v[12:15], a[224:227], v[224:227], v[12:15]
    s_waitcnt vmcnt(6)
    v_mfma_f32_16x16x32_bf16 v[8:11], a[100:103], v[228:231], v[8:11]
    v_mfma_f32_16x16x32_bf16 v[12:15], a[228:231], v[228:231], v[12:15]
    s_waitcnt vmcnt(5)
    v_mfma_f32_16x16x32_bf16 v[8:11], a[104:107], v[232:235], v[8:11]
    v_mfma_f32_16x16x32_bf16 v[12:15], a[232:235], v[232:235], v[12:15]
    s_waitcnt vmcnt(4)
    v_mfma_f32_16x16x32_bf16 v[8:11], a[108:111], v[236:239], v[8:11]
    v_mfma_f32_16x16x32_bf16 v[12:15], a[236:239], v[236:239], v[12:15]
    s_waitcnt vmcnt(3)
    v_mfma_f32_16x16x32_bf16 v[8:11], a[112:115], v[240:243], v[8:11]
    v_mfma_f32_16x16x32_bf16 v[12:15], a[240:243], v[240:243], v[12:15]
    s_waitcnt vmcnt(2)
    v_mfma_f32_16x16x32_bf16 v[8:11], a[116:119], v[244:247], v[8:11]
    v_mfma_f32_16x16x32_bf16 v[12:15], a[244:247], v[244:247], v[12:15]
    s_waitcnt vmcnt(1)
    v_mfma_f32_16x16x32_bf16 v[8:11], a[120:123], v[248:251], v[8:11]
    v_mfma_f32_16x16x32_bf16 v[12:15], a[248:251], v[248:251], v[12:15]
    s_waitcnt vmcnt(0)
    v_mfma_f32_16x16x32_bf16 v[8:11], a[124:127], v[252:255], v[8:11]
    v_mfma_f32_16x16x32_bf16 v[12:15], a[252:255], v[252:255], v[12:15]
    s_barrier
    s_nop 3
    ds_write_b128 v4, v[8:11]
    s_nop 1
    ds_write_b128 v4, v[12:15] offset:1024
    s_waitcnt lgkmcnt(0)
    s_barrier
    s_cmp_ge_u32 s30, 2
    s_cbranch_scc1 OL_next
    ds_read_b128 v[16:19], v5 offset:0
    ds_read_b128 v[20:23], v5 offset:2048
    ds_read_b128 v[24:27], v5 offset:4096
    ds_read_b128 v[28:31], v5 offset:6144
    s_waitcnt lgkmcnt(0)
    v_add_f32 v16, v16, v20
    v_add_f32 v24, v24, v28
    v_add_f32 v17, v17, v21
    v_add_f32 v25, v25, v29
    v_add_f32 v18, v18, v22
    v_add_f32 v26, v26, v30
    v_add_f32 v19, v19, v23
    v_add_f32 v27, v27, v31
    v_add_f32 v16, v16, v24
    v_add_f32 v17, v17, v25
    v_add_f32 v18, v18, v26
    v_add_f32 v19, v19, v27
    v_cvt_pk_bf16_f32 v20, v16, v17
    v_cvt_pk_bf16_f32 v21, v18, v19
    v_lshlrev_b32 v16, 16, v20
    v_and_b32 v17, 0xffff0000, v20
    v_lshlrev_b32 v18, 16, v21
    v_and_b32 v19, 0xffff0000, v21
    s_mov_b64 exec, s[38:39]
    buffer_store_dwordx4 v[16:19], v6, s[12:15], s36 offen nt
    s_mov_b64 exec, -1
    s_nop 0
OL_next:
    s_add_u32 s33, s33, s34
    s_cmp_lt_u32 s33, 128
    s_cbranch_scc1 OL_task
    s_cmp_ge_u32 s33, 130
    s_cbranch_scc1 OL_fin
    s_sub_u32 s33, s33, 2
    s_mov_b32 s40, 1
    s_branch OL_task
OL_fin:
L_end:
    s_endpgm
L_code_end:
.section .rodata,"a"
.p2align 6
.amdhsa_kernel concat_heads__ssm_conv_s5__memory_aug_recurrent_mem_tr__prompt_kernel
  .amdhsa_next_free_vgpr 512
  .amdhsa_next_free_sgpr 102
  .amdhsa_accum_offset 256
  .amdhsa_group_segment_fixed_size 0
  .amdhsa_kernarg_size 152
  .amdhsa_user_sgpr_count 2
  .amdhsa_user_sgpr_kernarg_segment_ptr 1
  .amdhsa_system_sgpr_workgroup_id_x 1
.end_amdhsa_kernel
```
